```python
import torch

def _softmax(x, axis=-1):
    return torch.softmax(x, dim=axis)

def _gelu(x):
    return torch.nn.functional.gelu(x, approximate='tanh')

def _silu(x):
    return torch.nn.functional.silu(x)

def _sigmoid(x):
    return torch.sigmoid(x)

def _layernorm(x, axis=-1, eps=1e-05):
    m = x.mean(dim=axis, keepdim=True)
    v = x.var(dim=axis, keepdim=True, unbiased=False)
    return (x - m) / torch.sqrt(v + eps)

def _scatter_add(tgt, idx, src, axis=0):
    return tgt.clone().index_add_(axis, idx, src)

def _segment_sum(src, seg, n):
    out = torch.zeros((n,) + src.shape[1:], dtype=src.dtype)
    return out.index_add_(0, seg, src)

def _pad(x, pw):
    flat = tuple((v for pair in reversed(pw) for v in pair))
    return torch.nn.functional.pad(x, flat)
kernel_name = 'interleave_layers__memory_aug_recurrent_mem_tr__mixer_token_mlp__prompt'

def setup_inputs():

    _w = lambda a: (lambda t: t.to(torch.bfloat16) if t.is_floating_point() else t)(torch.as_tensor(a))

    def _A_setup():
        B, S, Dm = (1, 2048, 640)
        H, Dh = (32, 128)
        M, seg = (8, 32)
        seg = min(seg, S)
        S = S // seg * seg
        return {'x': _w((lambda *s: torch.randn(*s, dtype=torch.bfloat16) * 0.05)(B, S, Dm)), 'mem0': _w((lambda *s: torch.randn(*s, dtype=torch.bfloat16) * 0.2)(B, M, Dm)), 'Wq': _w((lambda *s: torch.randn(*s, dtype=torch.bfloat16) * 0.8)(Dm, H, Dh) * Dm ** (-0.5)), 'Wk': _w((lambda *s: torch.randn(*s, dtype=torch.bfloat16) * 0.8)(Dm, H, Dh) * Dm ** (-0.5)), 'Wv': _w((lambda *s: torch.randn(*s, dtype=torch.bfloat16) * 0.2)(Dm, H, Dh) * Dm ** (-0.5)), 'Wo': _w((lambda *s: torch.randn(*s, dtype=torch.bfloat16) * 0.2)(H, Dh, Dm) * (H * Dh) ** (-0.5)), 'seg_len': seg}
    _A_in = _A_setup()

    def _B_setup():
        B, S, D, F = (1, 2048, 640, 1728)
        return {'x': _w((lambda *s: torch.randn(*s, dtype=torch.bfloat16) * 0.05)(B, S, D)), 'w1': _w((lambda *s: torch.randn(*s, dtype=torch.bfloat16) * 0.2)(S, F) * S ** (-0.5)), 'b1': _w((lambda *s: torch.randn(*s, dtype=torch.bfloat16) * 3.2)(F) * 0.02), 'w2': _w((lambda *s: torch.randn(*s, dtype=torch.bfloat16) * 0.1)(F, S) * F ** (-0.5)), 'b2': _w((lambda *s: torch.randn(*s, dtype=torch.bfloat16) * 0.2)(S) * 0.02)}
    _B_in = _B_setup()
    return {'A_x': _A_in['x'], 'A_mem0': _A_in['mem0'], 'A_Wq': _A_in['Wq'], 'A_Wk': _A_in['Wk'], 'A_Wv': _A_in['Wv'], 'A_Wo': _A_in['Wo'], 'A_seg_len': _A_in['seg_len'], 'B_x': _B_in['x'], 'B_w1': _B_in['w1'], 'B_b1': _B_in['b1'], 'B_w2': _B_in['w2'], 'B_b2': _B_in['b2']}

def reference(A_x, A_mem0, A_Wq, A_Wk, A_Wv, A_Wo, A_seg_len, B_x, B_w1, B_b1, B_w2, B_b2):

    def _A_ref(x, mem0, Wq, Wk, Wv, Wo, seg_len):
        B, S, Dm = x.shape
        H, Dh = (Wq.shape[1], Wq.shape[2])
        M = mem0.shape[1]
        scale = Dh ** (-0.5)
        n_seg = S // seg_len
        L = M + seg_len
        idx = torch.arange(L)
        mask = (idx[:, None] < M) | (idx[:, None] >= idx[None, :])
        mem = mem0
        outs = []
        for s in range(n_seg):
            xs = x[:, s * seg_len:(s + 1) * seg_len, :].clone()
            h = torch.concatenate([mem, xs], axis=1)
            q = torch.einsum('btd,dhe->bhte', h, Wq)
            k = torch.einsum('btd,dhe->bhte', h, Wk)
            v = torch.einsum('btd,dhe->bhte', h, Wv)
            scores = torch.einsum('bhqe,bhke->bhqk', q, k) * scale
            scores = torch.where(mask[None, None], scores, -1000000000.0)
            p = _softmax(scores, axis=-1)
            o = torch.einsum('bhqk,bhke->bhqe', p, v)
            o = torch.einsum('bhte,hed->btd', o, Wo)
            mem = o[:, :M, :].clone()
            outs.append(o[:, M:, :])
        return torch.concatenate(outs, axis=1)

    def _B_ref(x, w1, b1, w2, b2):
        B, S, D = x.shape
        h = _layernorm(x, axis=-1)
        u = torch.einsum('bsd,sf->bdf', h, w1) + b1
        u = _gelu(u)
        y = torch.einsum('bdf,fs->bds', u, w2) + b2
        return (lambda x, *d: x.permute(*d))(y, 0, 2, 1)
    x = A_x
    x = x + _A_ref(_layernorm(x, axis=-1), A_mem0, A_Wq, A_Wk, A_Wv, A_Wo, A_seg_len)
    x = x + _B_ref(_layernorm(x, axis=-1), B_w1, B_b1, B_w2, B_b2)
    x = x + _A_ref(_layernorm(x, axis=-1), A_mem0, A_Wq, A_Wk, A_Wv, A_Wo, A_seg_len)
    x = x + _B_ref(_layernorm(x, axis=-1), B_w1, B_b1, B_w2, B_b2)
    return x
```

```asm
; @launch grid=(256,1,1) block=(256,1,1) lds=163840
.amdgcn_target "amdgcn-amd-amdhsa--gfx950"
.text
.globl interleave_layers__memory_aug_recurrent_mem_tr__mixer_token_mlp__prompt_kernel
.p2align 8
.type interleave_layers__memory_aug_recurrent_mem_tr__mixer_token_mlp__prompt_kernel,@function
interleave_layers__memory_aug_recurrent_mem_tr__mixer_token_mlp__prompt_kernel:
s_cmp_ge_u32 s2, 256
s_cbranch_scc1 DONE
s_load_dwordx2 s[4:5], s[0:1], 112
s_mov_b32 s6, 268435456
s_mov_b32 s7, 0x20000
s_load_dwordx2 s[8:9], s[0:1], 104
s_mov_b32 s10, 256
s_mov_b32 s11, 0x20000
s_mov_b32 s37, 0
s_getreg_b32 s39, hwreg(HW_REG_XCC_ID)
s_and_b32 s39, s39, 15
s_waitcnt lgkmcnt(0)
s_cmp_gt_u32 s39, 7
s_cbranch_scc1 NOSEAT
s_lshl_b32 s36, s39, 4
v_mov_b32 v4, 0
v_mov_b32 v5, s36
v_cmp_eq_u32 vcc, 0, v0
s_nop 0
s_and_saveexec_b64 s[34:35], vcc
s_cbranch_execz EL_SKIP
v_mov_b32 v6, 1
buffer_atomic_add v6, v5, s[8:11], 0 offen offset:0 sc0 sc1
s_waitcnt vmcnt(0)
ds_write_b32 v4, v6
s_waitcnt lgkmcnt(0)
EL_SKIP:
s_mov_b64 exec, s[34:35]
s_barrier
ds_read_b32 v6, v4
s_waitcnt lgkmcnt(0)
v_readfirstlane_b32 s38, v6
s_barrier
s_cmp_le_u32 s38, 31
s_cbranch_scc1 ROLES
NOSEAT:
s_mov_b32 s36, 0
v_mov_b32 v4, 0
v_mov_b32 v5, s36
v_cmp_eq_u32 vcc, 0, v0
s_nop 0
s_and_saveexec_b64 s[34:35], vcc
s_cbranch_execz EL_SKIP2
v_mov_b32 v6, 1
buffer_atomic_add v6, v5, s[8:11], 0 offen offset:132 sc0 sc1
s_waitcnt vmcnt(0)
ds_write_b32 v4, v6
s_waitcnt lgkmcnt(0)
EL_SKIP2:
s_mov_b64 exec, s[34:35]
s_barrier
ds_read_b32 v6, v4
s_waitcnt lgkmcnt(0)
v_readfirstlane_b32 s38, v6
s_barrier
FALLBACK:
s_waitcnt vmcnt(0) lgkmcnt(0)
s_barrier
s_mov_b32 s36, 0
v_mov_b32 v4, 0
v_mov_b32 v5, s36
v_cmp_eq_u32 vcc, 0, v0
s_nop 0
s_and_saveexec_b64 s[34:35], vcc
s_cbranch_execz EL_SKIP3
v_mov_b32 v6, 1
buffer_atomic_add v6, v5, s[8:11], 0 offen offset:20 sc0 sc1
s_waitcnt vmcnt(0)
ds_write_b32 v4, v6
s_waitcnt lgkmcnt(0)
EL_SKIP3:
s_mov_b64 exec, s[34:35]
s_barrier
ds_read_b32 v6, v4
s_waitcnt lgkmcnt(0)
v_readfirstlane_b32 s38, v6
s_barrier
s_cmp_gt_u32 s38, 255
s_cbranch_scc1 ABORT
s_lshr_b32 s39, s38, 5
s_and_b32 s38, s38, 31
s_mov_b32 s37, 8
ROLES:
s_cmp_eq_u32 s39, 0
s_cbranch_scc1 ROLE_CHAIN
s_sub_u32 s36, s39, 1
s_mul_i32 s48, s38, 7
s_add_u32 s48, s48, s36
s_mul_i32 s73, s36, 20
s_add_u32 s73, s73, s38
s_cmp_lt_u32 s38, 20
s_cselect_b32 s73, s73, 999
s_mul_i32 s74, s36, 23
s_add_u32 s74, s74, s38
s_cmp_lt_u32 s38, 23
s_cselect_b32 s74, s74, 999
v_lshrrev_b32 v4, 6, v0
s_lshl_b32 s36, s48, 2
v_readfirstlane_b32 s49, v4
s_nop 0
s_add_u32 s36, s36, s49
s_load_dwordx2 s[12:13], s[0:1], 16
s_mov_b32 s14, 5242880
s_mov_b32 s15, 0x20000
s_load_dwordx2 s[16:17], s[0:1], 24
s_mov_b32 s18, 5242880
s_mov_b32 s19, 0x20000
s_load_dwordx2 s[20:21], s[0:1], 32
s_mov_b32 s22, 5242880
s_mov_b32 s23, 0x20000
s_load_dwordx2 s[24:25], s[0:1], 40
s_mov_b32 s26, 5242880
s_mov_b32 s27, 0x20000
s_mul_i32 s51, s36, 9363
s_lshr_b32 s51, s51, 16
s_mul_i32 s52, s51, 7
s_sub_u32 s52, s36, s52
s_and_b32 s53, s51, 3
v_and_b32 v4, 63, v0
v_lshlrev_b32 v13, 4, v4
v_lshrrev_b32 v5, 4, v4
v_lshrrev_b32 v10, 2, v4
v_and_b32 v11, 3, v4
v_mul_u32_u24 v7, 1280, v10
v_lshl_add_u32 v7, v11, 4, v7
v_lshrrev_b32 v6, 3, v4
v_lshlrev_b32 v6, 13, v6
v_lshl_add_u32 v6, v11, 4, v6
v_and_b32 v10, 1, v10
v_lshl_add_u32 v12, v10, 17, v6
v_lshl_add_u32 v6, v10, 18, v6
v_bfe_u32 v8, v4, 3, 1
v_lshlrev_b32 v8, 5, v8
v_lshl_add_u32 v8, v11, 3, v8
v_lshl_add_u32 v8, v10, 6, v8
s_lshl_b32 s58, s49, 13
v_add_u32 v8, s58, v8
v_and_b32 v10, 1, v5
v_lshl_add_u32 v9, v10, 10, v8
v_lshrrev_b32 v10, 1, v5
v_lshl_add_u32 v9, v10, 8, v9
v_lshl_add_u32 v8, v5, 8, v8
s_lshl_b32 s54, s51, 6
s_lshr_b32 s56, s51, 2
s_mul_i32 s55, s56, 163840
s_mul_i32 s56, s53, 320
s_add_u32 s55, s55, s56
s_mul_i32 s59, s51, 34816
s_add_u32 s59, s59, 25165824
s_mul_i32 s60, s51, 20480
s_add_u32 s60, s60, 2097152
s_waitcnt lgkmcnt(0)
s_cmp_lg_u32 s52, 0
s_cbranch_scc1 PREP_1
s_add_u32 s56, s53, 0
s_and_b32 s56, s56, 3
s_mul_i32 s56, s56, 1310720
s_add_u32 s56, s56, s54
s_add_u32 m0, s58, 0
s_add_u32 s57, s56, 65536
buffer_load_dwordx4 v6, s[16:19], s56 offen lds
s_add_u32 m0, s58, 1024
s_nop 0
buffer_load_dwordx4 v6, s[16:19], s57 offen lds
s_add_u32 s56, s53, 0
s_and_b32 s56, s56, 3
s_mul_i32 s56, s56, 1310720
s_add_u32 s56, s56, s54
s_add_u32 s56, s56, 1048576
s_add_u32 m0, s58, 2048
s_add_u32 s57, s56, 65536
buffer_load_dwordx4 v12, s[20:23], s56 offen lds
s_add_u32 m0, s58, 3072
s_nop 0
buffer_load_dwordx4 v12, s[20:23], s57 offen lds
s_add_u32 s56, s53, 1
s_and_b32 s56, s56, 3
s_mul_i32 s56, s56, 1310720
s_add_u32 s56, s56, s54
s_add_u32 s56, s56, 131072
s_add_u32 m0, s58, 4096
s_add_u32 s57, s56, 65536
buffer_load_dwordx4 v6, s[16:19], s56 offen lds
s_add_u32 m0, s58, 5120
s_nop 0
buffer_load_dwordx4 v6, s[16:19], s57 offen lds
s_add_u32 s56, s53, 2
s_and_b32 s56, s56, 3
s_mul_i32 s56, s56, 40960
s_add_u32 s56, s56, s55
s_add_u32 s56, s56, 256
s_add_u32 m0, s58, 6144
s_add_u32 s57, s56, 20480
buffer_load_dwordx4 v7, s[24:27], s56 offen lds
s_add_u32 m0, s58, 7168
s_nop 0
buffer_load_dwordx4 v7, s[24:27], s57 offen lds
s_waitcnt vmcnt(0) lgkmcnt(0)
ds_read_b64_tr_b16 v[16:17], v8 offset:0
ds_read_b64_tr_b16 v[18:19], v8 offset:128
ds_read_b64_tr_b16 v[20:21], v8 offset:1024
ds_read_b64_tr_b16 v[22:23], v8 offset:1152
ds_read_b64_tr_b16 v[24:25], v8 offset:2048
ds_read_b64_tr_b16 v[26:27], v8 offset:2176
ds_read_b64_tr_b16 v[28:29], v8 offset:3072
ds_read_b64_tr_b16 v[30:31], v8 offset:3200
ds_read_b64_tr_b16 v[32:33], v8 offset:4096
ds_read_b64_tr_b16 v[34:35], v8 offset:4224
ds_read_b64_tr_b16 v[36:37], v8 offset:5120
ds_read_b64_tr_b16 v[38:39], v8 offset:5248
s_waitcnt lgkmcnt(0)
ds_read_b64_tr_b16 v[40:41], v9 offset:6144
ds_read_b64_tr_b16 v[42:43], v9 offset:6272
ds_read_b64_tr_b16 v[44:45], v9 offset:6656
ds_read_b64_tr_b16 v[46:47], v9 offset:6784
s_waitcnt lgkmcnt(0)
s_add_u32 s56, s60, 0
buffer_store_dwordx4 v[16:19], v13, s[4:7], s56 offen sc1
buffer_store_dwordx4 v[20:23], v13, s[4:7], s56 offen offset:1024 sc1
s_add_u32 s56, s60, 14336
buffer_store_dwordx4 v[24:27], v13, s[4:7], s56 offen sc1
buffer_store_dwordx4 v[28:31], v13, s[4:7], s56 offen offset:1024 sc1
s_add_u32 s56, s59, 8192
buffer_store_dwordx4 v[32:35], v13, s[4:7], s56 offen sc1
buffer_store_dwordx4 v[36:39], v13, s[4:7], s56 offen offset:1024 sc1
s_add_u32 s56, s59, 22528
buffer_store_dwordx4 v[40:43], v13, s[4:7], s56 offen sc1
buffer_store_dwordx4 v[44:47], v13, s[4:7], s56 offen offset:1024 sc1
s_branch PREP_7
PREP_1:
s_cmp_lg_u32 s52, 1
s_cbranch_scc1 PREP_2
s_add_u32 s56, s53, 1
s_and_b32 s56, s56, 3
s_mul_i32 s56, s56, 1310720
s_add_u32 s56, s56, s54
s_add_u32 s56, s56, 524288
s_add_u32 m0, s58, 0
s_add_u32 s57, s56, 65536
buffer_load_dwordx4 v6, s[20:23], s56 offen lds
s_add_u32 m0, s58, 1024
s_nop 0
buffer_load_dwordx4 v6, s[20:23], s57 offen lds
s_add_u32 s56, s53, 2
s_and_b32 s56, s56, 3
s_mul_i32 s56, s56, 1310720
s_add_u32 s56, s56, s54
s_add_u32 s56, s56, 655360
s_add_u32 m0, s58, 2048
s_add_u32 s57, s56, 65536
buffer_load_dwordx4 v6, s[20:23], s56 offen lds
s_add_u32 m0, s58, 3072
s_nop 0
buffer_load_dwordx4 v6, s[20:23], s57 offen lds
s_add_u32 s56, s53, 1
s_and_b32 s56, s56, 3
s_mul_i32 s56, s56, 1310720
s_add_u32 s56, s56, s54
s_add_u32 s56, s56, 655360
s_add_u32 m0, s58, 4096
s_add_u32 s57, s56, 65536
buffer_load_dwordx4 v6, s[16:19], s56 offen lds
s_add_u32 m0, s58, 5120
s_nop 0
buffer_load_dwordx4 v6, s[16:19], s57 offen lds
s_add_u32 s56, s53, 1
s_and_b32 s56, s56, 3
s_mul_i32 s56, s56, 40960
s_add_u32 s56, s56, s55
s_add_u32 m0, s58, 6144
s_add_u32 s57, s56, 20480
buffer_load_dwordx4 v7, s[24:27], s56 offen lds
s_add_u32 m0, s58, 7168
s_nop 0
buffer_load_dwordx4 v7, s[24:27], s57 offen lds
s_waitcnt vmcnt(0) lgkmcnt(0)
ds_read_b64_tr_b16 v[16:17], v8 offset:0
ds_read_b64_tr_b16 v[18:19], v8 offset:128
ds_read_b64_tr_b16 v[20:21], v8 offset:1024
ds_read_b64_tr_b16 v[22:23], v8 offset:1152
ds_read_b64_tr_b16 v[24:25], v8 offset:2048
ds_read_b64_tr_b16 v[26:27], v8 offset:2176
ds_read_b64_tr_b16 v[28:29], v8 offset:3072
ds_read_b64_tr_b16 v[30:31], v8 offset:3200
ds_read_b64_tr_b16 v[32:33], v8 offset:4096
ds_read_b64_tr_b16 v[34:35], v8 offset:4224
ds_read_b64_tr_b16 v[36:37], v8 offset:5120
ds_read_b64_tr_b16 v[38:39], v8 offset:5248
s_waitcnt lgkmcnt(0)
ds_read_b64_tr_b16 v[40:41], v9 offset:6144
ds_read_b64_tr_b16 v[42:43], v9 offset:6272
ds_read_b64_tr_b16 v[44:45], v9 offset:6656
ds_read_b64_tr_b16 v[46:47], v9 offset:6784
s_waitcnt lgkmcnt(0)
s_add_u32 s56, s60, 2048
buffer_store_dwordx4 v[16:19], v13, s[4:7], s56 offen sc1
buffer_store_dwordx4 v[20:23], v13, s[4:7], s56 offen offset:1024 sc1
s_add_u32 s56, s60, 16384
buffer_store_dwordx4 v[24:27], v13, s[4:7], s56 offen sc1
buffer_store_dwordx4 v[28:31], v13, s[4:7], s56 offen offset:1024 sc1
s_add_u32 s56, s59, 10240
buffer_store_dwordx4 v[32:35], v13, s[4:7], s56 offen sc1
buffer_store_dwordx4 v[36:39], v13, s[4:7], s56 offen offset:1024 sc1
s_add_u32 s56, s59, 24576
buffer_store_dwordx4 v[40:43], v13, s[4:7], s56 offen sc1
buffer_store_dwordx4 v[44:47], v13, s[4:7], s56 offen offset:1024 sc1
s_branch PREP_7
PREP_2:
s_cmp_lg_u32 s52, 2
s_cbranch_scc1 PREP_3
s_add_u32 s56, s53, 3
s_and_b32 s56, s56, 3
s_mul_i32 s56, s56, 1310720
s_add_u32 s56, s56, s54
s_add_u32 s56, s56, 131072
s_add_u32 m0, s58, 0
s_add_u32 s57, s56, 65536
buffer_load_dwordx4 v6, s[20:23], s56 offen lds
s_add_u32 m0, s58, 1024
s_nop 0
buffer_load_dwordx4 v6, s[20:23], s57 offen lds
s_add_u32 s56, s53, 3
s_and_b32 s56, s56, 3
s_mul_i32 s56, s56, 40960
s_add_u32 s56, s56, s55
s_add_u32 s56, s56, 64
s_add_u32 m0, s58, 2048
s_add_u32 s57, s56, 20480
buffer_load_dwordx4 v7, s[24:27], s56 offen lds
s_add_u32 m0, s58, 3072
s_nop 0
buffer_load_dwordx4 v7, s[24:27], s57 offen lds
s_add_u32 s56, s53, 1
s_and_b32 s56, s56, 3
s_mul_i32 s56, s56, 1310720
s_add_u32 s56, s56, s54
s_add_u32 s56, s56, 1048576
s_add_u32 m0, s58, 4096
s_add_u32 s57, s56, 65536
buffer_load_dwordx4 v12, s[16:19], s56 offen lds
s_add_u32 m0, s58, 5120
s_nop 0
buffer_load_dwordx4 v12, s[16:19], s57 offen lds
s_add_u32 s56, s53, 3
s_and_b32 s56, s56, 3
s_mul_i32 s56, s56, 40960
s_add_u32 s56, s56, s55
s_add_u32 m0, s58, 6144
s_add_u32 s57, s56, 20480
buffer_load_dwordx4 v7, s[24:27], s56 offen lds
s_add_u32 m0, s58, 7168
s_nop 0
buffer_load_dwordx4 v7, s[24:27], s57 offen lds
s_waitcnt vmcnt(0) lgkmcnt(0)
ds_read_b64_tr_b16 v[16:17], v8 offset:0
ds_read_b64_tr_b16 v[18:19], v8 offset:128
ds_read_b64_tr_b16 v[20:21], v8 offset:1024
ds_read_b64_tr_b16 v[22:23], v8 offset:1152
ds_read_b64_tr_b16 v[24:25], v9 offset:2048
ds_read_b64_tr_b16 v[26:27], v9 offset:2176
ds_read_b64_tr_b16 v[28:29], v9 offset:2560
ds_read_b64_tr_b16 v[30:31], v9 offset:2688
ds_read_b64_tr_b16 v[32:33], v8 offset:4096
ds_read_b64_tr_b16 v[34:35], v8 offset:4224
ds_read_b64_tr_b16 v[36:37], v8 offset:5120
ds_read_b64_tr_b16 v[38:39], v8 offset:5248
s_waitcnt lgkmcnt(0)
ds_read_b64_tr_b16 v[40:41], v9 offset:6144
ds_read_b64_tr_b16 v[42:43], v9 offset:6272
ds_read_b64_tr_b16 v[44:45], v9 offset:6656
ds_read_b64_tr_b16 v[46:47], v9 offset:6784
s_waitcnt lgkmcnt(0)
s_add_u32 s56, s60, 4096
buffer_store_dwordx4 v[16:19], v13, s[4:7], s56 offen sc1
buffer_store_dwordx4 v[20:23], v13, s[4:7], s56 offen offset:1024 sc1
s_add_u32 s56, s60, 18432
buffer_store_dwordx4 v[24:27], v13, s[4:7], s56 offen sc1
buffer_store_dwordx4 v[28:31], v13, s[4:7], s56 offen offset:1024 sc1
s_add_u32 s56, s59, 12288
buffer_store_dwordx4 v[32:35], v13, s[4:7], s56 offen sc1
buffer_store_dwordx4 v[36:39], v13, s[4:7], s56 offen offset:1024 sc1
s_add_u32 s56, s59, 26624
buffer_store_dwordx4 v[40:43], v13, s[4:7], s56 offen sc1
buffer_store_dwordx4 v[44:47], v13, s[4:7], s56 offen offset:1024 sc1
s_branch PREP_7
PREP_3:
s_cmp_lg_u32 s52, 3
s_cbranch_scc1 PREP_4
s_add_u32 s56, s53, 1
s_and_b32 s56, s56, 3
s_mul_i32 s56, s56, 40960
s_add_u32 s56, s56, s55
s_add_u32 s56, s56, 64
s_add_u32 m0, s58, 0
s_add_u32 s57, s56, 20480
buffer_load_dwordx4 v7, s[24:27], s56 offen lds
s_add_u32 m0, s58, 1024
s_nop 0
buffer_load_dwordx4 v7, s[24:27], s57 offen lds
s_add_u32 s56, s53, 0
s_and_b32 s56, s56, 3
s_mul_i32 s56, s56, 1310720
s_add_u32 s56, s56, s54
s_add_u32 s56, s56, 131072
s_add_u32 m0, s58, 2048
s_add_u32 s57, s56, 65536
buffer_load_dwordx4 v6, s[16:19], s56 offen lds
s_add_u32 m0, s58, 3072
s_nop 0
buffer_load_dwordx4 v6, s[16:19], s57 offen lds
s_add_u32 s56, s53, 2
s_and_b32 s56, s56, 3
s_mul_i32 s56, s56, 1310720
s_add_u32 s56, s56, s54
s_add_u32 s56, s56, 131072
s_add_u32 m0, s58, 4096
s_add_u32 s57, s56, 65536
buffer_load_dwordx4 v6, s[16:19], s56 offen lds
s_add_u32 m0, s58, 5120
s_nop 0
buffer_load_dwordx4 v6, s[16:19], s57 offen lds
s_add_u32 s56, s53, 1
s_and_b32 s56, s56, 3
s_mul_i32 s56, s56, 40960
s_add_u32 s56, s56, s55
s_add_u32 s56, s56, 128
s_add_u32 m0, s58, 6144
s_add_u32 s57, s56, 20480
buffer_load_dwordx4 v7, s[24:27], s56 offen lds
s_add_u32 m0, s58, 7168
s_nop 0
buffer_load_dwordx4 v7, s[24:27], s57 offen lds
s_waitcnt vmcnt(0) lgkmcnt(0)
ds_read_b64_tr_b16 v[16:17], v9 offset:0
ds_read_b64_tr_b16 v[18:19], v9 offset:128
ds_read_b64_tr_b16 v[20:21], v9 offset:512
ds_read_b64_tr_b16 v[22:23], v9 offset:640
ds_read_b64_tr_b16 v[24:25], v8 offset:2048
ds_read_b64_tr_b16 v[26:27], v8 offset:2176
ds_read_b64_tr_b16 v[28:29], v8 offset:3072
ds_read_b64_tr_b16 v[30:31], v8 offset:3200
ds_read_b64_tr_b16 v[32:33], v8 offset:4096
ds_read_b64_tr_b16 v[34:35], v8 offset:4224
ds_read_b64_tr_b16 v[36:37], v8 offset:5120
ds_read_b64_tr_b16 v[38:39], v8 offset:5248
s_waitcnt lgkmcnt(0)
ds_read_b64_tr_b16 v[40:41], v9 offset:6144
ds_read_b64_tr_b16 v[42:43], v9 offset:6272
ds_read_b64_tr_b16 v[44:45], v9 offset:6656
ds_read_b64_tr_b16 v[46:47], v9 offset:6784
s_waitcnt lgkmcnt(0)
s_add_u32 s56, s60, 6144
buffer_store_dwordx4 v[16:19], v13, s[4:7], s56 offen sc1
buffer_store_dwordx4 v[20:23], v13, s[4:7], s56 offen offset:1024 sc1
s_add_u32 s56, s59, 0
buffer_store_dwordx4 v[24:27], v13, s[4:7], s56 offen sc1
buffer_store_dwordx4 v[28:31], v13, s[4:7], s56 offen offset:1024 sc1
s_add_u32 s56, s59, 14336
buffer_store_dwordx4 v[32:35], v13, s[4:7], s56 offen sc1
buffer_store_dwordx4 v[36:39], v13, s[4:7], s56 offen offset:1024 sc1
s_add_u32 s56, s59, 28672
buffer_store_dwordx4 v[40:43], v13, s[4:7], s56 offen sc1
buffer_store_dwordx4 v[44:47], v13, s[4:7], s56 offen offset:1024 sc1
s_branch PREP_7
PREP_4:
s_cmp_lg_u32 s52, 4
s_cbranch_scc1 PREP_5
s_add_u32 s56, s53, 0
s_and_b32 s56, s56, 3
s_mul_i32 s56, s56, 1310720
s_add_u32 s56, s56, s54
s_add_u32 m0, s58, 0
s_add_u32 s57, s56, 65536
buffer_load_dwordx4 v6, s[20:23], s56 offen lds
s_add_u32 m0, s58, 1024
s_nop 0
buffer_load_dwordx4 v6, s[20:23], s57 offen lds
s_add_u32 s56, s53, 0
s_and_b32 s56, s56, 3
s_mul_i32 s56, s56, 1310720
s_add_u32 s56, s56, s54
s_add_u32 s56, s56, 524288
s_add_u32 m0, s58, 2048
s_add_u32 s57, s56, 65536
buffer_load_dwordx4 v6, s[16:19], s56 offen lds
s_add_u32 m0, s58, 3072
s_nop 0
buffer_load_dwordx4 v6, s[16:19], s57 offen lds
s_add_u32 s56, s53, 2
s_and_b32 s56, s56, 3
s_mul_i32 s56, s56, 1310720
s_add_u32 s56, s56, s54
s_add_u32 s56, s56, 524288
s_add_u32 m0, s58, 4096
s_add_u32 s57, s56, 65536
buffer_load_dwordx4 v6, s[16:19], s56 offen lds
s_add_u32 m0, s58, 5120
s_nop 0
buffer_load_dwordx4 v6, s[16:19], s57 offen lds
s_add_u32 s56, s53, 1
s_and_b32 s56, s56, 3
s_mul_i32 s56, s56, 40960
s_add_u32 s56, s56, s55
s_add_u32 s56, s56, 192
s_add_u32 m0, s58, 6144
s_add_u32 s57, s56, 20480
buffer_load_dwordx4 v7, s[24:27], s56 offen lds
s_add_u32 m0, s58, 7168
s_nop 0
buffer_load_dwordx4 v7, s[24:27], s57 offen lds
s_waitcnt vmcnt(0) lgkmcnt(0)
ds_read_b64_tr_b16 v[16:17], v8 offset:0
ds_read_b64_tr_b16 v[18:19], v8 offset:128
ds_read_b64_tr_b16 v[20:21], v8 offset:1024
ds_read_b64_tr_b16 v[22:23], v8 offset:1152
ds_read_b64_tr_b16 v[24:25], v8 offset:2048
ds_read_b64_tr_b16 v[26:27], v8 offset:2176
ds_read_b64_tr_b16 v[28:29], v8 offset:3072
ds_read_b64_tr_b16 v[30:31], v8 offset:3200
ds_read_b64_tr_b16 v[32:33], v8 offset:4096
ds_read_b64_tr_b16 v[34:35], v8 offset:4224
ds_read_b64_tr_b16 v[36:37], v8 offset:5120
ds_read_b64_tr_b16 v[38:39], v8 offset:5248
s_waitcnt lgkmcnt(0)
ds_read_b64_tr_b16 v[40:41], v9 offset:6144
ds_read_b64_tr_b16 v[42:43], v9 offset:6272
ds_read_b64_tr_b16 v[44:45], v9 offset:6656
ds_read_b64_tr_b16 v[46:47], v9 offset:6784
s_waitcnt lgkmcnt(0)
s_add_u32 s56, s60, 8192
buffer_store_dwordx4 v[16:19], v13, s[4:7], s56 offen sc1
buffer_store_dwordx4 v[20:23], v13, s[4:7], s56 offen offset:1024 sc1
s_add_u32 s56, s59, 2048
buffer_store_dwordx4 v[24:27], v13, s[4:7], s56 offen sc1
buffer_store_dwordx4 v[28:31], v13, s[4:7], s56 offen offset:1024 sc1
s_add_u32 s56, s59, 16384
buffer_store_dwordx4 v[32:35], v13, s[4:7], s56 offen sc1
buffer_store_dwordx4 v[36:39], v13, s[4:7], s56 offen offset:1024 sc1
s_add_u32 s56, s59, 30720
buffer_store_dwordx4 v[40:43], v13, s[4:7], s56 offen sc1
buffer_store_dwordx4 v[44:47], v13, s[4:7], s56 offen offset:1024 sc1
s_branch PREP_7
PREP_5:
s_cmp_lg_u32 s52, 5
s_cbranch_scc1 PREP_6
s_add_u32 s56, s53, 2
s_and_b32 s56, s56, 3
s_mul_i32 s56, s56, 1310720
s_add_u32 s56, s56, s54
s_add_u32 m0, s58, 0
s_add_u32 s57, s56, 65536
buffer_load_dwordx4 v6, s[20:23], s56 offen lds
s_add_u32 m0, s58, 1024
s_nop 0
buffer_load_dwordx4 v6, s[20:23], s57 offen lds
s_add_u32 s56, s53, 0
s_and_b32 s56, s56, 3
s_mul_i32 s56, s56, 1310720
s_add_u32 s56, s56, s54
s_add_u32 s56, s56, 655360
s_add_u32 m0, s58, 2048
s_add_u32 s57, s56, 65536
buffer_load_dwordx4 v6, s[16:19], s56 offen lds
s_add_u32 m0, s58, 3072
s_nop 0
buffer_load_dwordx4 v6, s[16:19], s57 offen lds
s_add_u32 s56, s53, 0
s_and_b32 s56, s56, 3
s_mul_i32 s56, s56, 40960
s_add_u32 s56, s56, s55
s_add_u32 s56, s56, 256
s_add_u32 m0, s58, 4096
s_add_u32 s57, s56, 20480
buffer_load_dwordx4 v7, s[24:27], s56 offen lds
s_add_u32 m0, s58, 5120
s_nop 0
buffer_load_dwordx4 v7, s[24:27], s57 offen lds
s_add_u32 s56, s53, 2
s_and_b32 s56, s56, 3
s_mul_i32 s56, s56, 40960
s_add_u32 s56, s56, s55
s_add_u32 s56, s56, 192
s_add_u32 m0, s58, 6144
s_add_u32 s57, s56, 20480
buffer_load_dwordx4 v7, s[24:27], s56 offen lds
s_add_u32 m0, s58, 7168
s_nop 0
buffer_load_dwordx4 v7, s[24:27], s57 offen lds
s_waitcnt vmcnt(0) lgkmcnt(0)
ds_read_b64_tr_b16 v[16:17], v8 offset:0
ds_read_b64_tr_b16 v[18:19], v8 offset:128
ds_read_b64_tr_b16 v[20:21], v8 offset:1024
ds_read_b64_tr_b16 v[22:23], v8 offset:1152
ds_read_b64_tr_b16 v[24:25], v8 offset:2048
ds_read_b64_tr_b16 v[26:27], v8 offset:2176
ds_read_b64_tr_b16 v[28:29], v8 offset:3072
ds_read_b64_tr_b16 v[30:31], v8 offset:3200
ds_read_b64_tr_b16 v[32:33], v9 offset:4096
ds_read_b64_tr_b16 v[34:35], v9 offset:4224
ds_read_b64_tr_b16 v[36:37], v9 offset:4608
ds_read_b64_tr_b16 v[38:39], v9 offset:4736
s_waitcnt lgkmcnt(0)
ds_read_b64_tr_b16 v[40:41], v9 offset:6144
ds_read_b64_tr_b16 v[42:43], v9 offset:6272
ds_read_b64_tr_b16 v[44:45], v9 offset:6656
ds_read_b64_tr_b16 v[46:47], v9 offset:6784
s_waitcnt lgkmcnt(0)
s_add_u32 s56, s60, 10240
buffer_store_dwordx4 v[16:19], v13, s[4:7], s56 offen sc1
buffer_store_dwordx4 v[20:23], v13, s[4:7], s56 offen offset:1024 sc1
s_add_u32 s56, s59, 4096
buffer_store_dwordx4 v[24:27], v13, s[4:7], s56 offen sc1
buffer_store_dwordx4 v[28:31], v13, s[4:7], s56 offen offset:1024 sc1
s_add_u32 s56, s59, 18432
buffer_store_dwordx4 v[32:35], v13, s[4:7], s56 offen sc1
buffer_store_dwordx4 v[36:39], v13, s[4:7], s56 offen offset:1024 sc1
s_add_u32 s56, s59, 32768
buffer_store_dwordx4 v[40:43], v13, s[4:7], s56 offen sc1
buffer_store_dwordx4 v[44:47], v13, s[4:7], s56 offen offset:1024 sc1
s_branch PREP_7
PREP_6:
s_add_u32 s56, s53, 2
s_and_b32 s56, s56, 3
s_mul_i32 s56, s56, 40960
s_add_u32 s56, s56, s55
s_add_u32 s56, s56, 128
s_add_u32 m0, s58, 0
s_add_u32 s57, s56, 20480
buffer_load_dwordx4 v7, s[24:27], s56 offen lds
s_add_u32 m0, s58, 1024
s_nop 0
buffer_load_dwordx4 v7, s[24:27], s57 offen lds
s_add_u32 s56, s53, 1
s_and_b32 s56, s56, 3
s_mul_i32 s56, s56, 1310720
s_add_u32 s56, s56, s54
s_add_u32 m0, s58, 2048
s_add_u32 s57, s56, 65536
buffer_load_dwordx4 v6, s[16:19], s56 offen lds
s_add_u32 m0, s58, 3072
s_nop 0
buffer_load_dwordx4 v6, s[16:19], s57 offen lds
s_add_u32 s56, s53, 0
s_and_b32 s56, s56, 3
s_mul_i32 s56, s56, 40960
s_add_u32 s56, s56, s55
s_add_u32 m0, s58, 4096
s_add_u32 s57, s56, 20480
buffer_load_dwordx4 v7, s[24:27], s56 offen lds
s_add_u32 m0, s58, 5120
s_nop 0
buffer_load_dwordx4 v7, s[24:27], s57 offen lds
s_waitcnt vmcnt(0) lgkmcnt(0)
ds_read_b64_tr_b16 v[16:17], v9 offset:0
ds_read_b64_tr_b16 v[18:19], v9 offset:128
ds_read_b64_tr_b16 v[20:21], v9 offset:512
ds_read_b64_tr_b16 v[22:23], v9 offset:640
ds_read_b64_tr_b16 v[24:25], v8 offset:2048
ds_read_b64_tr_b16 v[26:27], v8 offset:2176
ds_read_b64_tr_b16 v[28:29], v8 offset:3072
ds_read_b64_tr_b16 v[30:31], v8 offset:3200
ds_read_b64_tr_b16 v[32:33], v9 offset:4096
ds_read_b64_tr_b16 v[34:35], v9 offset:4224
ds_read_b64_tr_b16 v[36:37], v9 offset:4608
ds_read_b64_tr_b16 v[38:39], v9 offset:4736
s_waitcnt lgkmcnt(0)
s_waitcnt lgkmcnt(0)
s_add_u32 s56, s60, 12288
buffer_store_dwordx4 v[16:19], v13, s[4:7], s56 offen sc1
buffer_store_dwordx4 v[20:23], v13, s[4:7], s56 offen offset:1024 sc1
s_add_u32 s56, s59, 6144
buffer_store_dwordx4 v[24:27], v13, s[4:7], s56 offen sc1
buffer_store_dwordx4 v[28:31], v13, s[4:7], s56 offen offset:1024 sc1
s_add_u32 s56, s59, 20480
buffer_store_dwordx4 v[32:35], v13, s[4:7], s56 offen sc1
buffer_store_dwordx4 v[36:39], v13, s[4:7], s56 offen offset:1024 sc1
PREP_7:
s_cmp_ge_u32 s48, 192
s_cbranch_scc1 ROLE_AW
s_load_dwordx2 s[12:13], s[0:1], 0
s_mov_b32 s14, 2621440
s_mov_b32 s15, 0x20000
s_load_dwordx2 s[20:21], s[0:1], 64
s_mov_b32 s22, 7077888
s_mov_b32 s23, 0x20000
s_load_dwordx2 s[24:25], s[0:1], 80
s_mov_b32 s26, 7077888
s_mov_b32 s27, 0x20000
s_load_dwordx2 s[28:29], s[0:1], 72
s_mov_b32 s30, 3456
s_mov_b32 s31, 0x20000
s_load_dwordx2 s[40:41], s[0:1], 88
s_mov_b32 s42, 4096
s_mov_b32 s43, 0x20000
s_load_dwordx2 s[44:45], s[0:1], 96
s_mov_b32 s46, 2621440
s_mov_b32 s47, 0x20000
v_and_b32 v1, 63, v0
v_lshrrev_b32 v3, 6, v0
v_lshlrev_b32 v2, 4, v1
v_readfirstlane_b32 s49, v3
v_lshrrev_b32 v3, 4, v1
s_mov_b32 s66, -1
s_mov_b32 s67, 0
s_mov_b32 s50, 0
s_waitcnt lgkmcnt(0)
s_sub_u32 s51, s48, 128
s_cmp_ge_u32 s51, 32
s_cbranch_scc1 GW_NOZ
s_lshl_b32 s51, s51, 10
v_lshlrev_b32 v4, 2, v0
v_mov_b32 v5, 0
buffer_store_dword v5, v4, s[4:7], s51 offen sc1
GW_NOZ:
s_cmp_ge_u32 s48, 40
s_cbranch_scc1 GW_NOP
s_lshl_b32 s51, s48, 12
s_add_u32 s51, s51, 1179648
v_lshlrev_b32 v4, 4, v0
v_mov_b32 v8, -1
v_mov_b32 v9, -1
v_mov_b32 v10, -1
v_mov_b32 v11, -1
buffer_store_dwordx4 v[8:11], v4, s[4:7], s51 offen sc1
GW_NOP:
s_waitcnt vmcnt(0) lgkmcnt(0)
s_barrier
s_lshl_b32 s36, s39, 4
v_mov_b32 v11, s36
v_cmp_eq_u32 vcc, 0, v0
s_nop 0
s_and_saveexec_b64 s[34:35], vcc
s_cbranch_execz ARR_1
v_mov_b32 v10, 1
buffer_atomic_add v10, v11, s[8:11], s37 offen offset:128 sc1
ARR_1:
s_mov_b64 exec, s[34:35]
s_mov_b32 s57, s48
s_cmp_ge_u32 s48, 128
s_cbranch_scc1 GW_NOLN
v_and_b32 v75, 15, v1
v_mul_u32_u24 v76, 1280, v75
v_lshl_add_u32 v76, v3, 4, v76
s_mul_i32 s51, s57, 20480
s_mul_i32 s52, s49, 320
s_add_u32 s51, s51, s52
buffer_load_dwordx4 v[4:7], v76, s[12:15], s51 offen offset:0
buffer_load_dwordx4 v[8:11], v76, s[12:15], s51 offen offset:64
buffer_load_dwordx4 v[12:15], v76, s[12:15], s51 offen offset:128
buffer_load_dwordx4 v[16:19], v76, s[12:15], s51 offen offset:192
buffer_load_dwordx4 v[20:23], v76, s[12:15], s51 offen offset:256
v_lshlrev_b32 v75, 4, v75
s_lshl_b32 s53, s49, 2
v_add_u32 v74, s53, v75
s_waitcnt vmcnt(0) lgkmcnt(0)
v_and_b32 v25, 0xffff0000, v4
v_lshlrev_b32 v24, 16, v4
v_and_b32 v27, 0xffff0000, v5
v_lshlrev_b32 v26, 16, v5
v_and_b32 v29, 0xffff0000, v6
v_lshlrev_b32 v28, 16, v6
v_and_b32 v31, 0xffff0000, v7
v_lshlrev_b32 v30, 16, v7
v_and_b32 v33, 0xffff0000, v8
v_lshlrev_b32 v32, 16, v8
v_and_b32 v35, 0xffff0000, v9
v_lshlrev_b32 v34, 16, v9
v_and_b32 v37, 0xffff0000, v10
v_lshlrev_b32 v36, 16, v10
v_and_b32 v39, 0xffff0000, v11
v_lshlrev_b32 v38, 16, v11
v_and_b32 v41, 0xffff0000, v12
v_lshlrev_b32 v40, 16, v12
v_and_b32 v43, 0xffff0000, v13
v_lshlrev_b32 v42, 16, v13
v_and_b32 v45, 0xffff0000, v14
v_lshlrev_b32 v44, 16, v14
v_and_b32 v47, 0xffff0000, v15
v_lshlrev_b32 v46, 16, v15
v_and_b32 v49, 0xffff0000, v16
v_lshlrev_b32 v48, 16, v16
v_and_b32 v51, 0xffff0000, v17
v_lshlrev_b32 v50, 16, v17
v_and_b32 v53, 0xffff0000, v18
v_lshlrev_b32 v52, 16, v18
v_and_b32 v55, 0xffff0000, v19
v_lshlrev_b32 v54, 16, v19
v_and_b32 v57, 0xffff0000, v20
v_lshlrev_b32 v56, 16, v20
v_and_b32 v59, 0xffff0000, v21
v_lshlrev_b32 v58, 16, v21
v_and_b32 v61, 0xffff0000, v22
v_lshlrev_b32 v60, 16, v22
v_and_b32 v63, 0xffff0000, v23
v_lshlrev_b32 v62, 16, v23
v_pk_add_f32 v[64:65], v[24:25], v[26:27]
v_pk_add_f32 v[64:65], v[64:65], v[28:29]
v_pk_add_f32 v[64:65], v[64:65], v[30:31]
v_pk_add_f32 v[64:65], v[64:65], v[32:33]
v_pk_add_f32 v[64:65], v[64:65], v[34:35]
v_pk_add_f32 v[64:65], v[64:65], v[36:37]
v_pk_add_f32 v[64:65], v[64:65], v[38:39]
v_pk_add_f32 v[64:65], v[64:65], v[40:41]
v_pk_add_f32 v[64:65], v[64:65], v[42:43]
v_pk_add_f32 v[64:65], v[64:65], v[44:45]
v_pk_add_f32 v[64:65], v[64:65], v[46:47]
v_pk_add_f32 v[64:65], v[64:65], v[48:49]
v_pk_add_f32 v[64:65], v[64:65], v[50:51]
v_pk_add_f32 v[64:65], v[64:65], v[52:53]
v_pk_add_f32 v[64:65], v[64:65], v[54:55]
v_pk_add_f32 v[64:65], v[64:65], v[56:57]
v_pk_add_f32 v[64:65], v[64:65], v[58:59]
v_pk_add_f32 v[64:65], v[64:65], v[60:61]
v_pk_add_f32 v[64:65], v[64:65], v[62:63]
v_add_f32 v64, v64, v65
v_mov_b32 v65, v64
s_nop 1
v_permlane32_swap_b32 v64, v65
v_add_f32 v64, v64, v65
v_mov_b32 v65, v64
s_nop 1
v_permlane16_swap_b32 v64, v65
v_add_f32 v64, v64, v65
ds_write_b32 v74, v64 offset:0
s_waitcnt lgkmcnt(0)
s_barrier
ds_read_b128 v[66:69], v75 offset:0
s_waitcnt lgkmcnt(0)
v_add_f32 v64, v66, v67
v_add_f32 v68, v68, v69
v_add_f32 v64, v64, v68
v_mul_f32 v70, 0xbacccccd, v64
v_mov_b32 v71, v70
v_pk_add_f32 v[24:25], v[24:25], v[70:71]
v_pk_add_f32 v[26:27], v[26:27], v[70:71]
v_pk_add_f32 v[28:29], v[28:29], v[70:71]
v_pk_add_f32 v[30:31], v[30:31], v[70:71]
v_pk_add_f32 v[32:33], v[32:33], v[70:71]
v_pk_add_f32 v[34:35], v[34:35], v[70:71]
v_pk_add_f32 v[36:37], v[36:37], v[70:71]
v_pk_add_f32 v[38:39], v[38:39], v[70:71]
v_pk_add_f32 v[40:41], v[40:41], v[70:71]
v_pk_add_f32 v[42:43], v[42:43], v[70:71]
v_pk_add_f32 v[44:45], v[44:45], v[70:71]
v_pk_add_f32 v[46:47], v[46:47], v[70:71]
v_pk_add_f32 v[48:49], v[48:49], v[70:71]
v_pk_add_f32 v[50:51], v[50:51], v[70:71]
v_pk_add_f32 v[52:53], v[52:53], v[70:71]
v_pk_add_f32 v[54:55], v[54:55], v[70:71]
v_pk_add_f32 v[56:57], v[56:57], v[70:71]
v_pk_add_f32 v[58:59], v[58:59], v[70:71]
v_pk_add_f32 v[60:61], v[60:61], v[70:71]
v_pk_add_f32 v[62:63], v[62:63], v[70:71]
v_pk_mul_f32 v[64:65], v[24:25], v[24:25]
v_pk_fma_f32 v[64:65], v[26:27], v[26:27], v[64:65]
v_pk_fma_f32 v[64:65], v[28:29], v[28:29], v[64:65]
v_pk_fma_f32 v[64:65], v[30:31], v[30:31], v[64:65]
v_pk_fma_f32 v[64:65], v[32:33], v[32:33], v[64:65]
v_pk_fma_f32 v[64:65], v[34:35], v[34:35], v[64:65]
v_pk_fma_f32 v[64:65], v[36:37], v[36:37], v[64:65]
v_pk_fma_f32 v[64:65], v[38:39], v[38:39], v[64:65]
v_pk_fma_f32 v[64:65], v[40:41], v[40:41], v[64:65]
v_pk_fma_f32 v[64:65], v[42:43], v[42:43], v[64:65]
v_pk_fma_f32 v[64:65], v[44:45], v[44:45], v[64:65]
v_pk_fma_f32 v[64:65], v[46:47], v[46:47], v[64:65]
v_pk_fma_f32 v[64:65], v[48:49], v[48:49], v[64:65]
v_pk_fma_f32 v[64:65], v[50:51], v[50:51], v[64:65]
v_pk_fma_f32 v[64:65], v[52:53], v[52:53], v[64:65]
v_pk_fma_f32 v[64:65], v[54:55], v[54:55], v[64:65]
v_pk_fma_f32 v[64:65], v[56:57], v[56:57], v[64:65]
v_pk_fma_f32 v[64:65], v[58:59], v[58:59], v[64:65]
v_pk_fma_f32 v[64:65], v[60:61], v[60:61], v[64:65]
v_pk_fma_f32 v[64:65], v[62:63], v[62:63], v[64:65]
v_add_f32 v64, v64, v65
v_mov_b32 v65, v64
s_nop 1
v_permlane32_swap_b32 v64, v65
v_add_f32 v64, v64, v65
v_mov_b32 v65, v64
s_nop 1
v_permlane16_swap_b32 v64, v65
v_add_f32 v64, v64, v65
ds_write_b32 v74, v64 offset:256
s_waitcnt lgkmcnt(0)
s_barrier
ds_read_b128 v[66:69], v75 offset:256
s_waitcnt lgkmcnt(0)
v_add_f32 v64, v66, v67
v_add_f32 v68, v68, v69
v_add_f32 v64, v64, v68
v_mul_f32 v64, 0x3acccccd, v64
v_cvt_pk_bf16_f32 v64, v64, v64
v_and_b32 v64, 0xffff0000, v64
v_add_f32 v64, 0x3727c5ac, v64
v_cvt_pk_bf16_f32 v64, v64, v64
v_and_b32 v64, 0xffff0000, v64
v_sqrt_f32 v64, v64
v_cvt_pk_bf16_f32 v65, v70, v70
v_and_b32 v65, 0xffff0000, v65
v_cvt_pk_bf16_f32 v64, v64, v64
v_and_b32 v64, 0xffff0000, v64
v_rcp_f32 v72, v64
v_sub_f32 v65, v65, v70
v_mov_b32 v73, v72
v_mul_f32 v70, v65, v72
v_mov_b32 v71, v70
v_pk_fma_f32 v[24:25], v[24:25], v[72:73], v[70:71]
v_pk_fma_f32 v[26:27], v[26:27], v[72:73], v[70:71]
v_pk_fma_f32 v[28:29], v[28:29], v[72:73], v[70:71]
v_pk_fma_f32 v[30:31], v[30:31], v[72:73], v[70:71]
v_pk_fma_f32 v[32:33], v[32:33], v[72:73], v[70:71]
v_pk_fma_f32 v[34:35], v[34:35], v[72:73], v[70:71]
v_pk_fma_f32 v[36:37], v[36:37], v[72:73], v[70:71]
v_pk_fma_f32 v[38:39], v[38:39], v[72:73], v[70:71]
v_pk_fma_f32 v[40:41], v[40:41], v[72:73], v[70:71]
v_pk_fma_f32 v[42:43], v[42:43], v[72:73], v[70:71]
v_pk_fma_f32 v[44:45], v[44:45], v[72:73], v[70:71]
v_pk_fma_f32 v[46:47], v[46:47], v[72:73], v[70:71]
v_pk_fma_f32 v[48:49], v[48:49], v[72:73], v[70:71]
v_pk_fma_f32 v[50:51], v[50:51], v[72:73], v[70:71]
v_pk_fma_f32 v[52:53], v[52:53], v[72:73], v[70:71]
v_pk_fma_f32 v[54:55], v[54:55], v[72:73], v[70:71]
v_pk_fma_f32 v[56:57], v[56:57], v[72:73], v[70:71]
v_pk_fma_f32 v[58:59], v[58:59], v[72:73], v[70:71]
v_pk_fma_f32 v[60:61], v[60:61], v[72:73], v[70:71]
v_pk_fma_f32 v[62:63], v[62:63], v[72:73], v[70:71]
s_mul_i32 s51, s57, 20480
s_mul_i32 s52, s49, 5120
s_add_u32 s51, s51, s52
s_mul_i32 s52, s50, 2621440
s_add_u32 s51, s51, s52
s_add_u32 s51, s51, 134217728
s_add_u32 s52, s51, 4096
v_cvt_pk_bf16_f32 v4, v24, v25
v_cvt_pk_bf16_f32 v5, v26, v27
v_cvt_pk_bf16_f32 v6, v28, v29
v_cvt_pk_bf16_f32 v7, v30, v31
buffer_store_dwordx4 v[4:7], v2, s[4:7], s51 offen offset:0 sc1
v_cvt_pk_bf16_f32 v8, v32, v33
v_cvt_pk_bf16_f32 v9, v34, v35
v_cvt_pk_bf16_f32 v10, v36, v37
v_cvt_pk_bf16_f32 v11, v38, v39
buffer_store_dwordx4 v[8:11], v2, s[4:7], s51 offen offset:1024 sc1
v_cvt_pk_bf16_f32 v12, v40, v41
v_cvt_pk_bf16_f32 v13, v42, v43
v_cvt_pk_bf16_f32 v14, v44, v45
v_cvt_pk_bf16_f32 v15, v46, v47
buffer_store_dwordx4 v[12:15], v2, s[4:7], s51 offen offset:2048 sc1
v_cvt_pk_bf16_f32 v16, v48, v49
v_cvt_pk_bf16_f32 v17, v50, v51
v_cvt_pk_bf16_f32 v18, v52, v53
v_cvt_pk_bf16_f32 v19, v54, v55
buffer_store_dwordx4 v[16:19], v2, s[4:7], s51 offen offset:3072 sc1
v_cvt_pk_bf16_f32 v20, v56, v57
v_cvt_pk_bf16_f32 v21, v58, v59
v_cvt_pk_bf16_f32 v22, v60, v61
v_cvt_pk_bf16_f32 v23, v62, v63
buffer_store_dwordx4 v[20:23], v2, s[4:7], s52 offen offset:0 sc1
v_and_b32 v11, 7, v0
v_lshlrev_b32 v11, 4, v11
s_mov_b32 s69, 0
WST_2:
buffer_load_dword v10, v11, s[8:11], s37 offen offset:128 sc1
buffer_load_dword v11, off, s[8:11], 0 offset:132 sc1
s_add_u32 s69, s69, 1
s_cmp_gt_u32 s69, 131072
s_cbranch_scc1 ABORT
s_waitcnt vmcnt(0)
v_cmp_gt_u32 vcc, 32, v10
s_cbranch_vccz WSTOK_3
v_readfirstlane_b32 s36, v11
v_and_b32 v11, 7, v0
v_lshlrev_b32 v11, 4, v11
s_sub_u32 s35, s37, 1
s_cselect_b32 s36, s36, 0
s_cmp_lg_u32 s36, 0
s_cbranch_scc1 FALLBACK
s_sleep 2
s_branch WST_2
WSTOK_3:
s_lshl_b32 s51, s50, 9
s_lshl_b32 s52, s57, 2
s_add_u32 s51, s51, s52
s_add_u32 s51, s51, 5120
s_waitcnt vmcnt(0) lgkmcnt(0)
s_barrier
s_cmp_lg_u32 s49, 0
s_cbranch_scc1 PUB_4
v_mov_b32 v4, 0
v_mov_b32 v5, 1
buffer_store_dword v5, v4, s[4:7], s51 offen sc1
PUB_4:
s_barrier
GW_NOLN:
s_load_dwordx2 s[54:55], s[0:1], 24
s_load_dwordx2 s[16:17], s[0:1], 16
s_load_dwordx2 s[64:65], s[0:1], 32
s_mov_b32 s18, 5242880
s_mov_b32 s19, 0x20000
s_lshr_b32 s72, s48, 6
s_waitcnt lgkmcnt(0)
s_cmp_eq_u32 s72, 1
s_cselect_b64 s[16:17], s[54:55], s[16:17]
s_cmp_eq_u32 s72, 2
s_cselect_b64 s[16:17], s[64:65], s[16:17]
s_and_b32 s51, s48, 63
s_lshl_b32 s51, s51, 7
v_lshrrev_b32 v4, 3, v1
s_mov_b32 s53, 8192
v_mul_lo_u32 v4, v4, s53
v_and_b32 v5, 7, v1
v_lshl_add_u32 v4, v5, 4, v4
s_mul_i32 s53, s49, 65536
s_add_u32 s53, s53, s51
s_lshl_b32 s54, s49, 10
s_add_u32 m0, s54, 0
s_nop 0
buffer_load_dwordx4 v4, s[16:19], s53 offen lds
s_add_u32 m0, s54, 4096
s_add_u32 s53, s53, 262144
buffer_load_dwordx4 v4, s[16:19], s53 offen lds
s_add_u32 m0, s54, 8192
s_add_u32 s53, s53, 262144
buffer_load_dwordx4 v4, s[16:19], s53 offen lds
s_add_u32 m0, s54, 12288
s_add_u32 s53, s53, 262144
buffer_load_dwordx4 v4, s[16:19], s53 offen lds
s_add_u32 m0, s54, 16384
s_add_u32 s53, s53, 262144
buffer_load_dwordx4 v4, s[16:19], s53 offen lds
s_add_u32 m0, s54, 20480
s_add_u32 s53, s53, 262144
buffer_load_dwordx4 v4, s[16:19], s53 offen lds
s_add_u32 m0, s54, 24576
s_add_u32 s53, s53, 262144
buffer_load_dwordx4 v4, s[16:19], s53 offen lds
s_add_u32 m0, s54, 28672
s_add_u32 s53, s53, 262144
buffer_load_dwordx4 v4, s[16:19], s53 offen lds
s_add_u32 m0, s54, 32768
s_add_u32 s53, s53, 262144
buffer_load_dwordx4 v4, s[16:19], s53 offen lds
s_add_u32 m0, s54, 36864
s_add_u32 s53, s53, 262144
buffer_load_dwordx4 v4, s[16:19], s53 offen lds
s_add_u32 m0, s54, 40960
s_add_u32 s53, s53, 262144
buffer_load_dwordx4 v4, s[16:19], s53 offen lds
s_add_u32 m0, s54, 45056
s_add_u32 s53, s53, 262144
buffer_load_dwordx4 v4, s[16:19], s53 offen lds
s_add_u32 m0, s54, 49152
s_add_u32 s53, s53, 262144
buffer_load_dwordx4 v4, s[16:19], s53 offen lds
s_add_u32 m0, s54, 53248
s_add_u32 s53, s53, 262144
buffer_load_dwordx4 v4, s[16:19], s53 offen lds
s_add_u32 m0, s54, 57344
s_add_u32 s53, s53, 262144
buffer_load_dwordx4 v4, s[16:19], s53 offen lds
s_add_u32 m0, s54, 61440
s_add_u32 s53, s53, 262144
buffer_load_dwordx4 v4, s[16:19], s53 offen lds
s_add_u32 m0, s54, 65536
s_add_u32 s53, s53, 262144
buffer_load_dwordx4 v4, s[16:19], s53 offen lds
s_add_u32 m0, s54, 69632
s_add_u32 s53, s53, 262144
buffer_load_dwordx4 v4, s[16:19], s53 offen lds
s_add_u32 m0, s54, 73728
s_add_u32 s53, s53, 262144
buffer_load_dwordx4 v4, s[16:19], s53 offen lds
s_add_u32 m0, s54, 77824
s_add_u32 s53, s53, 262144
buffer_load_dwordx4 v4, s[16:19], s53 offen lds
s_waitcnt vmcnt(0) lgkmcnt(0)
s_barrier
v_bfe_u32 v6, v1, 2, 2
v_lshl_add_u32 v6, v3, 3, v6
v_lshlrev_b32 v6, 7, v6
v_and_b32 v7, 3, v1
v_lshl_add_u32 v6, v7, 3, v6
s_and_b32 s51, s49, 1
s_lshl_b32 s51, s51, 6
v_add_u32 v6, s51, v6
v_add_u32 v7, 40960, v6
ds_read_b64_tr_b16 a[96:97], v6 offset:0
ds_read_b64_tr_b16 a[98:99], v6 offset:512
ds_read_b64_tr_b16 a[100:101], v6 offset:32
ds_read_b64_tr_b16 a[102:103], v6 offset:544
ds_read_b64_tr_b16 a[104:105], v6 offset:4096
ds_read_b64_tr_b16 a[106:107], v6 offset:4608
ds_read_b64_tr_b16 a[108:109], v6 offset:4128
ds_read_b64_tr_b16 a[110:111], v6 offset:4640
ds_read_b64_tr_b16 a[112:113], v6 offset:8192
ds_read_b64_tr_b16 a[114:115], v6 offset:8704
ds_read_b64_tr_b16 a[116:117], v6 offset:8224
ds_read_b64_tr_b16 a[118:119], v6 offset:8736
s_waitcnt lgkmcnt(0)
ds_read_b64_tr_b16 a[120:121], v6 offset:12288
ds_read_b64_tr_b16 a[122:123], v6 offset:12800
ds_read_b64_tr_b16 a[124:125], v6 offset:12320
ds_read_b64_tr_b16 a[126:127], v6 offset:12832
ds_read_b64_tr_b16 a[128:129], v6 offset:16384
ds_read_b64_tr_b16 a[130:131], v6 offset:16896
ds_read_b64_tr_b16 a[132:133], v6 offset:16416
ds_read_b64_tr_b16 a[134:135], v6 offset:16928
ds_read_b64_tr_b16 a[136:137], v6 offset:20480
ds_read_b64_tr_b16 a[138:139], v6 offset:20992
ds_read_b64_tr_b16 a[140:141], v6 offset:20512
ds_read_b64_tr_b16 a[142:143], v6 offset:21024
s_waitcnt lgkmcnt(0)
ds_read_b64_tr_b16 a[144:145], v6 offset:24576
ds_read_b64_tr_b16 a[146:147], v6 offset:25088
ds_read_b64_tr_b16 a[148:149], v6 offset:24608
ds_read_b64_tr_b16 a[150:151], v6 offset:25120
ds_read_b64_tr_b16 a[152:153], v6 offset:28672
ds_read_b64_tr_b16 a[154:155], v6 offset:29184
ds_read_b64_tr_b16 a[156:157], v6 offset:28704
ds_read_b64_tr_b16 a[158:159], v6 offset:29216
ds_read_b64_tr_b16 a[160:161], v6 offset:32768
ds_read_b64_tr_b16 a[162:163], v6 offset:33280
ds_read_b64_tr_b16 a[164:165], v6 offset:32800
ds_read_b64_tr_b16 a[166:167], v6 offset:33312
s_waitcnt lgkmcnt(0)
ds_read_b64_tr_b16 a[168:169], v6 offset:36864
ds_read_b64_tr_b16 a[170:171], v6 offset:37376
ds_read_b64_tr_b16 a[172:173], v6 offset:36896
ds_read_b64_tr_b16 a[174:175], v6 offset:37408
ds_read_b64_tr_b16 a[176:177], v7 offset:0
ds_read_b64_tr_b16 a[178:179], v7 offset:512
ds_read_b64_tr_b16 a[180:181], v7 offset:32
ds_read_b64_tr_b16 a[182:183], v7 offset:544
ds_read_b64_tr_b16 a[184:185], v7 offset:4096
ds_read_b64_tr_b16 a[186:187], v7 offset:4608
ds_read_b64_tr_b16 a[188:189], v7 offset:4128
ds_read_b64_tr_b16 a[190:191], v7 offset:4640
s_waitcnt lgkmcnt(0)
ds_read_b64_tr_b16 a[192:193], v7 offset:8192
ds_read_b64_tr_b16 a[194:195], v7 offset:8704
ds_read_b64_tr_b16 a[196:197], v7 offset:8224
ds_read_b64_tr_b16 a[198:199], v7 offset:8736
ds_read_b64_tr_b16 a[200:201], v7 offset:12288
ds_read_b64_tr_b16 a[202:203], v7 offset:12800
ds_read_b64_tr_b16 a[204:205], v7 offset:12320
ds_read_b64_tr_b16 a[206:207], v7 offset:12832
ds_read_b64_tr_b16 a[208:209], v7 offset:16384
ds_read_b64_tr_b16 a[210:211], v7 offset:16896
ds_read_b64_tr_b16 a[212:213], v7 offset:16416
ds_read_b64_tr_b16 a[214:215], v7 offset:16928
s_waitcnt lgkmcnt(0)
ds_read_b64_tr_b16 a[216:217], v7 offset:20480
ds_read_b64_tr_b16 a[218:219], v7 offset:20992
ds_read_b64_tr_b16 a[220:221], v7 offset:20512
ds_read_b64_tr_b16 a[222:223], v7 offset:21024
ds_read_b64_tr_b16 a[224:225], v7 offset:24576
ds_read_b64_tr_b16 a[226:227], v7 offset:25088
ds_read_b64_tr_b16 a[228:229], v7 offset:24608
ds_read_b64_tr_b16 a[230:231], v7 offset:25120
ds_read_b64_tr_b16 a[232:233], v7 offset:28672
ds_read_b64_tr_b16 a[234:235], v7 offset:29184
ds_read_b64_tr_b16 a[236:237], v7 offset:28704
ds_read_b64_tr_b16 a[238:239], v7 offset:29216
s_waitcnt lgkmcnt(0)
ds_read_b64_tr_b16 a[240:241], v7 offset:32768
ds_read_b64_tr_b16 a[242:243], v7 offset:33280
ds_read_b64_tr_b16 a[244:245], v7 offset:32800
ds_read_b64_tr_b16 a[246:247], v7 offset:33312
ds_read_b64_tr_b16 a[248:249], v7 offset:36864
ds_read_b64_tr_b16 a[250:251], v7 offset:37376
ds_read_b64_tr_b16 a[252:253], v7 offset:36896
ds_read_b64_tr_b16 a[254:255], v7 offset:37408
s_waitcnt vmcnt(0) lgkmcnt(0)
s_barrier
v_and_b32 v11, 7, v0
v_lshlrev_b32 v11, 4, v11
s_mov_b32 s69, 0
WST_5:
buffer_load_dword v10, v11, s[8:11], s37 offen offset:128 sc1
buffer_load_dword v11, off, s[8:11], 0 offset:132 sc1
s_add_u32 s69, s69, 1
s_cmp_gt_u32 s69, 131072
s_cbranch_scc1 ABORT
s_waitcnt vmcnt(0)
v_cmp_gt_u32 vcc, 32, v10
s_cbranch_vccz WSTOK_6
v_readfirstlane_b32 s36, v11
v_and_b32 v11, 7, v0
v_lshlrev_b32 v11, 4, v11
s_sub_u32 s35, s37, 1
s_cselect_b32 s36, s36, 0
s_cmp_lg_u32 s36, 0
s_cbranch_scc1 FALLBACK
s_sleep 2
s_branch WST_5
WSTOK_6:
GW_LAYER:
s_lshr_b32 s51, s49, 1
s_mul_i32 s51, s51, 40960
v_add_u32 v62, s51, v2
v_add_u32 v63, 81920, v62
s_mul_i32 s61, s50, 2621440
s_mul_i32 s51, s49, 20480
s_add_u32 s61, s61, s51
s_add_u32 s61, s61, 134217728
s_lshl_b32 s62, s72, 25
s_add_u32 s62, s62, 33554432
s_lshl_b32 s51, s50, 24
s_add_u32 s62, s62, s51
s_lshr_b32 s51, s49, 1
s_lshl_b32 s51, s51, 18
s_add_u32 s62, s62, s51
s_bfe_u32 s51, s48, 0x50001
s_lshl_b32 s52, s51, 13
s_add_u32 s62, s62, s52
s_lshl_b32 s63, s51, 7
s_and_b32 s51, s48, 1
s_lshl_b32 s52, s72, 1
s_add_u32 s52, s52, s51
s_lshl_b32 s52, s52, 2
s_add_u32 s63, s63, s52
s_add_u32 s63, s63, 0
s_lshl_b32 s51, s51, 1
s_and_b32 s52, s49, 1
s_add_u32 s51, s51, s52
s_cmp_eq_u32 s72, 2
s_cselect_b32 s52, 11, 10
s_movk_i32 s64, 4096
s_cselect_b32 s64, 1024, s64
s_lshl_b32 s51, s51, s52
s_add_u32 s62, s62, s51
s_add_u32 s68, s62, s64
s_cmp_eq_u32 s50, 0
s_movk_i32 s60, 14336
s_cselect_b32 s60, 5120, s60
s_cselect_b32 s75, 3, 9
s_lshl_b32 s58, s50, 6
s_mul_i32 s70, s49, 20480
s_cmp_lg_u32 s49, 0
s_cbranch_scc1 WFOK_9
v_min_u32 v60, s75, v1
v_lshlrev_b32 v60, 2, v60
s_mov_b32 s69, 0
WF_8:
buffer_load_dword v61, v60, s[4:7], s60 offen sc1
s_add_u32 s69, s69, 1
s_cmp_gt_u32 s69, 131072
s_cbranch_scc1 ABORT
s_waitcnt vmcnt(0)
v_cmp_gt_u32 vcc, 1, v61
s_cbranch_vccz WFOK_9
s_sleep 2
s_branch WF_8
WFOK_9:
s_barrier
QKVS_7:
s_cmp_eq_u32 s50, 0
s_cselect_b32 s51, 16, 0
s_add_u32 s60, s60, s51
s_add_u32 m0, s70, 0
s_add_u32 s51, s61, 0
buffer_load_dwordx4 v2, s[4:7], s51 offen offset:0 sc1 lds
buffer_load_dwordx4 v2, s[4:7], s51 offen offset:1024 sc1 lds
buffer_load_dwordx4 v2, s[4:7], s51 offen offset:2048 sc1 lds
buffer_load_dwordx4 v2, s[4:7], s51 offen offset:3072 sc1 lds
s_add_u32 m0, s70, 4096
s_add_u32 s51, s61, 4096
buffer_load_dwordx4 v2, s[4:7], s51 offen offset:0 sc1 lds
buffer_load_dwordx4 v2, s[4:7], s51 offen offset:1024 sc1 lds
buffer_load_dwordx4 v2, s[4:7], s51 offen offset:2048 sc1 lds
buffer_load_dwordx4 v2, s[4:7], s51 offen offset:3072 sc1 lds
s_add_u32 m0, s70, 8192
s_add_u32 s51, s61, 8192
buffer_load_dwordx4 v2, s[4:7], s51 offen offset:0 sc1 lds
buffer_load_dwordx4 v2, s[4:7], s51 offen offset:1024 sc1 lds
buffer_load_dwordx4 v2, s[4:7], s51 offen offset:2048 sc1 lds
buffer_load_dwordx4 v2, s[4:7], s51 offen offset:3072 sc1 lds
s_add_u32 m0, s70, 12288
s_add_u32 s51, s61, 12288
buffer_load_dwordx4 v2, s[4:7], s51 offen offset:0 sc1 lds
buffer_load_dwordx4 v2, s[4:7], s51 offen offset:1024 sc1 lds
buffer_load_dwordx4 v2, s[4:7], s51 offen offset:2048 sc1 lds
buffer_load_dwordx4 v2, s[4:7], s51 offen offset:3072 sc1 lds
s_add_u32 m0, s70, 16384
s_add_u32 s51, s61, 16384
buffer_load_dwordx4 v2, s[4:7], s51 offen offset:0 sc1 lds
buffer_load_dwordx4 v2, s[4:7], s51 offen offset:1024 sc1 lds
buffer_load_dwordx4 v2, s[4:7], s51 offen offset:2048 sc1 lds
buffer_load_dwordx4 v2, s[4:7], s51 offen offset:3072 sc1 lds
s_add_u32 s61, s61, 81920
s_mov_b32 s57, 0
QKV_LOOP:
s_waitcnt vmcnt(0) lgkmcnt(0)
s_barrier
s_cmp_lg_u32 s49, 0
s_cbranch_scc1 QKVP_10
v_mov_b32 v60, 0
v_mov_b32 v61, s58
buffer_store_dword v61, v60, s[4:7], s63 offen sc1
QKVP_10:
s_cmp_lg_u32 s50, 0
s_cbranch_scc1 QKVS_12
s_cmp_lg_u32 s49, 0
s_cbranch_scc1 WFOK_14
v_min_u32 v60, s75, v1
v_lshlrev_b32 v60, 2, v60
s_mov_b32 s69, 0
WF_13:
buffer_load_dword v61, v60, s[4:7], s60 offen sc1
s_add_u32 s69, s69, 1
s_cmp_gt_u32 s69, 131072
s_cbranch_scc1 ABORT
s_waitcnt vmcnt(0)
v_cmp_gt_u32 vcc, 1, v61
s_cbranch_vccz WFOK_14
s_sleep 2
s_branch WF_13
WFOK_14:
s_barrier
QKVS_12:
s_cmp_eq_u32 s50, 0
s_cselect_b32 s51, 16, 64
s_add_u32 s60, s60, s51
s_add_u32 m0, s70, 81920
s_add_u32 s51, s61, 0
buffer_load_dwordx4 v2, s[4:7], s51 offen offset:0 sc1 lds
buffer_load_dwordx4 v2, s[4:7], s51 offen offset:1024 sc1 lds
buffer_load_dwordx4 v2, s[4:7], s51 offen offset:2048 sc1 lds
buffer_load_dwordx4 v2, s[4:7], s51 offen offset:3072 sc1 lds
s_add_u32 m0, s70, 86016
s_add_u32 s51, s61, 4096
buffer_load_dwordx4 v2, s[4:7], s51 offen offset:0 sc1 lds
buffer_load_dwordx4 v2, s[4:7], s51 offen offset:1024 sc1 lds
buffer_load_dwordx4 v2, s[4:7], s51 offen offset:2048 sc1 lds
buffer_load_dwordx4 v2, s[4:7], s51 offen offset:3072 sc1 lds
s_add_u32 m0, s70, 90112
s_add_u32 s51, s61, 8192
buffer_load_dwordx4 v2, s[4:7], s51 offen offset:0 sc1 lds
buffer_load_dwordx4 v2, s[4:7], s51 offen offset:1024 sc1 lds
buffer_load_dwordx4 v2, s[4:7], s51 offen offset:2048 sc1 lds
buffer_load_dwordx4 v2, s[4:7], s51 offen offset:3072 sc1 lds
s_add_u32 m0, s70, 94208
s_add_u32 s51, s61, 12288
buffer_load_dwordx4 v2, s[4:7], s51 offen offset:0 sc1 lds
buffer_load_dwordx4 v2, s[4:7], s51 offen offset:1024 sc1 lds
buffer_load_dwordx4 v2, s[4:7], s51 offen offset:2048 sc1 lds
buffer_load_dwordx4 v2, s[4:7], s51 offen offset:3072 sc1 lds
s_add_u32 m0, s70, 98304
s_add_u32 s51, s61, 16384
buffer_load_dwordx4 v2, s[4:7], s51 offen offset:0 sc1 lds
buffer_load_dwordx4 v2, s[4:7], s51 offen offset:1024 sc1 lds
buffer_load_dwordx4 v2, s[4:7], s51 offen offset:2048 sc1 lds
buffer_load_dwordx4 v2, s[4:7], s51 offen offset:3072 sc1 lds
s_add_u32 s61, s61, 81920
QKVN_11:
s_cmp_eq_u32 s72, 2
s_cbranch_scc1 QKVV_15
ds_read_b128 v[20:23], v62 offset:0
ds_read_b128 v[24:27], v62 offset:20480
ds_read_b128 v[28:31], v62 offset:1024
ds_read_b128 v[32:35], v62 offset:21504
ds_read_b128 v[36:39], v62 offset:2048
ds_read_b128 v[40:43], v62 offset:22528
ds_read_b128 v[44:47], v62 offset:3072
ds_read_b128 v[48:51], v62 offset:23552
s_waitcnt lgkmcnt(7)
v_mfma_f32_16x16x32_bf16 v[4:7], a[96:99], v[20:23], 0
v_mfma_f32_16x16x32_bf16 v[12:15], a[100:103], v[20:23], 0
ds_read_b128 v[20:23], v62 offset:4096
s_waitcnt lgkmcnt(7)
v_mfma_f32_16x16x32_bf16 v[8:11], a[96:99], v[24:27], 0
v_mfma_f32_16x16x32_bf16 v[16:19], a[100:103], v[24:27], 0
ds_read_b128 v[24:27], v62 offset:24576
s_waitcnt lgkmcnt(7)
v_mfma_f32_16x16x32_bf16 v[4:7], a[104:107], v[28:31], v[4:7]
v_mfma_f32_16x16x32_bf16 v[12:15], a[108:111], v[28:31], v[12:15]
ds_read_b128 v[28:31], v62 offset:5120
s_waitcnt lgkmcnt(7)
v_mfma_f32_16x16x32_bf16 v[8:11], a[104:107], v[32:35], v[8:11]
v_mfma_f32_16x16x32_bf16 v[16:19], a[108:111], v[32:35], v[16:19]
ds_read_b128 v[32:35], v62 offset:25600
s_waitcnt lgkmcnt(7)
v_mfma_f32_16x16x32_bf16 v[4:7], a[112:115], v[36:39], v[4:7]
v_mfma_f32_16x16x32_bf16 v[12:15], a[116:119], v[36:39], v[12:15]
ds_read_b128 v[36:39], v62 offset:6144
s_waitcnt lgkmcnt(7)
v_mfma_f32_16x16x32_bf16 v[8:11], a[112:115], v[40:43], v[8:11]
v_mfma_f32_16x16x32_bf16 v[16:19], a[116:119], v[40:43], v[16:19]
ds_read_b128 v[40:43], v62 offset:26624
s_waitcnt lgkmcnt(7)
v_mfma_f32_16x16x32_bf16 v[4:7], a[120:123], v[44:47], v[4:7]
v_mfma_f32_16x16x32_bf16 v[12:15], a[124:127], v[44:47], v[12:15]
ds_read_b128 v[44:47], v62 offset:7168
s_waitcnt lgkmcnt(7)
v_mfma_f32_16x16x32_bf16 v[8:11], a[120:123], v[48:51], v[8:11]
v_mfma_f32_16x16x32_bf16 v[16:19], a[124:127], v[48:51], v[16:19]
ds_read_b128 v[48:51], v62 offset:27648
s_waitcnt lgkmcnt(7)
v_mfma_f32_16x16x32_bf16 v[4:7], a[128:131], v[20:23], v[4:7]
v_mfma_f32_16x16x32_bf16 v[12:15], a[132:135], v[20:23], v[12:15]
ds_read_b128 v[20:23], v62 offset:8192
s_waitcnt lgkmcnt(7)
v_mfma_f32_16x16x32_bf16 v[8:11], a[128:131], v[24:27], v[8:11]
v_mfma_f32_16x16x32_bf16 v[16:19], a[132:135], v[24:27], v[16:19]
ds_read_b128 v[24:27], v62 offset:28672
s_waitcnt lgkmcnt(7)
v_mfma_f32_16x16x32_bf16 v[4:7], a[136:139], v[28:31], v[4:7]
v_mfma_f32_16x16x32_bf16 v[12:15], a[140:143], v[28:31], v[12:15]
ds_read_b128 v[28:31], v62 offset:9216
s_waitcnt lgkmcnt(7)
v_mfma_f32_16x16x32_bf16 v[8:11], a[136:139], v[32:35], v[8:11]
v_mfma_f32_16x16x32_bf16 v[16:19], a[140:143], v[32:35], v[16:19]
ds_read_b128 v[32:35], v62 offset:29696
s_waitcnt lgkmcnt(7)
v_mfma_f32_16x16x32_bf16 v[4:7], a[144:147], v[36:39], v[4:7]
v_mfma_f32_16x16x32_bf16 v[12:15], a[148:151], v[36:39], v[12:15]
ds_read_b128 v[36:39], v62 offset:10240
s_waitcnt lgkmcnt(7)
v_mfma_f32_16x16x32_bf16 v[8:11], a[144:147], v[40:43], v[8:11]
v_mfma_f32_16x16x32_bf16 v[16:19], a[148:151], v[40:43], v[16:19]
ds_read_b128 v[40:43], v62 offset:30720
s_waitcnt lgkmcnt(7)
v_mfma_f32_16x16x32_bf16 v[4:7], a[152:155], v[44:47], v[4:7]
v_mfma_f32_16x16x32_bf16 v[12:15], a[156:159], v[44:47], v[12:15]
ds_read_b128 v[44:47], v62 offset:11264
s_waitcnt lgkmcnt(7)
v_mfma_f32_16x16x32_bf16 v[8:11], a[152:155], v[48:51], v[8:11]
v_mfma_f32_16x16x32_bf16 v[16:19], a[156:159], v[48:51], v[16:19]
ds_read_b128 v[48:51], v62 offset:31744
s_waitcnt lgkmcnt(7)
v_mfma_f32_16x16x32_bf16 v[4:7], a[160:163], v[20:23], v[4:7]
v_mfma_f32_16x16x32_bf16 v[12:15], a[164:167], v[20:23], v[12:15]
ds_read_b128 v[20:23], v62 offset:12288
s_waitcnt lgkmcnt(7)
v_mfma_f32_16x16x32_bf16 v[8:11], a[160:163], v[24:27], v[8:11]
v_mfma_f32_16x16x32_bf16 v[16:19], a[164:167], v[24:27], v[16:19]
ds_read_b128 v[24:27], v62 offset:32768
s_waitcnt lgkmcnt(7)
v_mfma_f32_16x16x32_bf16 v[4:7], a[168:171], v[28:31], v[4:7]
v_mfma_f32_16x16x32_bf16 v[12:15], a[172:175], v[28:31], v[12:15]
ds_read_b128 v[28:31], v62 offset:13312
s_waitcnt lgkmcnt(7)
v_mfma_f32_16x16x32_bf16 v[8:11], a[168:171], v[32:35], v[8:11]
v_mfma_f32_16x16x32_bf16 v[16:19], a[172:175], v[32:35], v[16:19]
ds_read_b128 v[32:35], v62 offset:33792
s_waitcnt lgkmcnt(7)
v_mfma_f32_16x16x32_bf16 v[4:7], a[176:179], v[36:39], v[4:7]
v_mfma_f32_16x16x32_bf16 v[12:15], a[180:183], v[36:39], v[12:15]
ds_read_b128 v[36:39], v62 offset:14336
s_waitcnt lgkmcnt(7)
v_mfma_f32_16x16x32_bf16 v[8:11], a[176:179], v[40:43], v[8:11]
v_mfma_f32_16x16x32_bf16 v[16:19], a[180:183], v[40:43], v[16:19]
ds_read_b128 v[40:43], v62 offset:34816
s_waitcnt lgkmcnt(7)
v_mfma_f32_16x16x32_bf16 v[4:7], a[184:187], v[44:47], v[4:7]
v_mfma_f32_16x16x32_bf16 v[12:15], a[188:191], v[44:47], v[12:15]
ds_read_b128 v[44:47], v62 offset:15360
s_waitcnt lgkmcnt(7)
v_mfma_f32_16x16x32_bf16 v[8:11], a[184:187], v[48:51], v[8:11]
v_mfma_f32_16x16x32_bf16 v[16:19], a[188:191], v[48:51], v[16:19]
ds_read_b128 v[48:51], v62 offset:35840
s_waitcnt lgkmcnt(7)
v_mfma_f32_16x16x32_bf16 v[4:7], a[192:195], v[20:23], v[4:7]
v_mfma_f32_16x16x32_bf16 v[12:15], a[196:199], v[20:23], v[12:15]
ds_read_b128 v[20:23], v62 offset:16384
s_waitcnt lgkmcnt(7)
v_mfma_f32_16x16x32_bf16 v[8:11], a[192:195], v[24:27], v[8:11]
v_mfma_f32_16x16x32_bf16 v[16:19], a[196:199], v[24:27], v[16:19]
ds_read_b128 v[24:27], v62 offset:36864
s_waitcnt lgkmcnt(7)
v_mfma_f32_16x16x32_bf16 v[4:7], a[200:203], v[28:31], v[4:7]
v_mfma_f32_16x16x32_bf16 v[12:15], a[204:207], v[28:31], v[12:15]
ds_read_b128 v[28:31], v62 offset:17408
s_waitcnt lgkmcnt(7)
v_mfma_f32_16x16x32_bf16 v[8:11], a[200:203], v[32:35], v[8:11]
v_mfma_f32_16x16x32_bf16 v[16:19], a[204:207], v[32:35], v[16:19]
ds_read_b128 v[32:35], v62 offset:37888
s_waitcnt lgkmcnt(7)
v_mfma_f32_16x16x32_bf16 v[4:7], a[208:211], v[36:39], v[4:7]
v_mfma_f32_16x16x32_bf16 v[12:15], a[212:215], v[36:39], v[12:15]
ds_read_b128 v[36:39], v62 offset:18432
s_waitcnt lgkmcnt(7)
v_mfma_f32_16x16x32_bf16 v[8:11], a[208:211], v[40:43], v[8:11]
v_mfma_f32_16x16x32_bf16 v[16:19], a[212:215], v[40:43], v[16:19]
ds_read_b128 v[40:43], v62 offset:38912
s_waitcnt lgkmcnt(7)
v_mfma_f32_16x16x32_bf16 v[4:7], a[216:219], v[44:47], v[4:7]
v_mfma_f32_16x16x32_bf16 v[12:15], a[220:223], v[44:47], v[12:15]
ds_read_b128 v[44:47], v62 offset:19456
s_waitcnt lgkmcnt(7)
v_mfma_f32_16x16x32_bf16 v[8:11], a[216:219], v[48:51], v[8:11]
v_mfma_f32_16x16x32_bf16 v[16:19], a[220:223], v[48:51], v[16:19]
ds_read_b128 v[48:51], v62 offset:39936
s_waitcnt lgkmcnt(7)
v_mfma_f32_16x16x32_bf16 v[4:7], a[224:227], v[20:23], v[4:7]
v_mfma_f32_16x16x32_bf16 v[12:15], a[228:231], v[20:23], v[12:15]
s_waitcnt lgkmcnt(6)
v_mfma_f32_16x16x32_bf16 v[8:11], a[224:227], v[24:27], v[8:11]
v_mfma_f32_16x16x32_bf16 v[16:19], a[228:231], v[24:27], v[16:19]
s_waitcnt lgkmcnt(5)
v_mfma_f32_16x16x32_bf16 v[4:7], a[232:235], v[28:31], v[4:7]
v_mfma_f32_16x16x32_bf16 v[12:15], a[236:239], v[28:31], v[12:15]
s_waitcnt lgkmcnt(4)
v_mfma_f32_16x16x32_bf16 v[8:11], a[232:235], v[32:35], v[8:11]
v_mfma_f32_16x16x32_bf16 v[16:19], a[236:239], v[32:35], v[16:19]
s_waitcnt lgkmcnt(3)
v_mfma_f32_16x16x32_bf16 v[4:7], a[240:243], v[36:39], v[4:7]
v_mfma_f32_16x16x32_bf16 v[12:15], a[244:247], v[36:39], v[12:15]
s_waitcnt lgkmcnt(2)
v_mfma_f32_16x16x32_bf16 v[8:11], a[240:243], v[40:43], v[8:11]
v_mfma_f32_16x16x32_bf16 v[16:19], a[244:247], v[40:43], v[16:19]
s_waitcnt lgkmcnt(1)
v_mfma_f32_16x16x32_bf16 v[4:7], a[248:251], v[44:47], v[4:7]
v_mfma_f32_16x16x32_bf16 v[12:15], a[252:255], v[44:47], v[12:15]
s_waitcnt lgkmcnt(0)
v_mfma_f32_16x16x32_bf16 v[8:11], a[248:251], v[48:51], v[8:11]
v_mfma_f32_16x16x32_bf16 v[16:19], a[252:255], v[48:51], v[16:19]
v_cvt_pk_bf16_f32 v52, v4, v5
v_cvt_pk_bf16_f32 v53, v6, v7
v_cvt_pk_bf16_f32 v54, v12, v13
v_cvt_pk_bf16_f32 v55, v14, v15
buffer_store_dwordx4 v[52:55], v2, s[4:7], s62 offen sc1
v_cvt_pk_bf16_f32 v56, v8, v9
v_cvt_pk_bf16_f32 v57, v10, v11
s_nop 0
v_cvt_pk_bf16_f32 v58, v16, v17
v_cvt_pk_bf16_f32 v59, v18, v19
buffer_store_dwordx4 v[56:59], v2, s[4:7], s68 offen sc1
s_branch QKVJ_16
QKVV_15:
ds_read_b128 v[20:23], v62 offset:0
ds_read_b128 v[24:27], v62 offset:20480
ds_read_b128 v[28:31], v62 offset:1024
ds_read_b128 v[32:35], v62 offset:21504
ds_read_b128 v[36:39], v62 offset:2048
ds_read_b128 v[40:43], v62 offset:22528
ds_read_b128 v[44:47], v62 offset:3072
ds_read_b128 v[48:51], v62 offset:23552
s_waitcnt lgkmcnt(7)
v_mfma_f32_16x16x32_bf16 v[4:7], v[20:23], a[96:99], 0
v_mfma_f32_16x16x32_bf16 v[12:15], v[20:23], a[100:103], 0
ds_read_b128 v[20:23], v62 offset:4096
s_waitcnt lgkmcnt(7)
v_mfma_f32_16x16x32_bf16 v[8:11], v[24:27], a[96:99], 0
v_mfma_f32_16x16x32_bf16 v[16:19], v[24:27], a[100:103], 0
ds_read_b128 v[24:27], v62 offset:24576
s_waitcnt lgkmcnt(7)
v_mfma_f32_16x16x32_bf16 v[4:7], v[28:31], a[104:107], v[4:7]
v_mfma_f32_16x16x32_bf16 v[12:15], v[28:31], a[108:111], v[12:15]
ds_read_b128 v[28:31], v62 offset:5120
s_waitcnt lgkmcnt(7)
v_mfma_f32_16x16x32_bf16 v[8:11], v[32:35], a[104:107], v[8:11]
v_mfma_f32_16x16x32_bf16 v[16:19], v[32:35], a[108:111], v[16:19]
ds_read_b128 v[32:35], v62 offset:25600
s_waitcnt lgkmcnt(7)
v_mfma_f32_16x16x32_bf16 v[4:7], v[36:39], a[112:115], v[4:7]
v_mfma_f32_16x16x32_bf16 v[12:15], v[36:39], a[116:119], v[12:15]
ds_read_b128 v[36:39], v62 offset:6144
s_waitcnt lgkmcnt(7)
v_mfma_f32_16x16x32_bf16 v[8:11], v[40:43], a[112:115], v[8:11]
v_mfma_f32_16x16x32_bf16 v[16:19], v[40:43], a[116:119], v[16:19]
ds_read_b128 v[40:43], v62 offset:26624
s_waitcnt lgkmcnt(7)
v_mfma_f32_16x16x32_bf16 v[4:7], v[44:47], a[120:123], v[4:7]
v_mfma_f32_16x16x32_bf16 v[12:15], v[44:47], a[124:127], v[12:15]
ds_read_b128 v[44:47], v62 offset:7168
s_waitcnt lgkmcnt(7)
v_mfma_f32_16x16x32_bf16 v[8:11], v[48:51], a[120:123], v[8:11]
v_mfma_f32_16x16x32_bf16 v[16:19], v[48:51], a[124:127], v[16:19]
ds_read_b128 v[48:51], v62 offset:27648
s_waitcnt lgkmcnt(7)
v_mfma_f32_16x16x32_bf16 v[4:7], v[20:23], a[128:131], v[4:7]
v_mfma_f32_16x16x32_bf16 v[12:15], v[20:23], a[132:135], v[12:15]
ds_read_b128 v[20:23], v62 offset:8192
s_waitcnt lgkmcnt(7)
v_mfma_f32_16x16x32_bf16 v[8:11], v[24:27], a[128:131], v[8:11]
v_mfma_f32_16x16x32_bf16 v[16:19], v[24:27], a[132:135], v[16:19]
ds_read_b128 v[24:27], v62 offset:28672
s_waitcnt lgkmcnt(7)
v_mfma_f32_16x16x32_bf16 v[4:7], v[28:31], a[136:139], v[4:7]
v_mfma_f32_16x16x32_bf16 v[12:15], v[28:31], a[140:143], v[12:15]
ds_read_b128 v[28:31], v62 offset:9216
s_waitcnt lgkmcnt(7)
v_mfma_f32_16x16x32_bf16 v[8:11], v[32:35], a[136:139], v[8:11]
v_mfma_f32_16x16x32_bf16 v[16:19], v[32:35], a[140:143], v[16:19]
ds_read_b128 v[32:35], v62 offset:29696
s_waitcnt lgkmcnt(7)
v_mfma_f32_16x16x32_bf16 v[4:7], v[36:39], a[144:147], v[4:7]
v_mfma_f32_16x16x32_bf16 v[12:15], v[36:39], a[148:151], v[12:15]
ds_read_b128 v[36:39], v62 offset:10240
s_waitcnt lgkmcnt(7)
v_mfma_f32_16x16x32_bf16 v[8:11], v[40:43], a[144:147], v[8:11]
v_mfma_f32_16x16x32_bf16 v[16:19], v[40:43], a[148:151], v[16:19]
ds_read_b128 v[40:43], v62 offset:30720
s_waitcnt lgkmcnt(7)
v_mfma_f32_16x16x32_bf16 v[4:7], v[44:47], a[152:155], v[4:7]
v_mfma_f32_16x16x32_bf16 v[12:15], v[44:47], a[156:159], v[12:15]
ds_read_b128 v[44:47], v62 offset:11264
s_waitcnt lgkmcnt(7)
v_mfma_f32_16x16x32_bf16 v[8:11], v[48:51], a[152:155], v[8:11]
v_mfma_f32_16x16x32_bf16 v[16:19], v[48:51], a[156:159], v[16:19]
ds_read_b128 v[48:51], v62 offset:31744
s_waitcnt lgkmcnt(7)
v_mfma_f32_16x16x32_bf16 v[4:7], v[20:23], a[160:163], v[4:7]
v_mfma_f32_16x16x32_bf16 v[12:15], v[20:23], a[164:167], v[12:15]
ds_read_b128 v[20:23], v62 offset:12288
s_waitcnt lgkmcnt(7)
v_mfma_f32_16x16x32_bf16 v[8:11], v[24:27], a[160:163], v[8:11]
v_mfma_f32_16x16x32_bf16 v[16:19], v[24:27], a[164:167], v[16:19]
ds_read_b128 v[24:27], v62 offset:32768
s_waitcnt lgkmcnt(7)
v_mfma_f32_16x16x32_bf16 v[4:7], v[28:31], a[168:171], v[4:7]
v_mfma_f32_16x16x32_bf16 v[12:15], v[28:31], a[172:175], v[12:15]
ds_read_b128 v[28:31], v62 offset:13312
s_waitcnt lgkmcnt(7)
v_mfma_f32_16x16x32_bf16 v[8:11], v[32:35], a[168:171], v[8:11]
v_mfma_f32_16x16x32_bf16 v[16:19], v[32:35], a[172:175], v[16:19]
ds_read_b128 v[32:35], v62 offset:33792
s_waitcnt lgkmcnt(7)
v_mfma_f32_16x16x32_bf16 v[4:7], v[36:39], a[176:179], v[4:7]
v_mfma_f32_16x16x32_bf16 v[12:15], v[36:39], a[180:183], v[12:15]
ds_read_b128 v[36:39], v62 offset:14336
s_waitcnt lgkmcnt(7)
v_mfma_f32_16x16x32_bf16 v[8:11], v[40:43], a[176:179], v[8:11]
v_mfma_f32_16x16x32_bf16 v[16:19], v[40:43], a[180:183], v[16:19]
ds_read_b128 v[40:43], v62 offset:34816
s_waitcnt lgkmcnt(7)
v_mfma_f32_16x16x32_bf16 v[4:7], v[44:47], a[184:187], v[4:7]
v_mfma_f32_16x16x32_bf16 v[12:15], v[44:47], a[188:191], v[12:15]
ds_read_b128 v[44:47], v62 offset:15360
s_waitcnt lgkmcnt(7)
v_mfma_f32_16x16x32_bf16 v[8:11], v[48:51], a[184:187], v[8:11]
v_mfma_f32_16x16x32_bf16 v[16:19], v[48:51], a[188:191], v[16:19]
ds_read_b128 v[48:51], v62 offset:35840
s_waitcnt lgkmcnt(7)
v_mfma_f32_16x16x32_bf16 v[4:7], v[20:23], a[192:195], v[4:7]
v_mfma_f32_16x16x32_bf16 v[12:15], v[20:23], a[196:199], v[12:15]
ds_read_b128 v[20:23], v62 offset:16384
s_waitcnt lgkmcnt(7)
v_mfma_f32_16x16x32_bf16 v[8:11], v[24:27], a[192:195], v[8:11]
v_mfma_f32_16x16x32_bf16 v[16:19], v[24:27], a[196:199], v[16:19]
ds_read_b128 v[24:27], v62 offset:36864
s_waitcnt lgkmcnt(7)
v_mfma_f32_16x16x32_bf16 v[4:7], v[28:31], a[200:203], v[4:7]
v_mfma_f32_16x16x32_bf16 v[12:15], v[28:31], a[204:207], v[12:15]
ds_read_b128 v[28:31], v62 offset:17408
s_waitcnt lgkmcnt(7)
v_mfma_f32_16x16x32_bf16 v[8:11], v[32:35], a[200:203], v[8:11]
v_mfma_f32_16x16x32_bf16 v[16:19], v[32:35], a[204:207], v[16:19]
ds_read_b128 v[32:35], v62 offset:37888
s_waitcnt lgkmcnt(7)
v_mfma_f32_16x16x32_bf16 v[4:7], v[36:39], a[208:211], v[4:7]
v_mfma_f32_16x16x32_bf16 v[12:15], v[36:39], a[212:215], v[12:15]
ds_read_b128 v[36:39], v62 offset:18432
s_waitcnt lgkmcnt(7)
v_mfma_f32_16x16x32_bf16 v[8:11], v[40:43], a[208:211], v[8:11]
v_mfma_f32_16x16x32_bf16 v[16:19], v[40:43], a[212:215], v[16:19]
ds_read_b128 v[40:43], v62 offset:38912
s_waitcnt lgkmcnt(7)
v_mfma_f32_16x16x32_bf16 v[4:7], v[44:47], a[216:219], v[4:7]
v_mfma_f32_16x16x32_bf16 v[12:15], v[44:47], a[220:223], v[12:15]
ds_read_b128 v[44:47], v62 offset:19456
s_waitcnt lgkmcnt(7)
v_mfma_f32_16x16x32_bf16 v[8:11], v[48:51], a[216:219], v[8:11]
v_mfma_f32_16x16x32_bf16 v[16:19], v[48:51], a[220:223], v[16:19]
ds_read_b128 v[48:51], v62 offset:39936
s_waitcnt lgkmcnt(7)
v_mfma_f32_16x16x32_bf16 v[4:7], v[20:23], a[224:227], v[4:7]
v_mfma_f32_16x16x32_bf16 v[12:15], v[20:23], a[228:231], v[12:15]
s_waitcnt lgkmcnt(6)
v_mfma_f32_16x16x32_bf16 v[8:11], v[24:27], a[224:227], v[8:11]
v_mfma_f32_16x16x32_bf16 v[16:19], v[24:27], a[228:231], v[16:19]
s_waitcnt lgkmcnt(5)
v_mfma_f32_16x16x32_bf16 v[4:7], v[28:31], a[232:235], v[4:7]
v_mfma_f32_16x16x32_bf16 v[12:15], v[28:31], a[236:239], v[12:15]
s_waitcnt lgkmcnt(4)
v_mfma_f32_16x16x32_bf16 v[8:11], v[32:35], a[232:235], v[8:11]
v_mfma_f32_16x16x32_bf16 v[16:19], v[32:35], a[236:239], v[16:19]
s_waitcnt lgkmcnt(3)
v_mfma_f32_16x16x32_bf16 v[4:7], v[36:39], a[240:243], v[4:7]
v_mfma_f32_16x16x32_bf16 v[12:15], v[36:39], a[244:247], v[12:15]
s_waitcnt lgkmcnt(2)
v_mfma_f32_16x16x32_bf16 v[8:11], v[40:43], a[240:243], v[8:11]
v_mfma_f32_16x16x32_bf16 v[16:19], v[40:43], a[244:247], v[16:19]
s_waitcnt lgkmcnt(1)
v_mfma_f32_16x16x32_bf16 v[4:7], v[44:47], a[248:251], v[4:7]
v_mfma_f32_16x16x32_bf16 v[12:15], v[44:47], a[252:255], v[12:15]
s_waitcnt lgkmcnt(0)
v_mfma_f32_16x16x32_bf16 v[8:11], v[48:51], a[248:251], v[8:11]
v_mfma_f32_16x16x32_bf16 v[16:19], v[48:51], a[252:255], v[16:19]
v_cvt_pk_bf16_f32 v52, v4, v5
v_cvt_pk_bf16_f32 v53, v6, v7
s_nop 1
v_cvt_pk_bf16_f32 v54, v8, v9
v_cvt_pk_bf16_f32 v55, v10, v11
buffer_store_dwordx4 v[52:55], v2, s[4:7], s62 offen sc1
v_cvt_pk_bf16_f32 v56, v12, v13
v_cvt_pk_bf16_f32 v57, v14, v15
v_cvt_pk_bf16_f32 v58, v16, v17
v_cvt_pk_bf16_f32 v59, v18, v19
buffer_store_dwordx4 v[56:59], v2, s[4:7], s68 offen sc1
QKVJ_16:
s_add_u32 s62, s62, 524288
s_add_u32 s68, s68, 524288
s_add_u32 s58, s58, 2
s_waitcnt vmcnt(0) lgkmcnt(0)
s_barrier
s_cmp_lg_u32 s49, 0
s_cbranch_scc1 QKVP_17
v_mov_b32 v60, 0
v_mov_b32 v61, s58
buffer_store_dword v61, v60, s[4:7], s63 offen sc1
QKVP_17:
s_cmp_eq_u32 s57, 30
s_cbranch_scc1 QKVN_18
s_cmp_lg_u32 s49, 0
s_cbranch_scc1 WFOK_21
v_min_u32 v60, s75, v1
v_lshlrev_b32 v60, 2, v60
s_mov_b32 s69, 0
WF_20:
buffer_load_dword v61, v60, s[4:7], s60 offen sc1
s_add_u32 s69, s69, 1
s_cmp_gt_u32 s69, 131072
s_cbranch_scc1 ABORT
s_waitcnt vmcnt(0)
v_cmp_gt_u32 vcc, 1, v61
s_cbranch_vccz WFOK_21
s_sleep 2
s_branch WF_20
WFOK_21:
s_barrier
QKVS_19:
s_cmp_eq_u32 s50, 0
s_cselect_b32 s51, 16, 0
s_add_u32 s60, s60, s51
s_add_u32 m0, s70, 0
s_add_u32 s51, s61, 0
buffer_load_dwordx4 v2, s[4:7], s51 offen offset:0 sc1 lds
buffer_load_dwordx4 v2, s[4:7], s51 offen offset:1024 sc1 lds
buffer_load_dwordx4 v2, s[4:7], s51 offen offset:2048 sc1 lds
buffer_load_dwordx4 v2, s[4:7], s51 offen offset:3072 sc1 lds
s_add_u32 m0, s70, 4096
s_add_u32 s51, s61, 4096
buffer_load_dwordx4 v2, s[4:7], s51 offen offset:0 sc1 lds
buffer_load_dwordx4 v2, s[4:7], s51 offen offset:1024 sc1 lds
buffer_load_dwordx4 v2, s[4:7], s51 offen offset:2048 sc1 lds
buffer_load_dwordx4 v2, s[4:7], s51 offen offset:3072 sc1 lds
s_add_u32 m0, s70, 8192
s_add_u32 s51, s61, 8192
buffer_load_dwordx4 v2, s[4:7], s51 offen offset:0 sc1 lds
buffer_load_dwordx4 v2, s[4:7], s51 offen offset:1024 sc1 lds
buffer_load_dwordx4 v2, s[4:7], s51 offen offset:2048 sc1 lds
buffer_load_dwordx4 v2, s[4:7], s51 offen offset:3072 sc1 lds
s_add_u32 m0, s70, 12288
s_add_u32 s51, s61, 12288
buffer_load_dwordx4 v2, s[4:7], s51 offen offset:0 sc1 lds
buffer_load_dwordx4 v2, s[4:7], s51 offen offset:1024 sc1 lds
buffer_load_dwordx4 v2, s[4:7], s51 offen offset:2048 sc1 lds
buffer_load_dwordx4 v2, s[4:7], s51 offen offset:3072 sc1 lds
s_add_u32 m0, s70, 16384
s_add_u32 s51, s61, 16384
buffer_load_dwordx4 v2, s[4:7], s51 offen offset:0 sc1 lds
buffer_load_dwordx4 v2, s[4:7], s51 offen offset:1024 sc1 lds
buffer_load_dwordx4 v2, s[4:7], s51 offen offset:2048 sc1 lds
buffer_load_dwordx4 v2, s[4:7], s51 offen offset:3072 sc1 lds
s_add_u32 s61, s61, 81920
QKVN_18:
s_cmp_eq_u32 s72, 2
s_cbranch_scc1 QKVV_22
ds_read_b128 v[20:23], v63 offset:0
ds_read_b128 v[24:27], v63 offset:20480
ds_read_b128 v[28:31], v63 offset:1024
ds_read_b128 v[32:35], v63 offset:21504
ds_read_b128 v[36:39], v63 offset:2048
ds_read_b128 v[40:43], v63 offset:22528
ds_read_b128 v[44:47], v63 offset:3072
ds_read_b128 v[48:51], v63 offset:23552
s_waitcnt lgkmcnt(7)
v_mfma_f32_16x16x32_bf16 v[4:7], a[96:99], v[20:23], 0
v_mfma_f32_16x16x32_bf16 v[12:15], a[100:103], v[20:23], 0
ds_read_b128 v[20:23], v63 offset:4096
s_waitcnt lgkmcnt(7)
v_mfma_f32_16x16x32_bf16 v[8:11], a[96:99], v[24:27], 0
v_mfma_f32_16x16x32_bf16 v[16:19], a[100:103], v[24:27], 0
ds_read_b128 v[24:27], v63 offset:24576
s_waitcnt lgkmcnt(7)
v_mfma_f32_16x16x32_bf16 v[4:7], a[104:107], v[28:31], v[4:7]
v_mfma_f32_16x16x32_bf16 v[12:15], a[108:111], v[28:31], v[12:15]
ds_read_b128 v[28:31], v63 offset:5120
s_waitcnt lgkmcnt(7)
v_mfma_f32_16x16x32_bf16 v[8:11], a[104:107], v[32:35], v[8:11]
v_mfma_f32_16x16x32_bf16 v[16:19], a[108:111], v[32:35], v[16:19]
ds_read_b128 v[32:35], v63 offset:25600
s_waitcnt lgkmcnt(7)
v_mfma_f32_16x16x32_bf16 v[4:7], a[112:115], v[36:39], v[4:7]
v_mfma_f32_16x16x32_bf16 v[12:15], a[116:119], v[36:39], v[12:15]
ds_read_b128 v[36:39], v63 offset:6144
s_waitcnt lgkmcnt(7)
v_mfma_f32_16x16x32_bf16 v[8:11], a[112:115], v[40:43], v[8:11]
v_mfma_f32_16x16x32_bf16 v[16:19], a[116:119], v[40:43], v[16:19]
ds_read_b128 v[40:43], v63 offset:26624
s_waitcnt lgkmcnt(7)
v_mfma_f32_16x16x32_bf16 v[4:7], a[120:123], v[44:47], v[4:7]
v_mfma_f32_16x16x32_bf16 v[12:15], a[124:127], v[44:47], v[12:15]
ds_read_b128 v[44:47], v63 offset:7168
s_waitcnt lgkmcnt(7)
v_mfma_f32_16x16x32_bf16 v[8:11], a[120:123], v[48:51], v[8:11]
v_mfma_f32_16x16x32_bf16 v[16:19], a[124:127], v[48:51], v[16:19]
ds_read_b128 v[48:51], v63 offset:27648
s_waitcnt lgkmcnt(7)
v_mfma_f32_16x16x32_bf16 v[4:7], a[128:131], v[20:23], v[4:7]
v_mfma_f32_16x16x32_bf16 v[12:15], a[132:135], v[20:23], v[12:15]
ds_read_b128 v[20:23], v63 offset:8192
s_waitcnt lgkmcnt(7)
v_mfma_f32_16x16x32_bf16 v[8:11], a[128:131], v[24:27], v[8:11]
v_mfma_f32_16x16x32_bf16 v[16:19], a[132:135], v[24:27], v[16:19]
ds_read_b128 v[24:27], v63 offset:28672
s_waitcnt lgkmcnt(7)
v_mfma_f32_16x16x32_bf16 v[4:7], a[136:139], v[28:31], v[4:7]
v_mfma_f32_16x16x32_bf16 v[12:15], a[140:143], v[28:31], v[12:15]
ds_read_b128 v[28:31], v63 offset:9216
s_waitcnt lgkmcnt(7)
v_mfma_f32_16x16x32_bf16 v[8:11], a[136:139], v[32:35], v[8:11]
v_mfma_f32_16x16x32_bf16 v[16:19], a[140:143], v[32:35], v[16:19]
ds_read_b128 v[32:35], v63 offset:29696
s_waitcnt lgkmcnt(7)
v_mfma_f32_16x16x32_bf16 v[4:7], a[144:147], v[36:39], v[4:7]
v_mfma_f32_16x16x32_bf16 v[12:15], a[148:151], v[36:39], v[12:15]
ds_read_b128 v[36:39], v63 offset:10240
s_waitcnt lgkmcnt(7)
v_mfma_f32_16x16x32_bf16 v[8:11], a[144:147], v[40:43], v[8:11]
v_mfma_f32_16x16x32_bf16 v[16:19], a[148:151], v[40:43], v[16:19]
ds_read_b128 v[40:43], v63 offset:30720
s_waitcnt lgkmcnt(7)
v_mfma_f32_16x16x32_bf16 v[4:7], a[152:155], v[44:47], v[4:7]
v_mfma_f32_16x16x32_bf16 v[12:15], a[156:159], v[44:47], v[12:15]
ds_read_b128 v[44:47], v63 offset:11264
s_waitcnt lgkmcnt(7)
v_mfma_f32_16x16x32_bf16 v[8:11], a[152:155], v[48:51], v[8:11]
v_mfma_f32_16x16x32_bf16 v[16:19], a[156:159], v[48:51], v[16:19]
ds_read_b128 v[48:51], v63 offset:31744
s_waitcnt lgkmcnt(7)
v_mfma_f32_16x16x32_bf16 v[4:7], a[160:163], v[20:23], v[4:7]
v_mfma_f32_16x16x32_bf16 v[12:15], a[164:167], v[20:23], v[12:15]
ds_read_b128 v[20:23], v63 offset:12288
s_waitcnt lgkmcnt(7)
v_mfma_f32_16x16x32_bf16 v[8:11], a[160:163], v[24:27], v[8:11]
v_mfma_f32_16x16x32_bf16 v[16:19], a[164:167], v[24:27], v[16:19]
ds_read_b128 v[24:27], v63 offset:32768
s_waitcnt lgkmcnt(7)
v_mfma_f32_16x16x32_bf16 v[4:7], a[168:171], v[28:31], v[4:7]
v_mfma_f32_16x16x32_bf16 v[12:15], a[172:175], v[28:31], v[12:15]
ds_read_b128 v[28:31], v63 offset:13312
s_waitcnt lgkmcnt(7)
v_mfma_f32_16x16x32_bf16 v[8:11], a[168:171], v[32:35], v[8:11]
v_mfma_f32_16x16x32_bf16 v[16:19], a[172:175], v[32:35], v[16:19]
ds_read_b128 v[32:35], v63 offset:33792
s_waitcnt lgkmcnt(7)
v_mfma_f32_16x16x32_bf16 v[4:7], a[176:179], v[36:39], v[4:7]
v_mfma_f32_16x16x32_bf16 v[12:15], a[180:183], v[36:39], v[12:15]
ds_read_b128 v[36:39], v63 offset:14336
s_waitcnt lgkmcnt(7)
v_mfma_f32_16x16x32_bf16 v[8:11], a[176:179], v[40:43], v[8:11]
v_mfma_f32_16x16x32_bf16 v[16:19], a[180:183], v[40:43], v[16:19]
ds_read_b128 v[40:43], v63 offset:34816
s_waitcnt lgkmcnt(7)
v_mfma_f32_16x16x32_bf16 v[4:7], a[184:187], v[44:47], v[4:7]
v_mfma_f32_16x16x32_bf16 v[12:15], a[188:191], v[44:47], v[12:15]
ds_read_b128 v[44:47], v63 offset:15360
s_waitcnt lgkmcnt(7)
v_mfma_f32_16x16x32_bf16 v[8:11], a[184:187], v[48:51], v[8:11]
v_mfma_f32_16x16x32_bf16 v[16:19], a[188:191], v[48:51], v[16:19]
ds_read_b128 v[48:51], v63 offset:35840
s_waitcnt lgkmcnt(7)
v_mfma_f32_16x16x32_bf16 v[4:7], a[192:195], v[20:23], v[4:7]
v_mfma_f32_16x16x32_bf16 v[12:15], a[196:199], v[20:23], v[12:15]
ds_read_b128 v[20:23], v63 offset:16384
s_waitcnt lgkmcnt(7)
v_mfma_f32_16x16x32_bf16 v[8:11], a[192:195], v[24:27], v[8:11]
v_mfma_f32_16x16x32_bf16 v[16:19], a[196:199], v[24:27], v[16:19]
ds_read_b128 v[24:27], v63 offset:36864
s_waitcnt lgkmcnt(7)
v_mfma_f32_16x16x32_bf16 v[4:7], a[200:203], v[28:31], v[4:7]
v_mfma_f32_16x16x32_bf16 v[12:15], a[204:207], v[28:31], v[12:15]
ds_read_b128 v[28:31], v63 offset:17408
s_waitcnt lgkmcnt(7)
v_mfma_f32_16x16x32_bf16 v[8:11], a[200:203], v[32:35], v[8:11]
v_mfma_f32_16x16x32_bf16 v[16:19], a[204:207], v[32:35], v[16:19]
ds_read_b128 v[32:35], v63 offset:37888
s_waitcnt lgkmcnt(7)
v_mfma_f32_16x16x32_bf16 v[4:7], a[208:211], v[36:39], v[4:7]
v_mfma_f32_16x16x32_bf16 v[12:15], a[212:215], v[36:39], v[12:15]
ds_read_b128 v[36:39], v63 offset:18432
s_waitcnt lgkmcnt(7)
v_mfma_f32_16x16x32_bf16 v[8:11], a[208:211], v[40:43], v[8:11]
v_mfma_f32_16x16x32_bf16 v[16:19], a[212:215], v[40:43], v[16:19]
ds_read_b128 v[40:43], v63 offset:38912
s_waitcnt lgkmcnt(7)
v_mfma_f32_16x16x32_bf16 v[4:7], a[216:219], v[44:47], v[4:7]
v_mfma_f32_16x16x32_bf16 v[12:15], a[220:223], v[44:47], v[12:15]
ds_read_b128 v[44:47], v63 offset:19456
s_waitcnt lgkmcnt(7)
v_mfma_f32_16x16x32_bf16 v[8:11], a[216:219], v[48:51], v[8:11]
v_mfma_f32_16x16x32_bf16 v[16:19], a[220:223], v[48:51], v[16:19]
ds_read_b128 v[48:51], v63 offset:39936
s_waitcnt lgkmcnt(7)
v_mfma_f32_16x16x32_bf16 v[4:7], a[224:227], v[20:23], v[4:7]
v_mfma_f32_16x16x32_bf16 v[12:15], a[228:231], v[20:23], v[12:15]
s_waitcnt lgkmcnt(6)
v_mfma_f32_16x16x32_bf16 v[8:11], a[224:227], v[24:27], v[8:11]
v_mfma_f32_16x16x32_bf16 v[16:19], a[228:231], v[24:27], v[16:19]
s_waitcnt lgkmcnt(5)
v_mfma_f32_16x16x32_bf16 v[4:7], a[232:235], v[28:31], v[4:7]
v_mfma_f32_16x16x32_bf16 v[12:15], a[236:239], v[28:31], v[12:15]
s_waitcnt lgkmcnt(4)
v_mfma_f32_16x16x32_bf16 v[8:11], a[232:235], v[32:35], v[8:11]
v_mfma_f32_16x16x32_bf16 v[16:19], a[236:239], v[32:35], v[16:19]
s_waitcnt lgkmcnt(3)
v_mfma_f32_16x16x32_bf16 v[4:7], a[240:243], v[36:39], v[4:7]
v_mfma_f32_16x16x32_bf16 v[12:15], a[244:247], v[36:39], v[12:15]
s_waitcnt lgkmcnt(2)
v_mfma_f32_16x16x32_bf16 v[8:11], a[240:243], v[40:43], v[8:11]
v_mfma_f32_16x16x32_bf16 v[16:19], a[244:247], v[40:43], v[16:19]
s_waitcnt lgkmcnt(1)
v_mfma_f32_16x16x32_bf16 v[4:7], a[248:251], v[44:47], v[4:7]
v_mfma_f32_16x16x32_bf16 v[12:15], a[252:255], v[44:47], v[12:15]
s_waitcnt lgkmcnt(0)
v_mfma_f32_16x16x32_bf16 v[8:11], a[248:251], v[48:51], v[8:11]
v_mfma_f32_16x16x32_bf16 v[16:19], a[252:255], v[48:51], v[16:19]
v_cvt_pk_bf16_f32 v52, v4, v5
v_cvt_pk_bf16_f32 v53, v6, v7
v_cvt_pk_bf16_f32 v54, v12, v13
v_cvt_pk_bf16_f32 v55, v14, v15
buffer_store_dwordx4 v[52:55], v2, s[4:7], s62 offen sc1
v_cvt_pk_bf16_f32 v56, v8, v9
v_cvt_pk_bf16_f32 v57, v10, v11
s_nop 0
v_cvt_pk_bf16_f32 v58, v16, v17
v_cvt_pk_bf16_f32 v59, v18, v19
buffer_store_dwordx4 v[56:59], v2, s[4:7], s68 offen sc1
s_branch QKVJ_23
QKVV_22:
ds_read_b128 v[20:23], v63 offset:0
ds_read_b128 v[24:27], v63 offset:20480
ds_read_b128 v[28:31], v63 offset:1024
ds_read_b128 v[32:35], v63 offset:21504
ds_read_b128 v[36:39], v63 offset:2048
ds_read_b128 v[40:43], v63 offset:22528
ds_read_b128 v[44:47], v63 offset:3072
ds_read_b128 v[48:51], v63 offset:23552
s_waitcnt lgkmcnt(7)
v_mfma_f32_16x16x32_bf16 v[4:7], v[20:23], a[96:99], 0
v_mfma_f32_16x16x32_bf16 v[12:15], v[20:23], a[100:103], 0
ds_read_b128 v[20:23], v63 offset:4096
s_waitcnt lgkmcnt(7)
v_mfma_f32_16x16x32_bf16 v[8:11], v[24:27], a[96:99], 0
v_mfma_f32_16x16x32_bf16 v[16:19], v[24:27], a[100:103], 0
ds_read_b128 v[24:27], v63 offset:24576
s_waitcnt lgkmcnt(7)
v_mfma_f32_16x16x32_bf16 v[4:7], v[28:31], a[104:107], v[4:7]
v_mfma_f32_16x16x32_bf16 v[12:15], v[28:31], a[108:111], v[12:15]
ds_read_b128 v[28:31], v63 offset:5120
s_waitcnt lgkmcnt(7)
v_mfma_f32_16x16x32_bf16 v[8:11], v[32:35], a[104:107], v[8:11]
v_mfma_f32_16x16x32_bf16 v[16:19], v[32:35], a[108:111], v[16:19]
ds_read_b128 v[32:35], v63 offset:25600
s_waitcnt lgkmcnt(7)
v_mfma_f32_16x16x32_bf16 v[4:7], v[36:39], a[112:115], v[4:7]
v_mfma_f32_16x16x32_bf16 v[12:15], v[36:39], a[116:119], v[12:15]
ds_read_b128 v[36:39], v63 offset:6144
s_waitcnt lgkmcnt(7)
v_mfma_f32_16x16x32_bf16 v[8:11], v[40:43], a[112:115], v[8:11]
v_mfma_f32_16x16x32_bf16 v[16:19], v[40:43], a[116:119], v[16:19]
ds_read_b128 v[40:43], v63 offset:26624
s_waitcnt lgkmcnt(7)
v_mfma_f32_16x16x32_bf16 v[4:7], v[44:47], a[120:123], v[4:7]
v_mfma_f32_16x16x32_bf16 v[12:15], v[44:47], a[124:127], v[12:15]
ds_read_b128 v[44:47], v63 offset:7168
s_waitcnt lgkmcnt(7)
v_mfma_f32_16x16x32_bf16 v[8:11], v[48:51], a[120:123], v[8:11]
v_mfma_f32_16x16x32_bf16 v[16:19], v[48:51], a[124:127], v[16:19]
ds_read_b128 v[48:51], v63 offset:27648
s_waitcnt lgkmcnt(7)
v_mfma_f32_16x16x32_bf16 v[4:7], v[20:23], a[128:131], v[4:7]
v_mfma_f32_16x16x32_bf16 v[12:15], v[20:23], a[132:135], v[12:15]
ds_read_b128 v[20:23], v63 offset:8192
s_waitcnt lgkmcnt(7)
v_mfma_f32_16x16x32_bf16 v[8:11], v[24:27], a[128:131], v[8:11]
v_mfma_f32_16x16x32_bf16 v[16:19], v[24:27], a[132:135], v[16:19]
ds_read_b128 v[24:27], v63 offset:28672
s_waitcnt lgkmcnt(7)
v_mfma_f32_16x16x32_bf16 v[4:7], v[28:31], a[136:139], v[4:7]
v_mfma_f32_16x16x32_bf16 v[12:15], v[28:31], a[140:143], v[12:15]
ds_read_b128 v[28:31], v63 offset:9216
s_waitcnt lgkmcnt(7)
v_mfma_f32_16x16x32_bf16 v[8:11], v[32:35], a[136:139], v[8:11]
v_mfma_f32_16x16x32_bf16 v[16:19], v[32:35], a[140:143], v[16:19]
ds_read_b128 v[32:35], v63 offset:29696
s_waitcnt lgkmcnt(7)
v_mfma_f32_16x16x32_bf16 v[4:7], v[36:39], a[144:147], v[4:7]
v_mfma_f32_16x16x32_bf16 v[12:15], v[36:39], a[148:151], v[12:15]
ds_read_b128 v[36:39], v63 offset:10240
s_waitcnt lgkmcnt(7)
v_mfma_f32_16x16x32_bf16 v[8:11], v[40:43], a[144:147], v[8:11]
v_mfma_f32_16x16x32_bf16 v[16:19], v[40:43], a[148:151], v[16:19]
ds_read_b128 v[40:43], v63 offset:30720
s_waitcnt lgkmcnt(7)
v_mfma_f32_16x16x32_bf16 v[4:7], v[44:47], a[152:155], v[4:7]
v_mfma_f32_16x16x32_bf16 v[12:15], v[44:47], a[156:159], v[12:15]
ds_read_b128 v[44:47], v63 offset:11264
s_waitcnt lgkmcnt(7)
v_mfma_f32_16x16x32_bf16 v[8:11], v[48:51], a[152:155], v[8:11]
v_mfma_f32_16x16x32_bf16 v[16:19], v[48:51], a[156:159], v[16:19]
ds_read_b128 v[48:51], v63 offset:31744
s_waitcnt lgkmcnt(7)
v_mfma_f32_16x16x32_bf16 v[4:7], v[20:23], a[160:163], v[4:7]
v_mfma_f32_16x16x32_bf16 v[12:15], v[20:23], a[164:167], v[12:15]
ds_read_b128 v[20:23], v63 offset:12288
s_waitcnt lgkmcnt(7)
v_mfma_f32_16x16x32_bf16 v[8:11], v[24:27], a[160:163], v[8:11]
v_mfma_f32_16x16x32_bf16 v[16:19], v[24:27], a[164:167], v[16:19]
ds_read_b128 v[24:27], v63 offset:32768
s_waitcnt lgkmcnt(7)
v_mfma_f32_16x16x32_bf16 v[4:7], v[28:31], a[168:171], v[4:7]
v_mfma_f32_16x16x32_bf16 v[12:15], v[28:31], a[172:175], v[12:15]
ds_read_b128 v[28:31], v63 offset:13312
s_waitcnt lgkmcnt(7)
v_mfma_f32_16x16x32_bf16 v[8:11], v[32:35], a[168:171], v[8:11]
v_mfma_f32_16x16x32_bf16 v[16:19], v[32:35], a[172:175], v[16:19]
ds_read_b128 v[32:35], v63 offset:33792
s_waitcnt lgkmcnt(7)
v_mfma_f32_16x16x32_bf16 v[4:7], v[36:39], a[176:179], v[4:7]
v_mfma_f32_16x16x32_bf16 v[12:15], v[36:39], a[180:183], v[12:15]
ds_read_b128 v[36:39], v63 offset:14336
s_waitcnt lgkmcnt(7)
v_mfma_f32_16x16x32_bf16 v[8:11], v[40:43], a[176:179], v[8:11]
v_mfma_f32_16x16x32_bf16 v[16:19], v[40:43], a[180:183], v[16:19]
ds_read_b128 v[40:43], v63 offset:34816
s_waitcnt lgkmcnt(7)
v_mfma_f32_16x16x32_bf16 v[4:7], v[44:47], a[184:187], v[4:7]
v_mfma_f32_16x16x32_bf16 v[12:15], v[44:47], a[188:191], v[12:15]
ds_read_b128 v[44:47], v63 offset:15360
s_waitcnt lgkmcnt(7)
v_mfma_f32_16x16x32_bf16 v[8:11], v[48:51], a[184:187], v[8:11]
v_mfma_f32_16x16x32_bf16 v[16:19], v[48:51], a[188:191], v[16:19]
ds_read_b128 v[48:51], v63 offset:35840
s_waitcnt lgkmcnt(7)
v_mfma_f32_16x16x32_bf16 v[4:7], v[20:23], a[192:195], v[4:7]
v_mfma_f32_16x16x32_bf16 v[12:15], v[20:23], a[196:199], v[12:15]
ds_read_b128 v[20:23], v63 offset:16384
s_waitcnt lgkmcnt(7)
v_mfma_f32_16x16x32_bf16 v[8:11], v[24:27], a[192:195], v[8:11]
v_mfma_f32_16x16x32_bf16 v[16:19], v[24:27], a[196:199], v[16:19]
ds_read_b128 v[24:27], v63 offset:36864
s_waitcnt lgkmcnt(7)
v_mfma_f32_16x16x32_bf16 v[4:7], v[28:31], a[200:203], v[4:7]
v_mfma_f32_16x16x32_bf16 v[12:15], v[28:31], a[204:207], v[12:15]
ds_read_b128 v[28:31], v63 offset:17408
s_waitcnt lgkmcnt(7)
v_mfma_f32_16x16x32_bf16 v[8:11], v[32:35], a[200:203], v[8:11]
v_mfma_f32_16x16x32_bf16 v[16:19], v[32:35], a[204:207], v[16:19]
ds_read_b128 v[32:35], v63 offset:37888
s_waitcnt lgkmcnt(7)
v_mfma_f32_16x16x32_bf16 v[4:7], v[36:39], a[208:211], v[4:7]
v_mfma_f32_16x16x32_bf16 v[12:15], v[36:39], a[212:215], v[12:15]
ds_read_b128 v[36:39], v63 offset:18432
s_waitcnt lgkmcnt(7)
v_mfma_f32_16x16x32_bf16 v[8:11], v[40:43], a[208:211], v[8:11]
v_mfma_f32_16x16x32_bf16 v[16:19], v[40:43], a[212:215], v[16:19]
ds_read_b128 v[40:43], v63 offset:38912
s_waitcnt lgkmcnt(7)
v_mfma_f32_16x16x32_bf16 v[4:7], v[44:47], a[216:219], v[4:7]
v_mfma_f32_16x16x32_bf16 v[12:15], v[44:47], a[220:223], v[12:15]
ds_read_b128 v[44:47], v63 offset:19456
s_waitcnt lgkmcnt(7)
v_mfma_f32_16x16x32_bf16 v[8:11], v[48:51], a[216:219], v[8:11]
v_mfma_f32_16x16x32_bf16 v[16:19], v[48:51], a[220:223], v[16:19]
ds_read_b128 v[48:51], v63 offset:39936
s_waitcnt lgkmcnt(7)
v_mfma_f32_16x16x32_bf16 v[4:7], v[20:23], a[224:227], v[4:7]
v_mfma_f32_16x16x32_bf16 v[12:15], v[20:23], a[228:231], v[12:15]
s_waitcnt lgkmcnt(6)
v_mfma_f32_16x16x32_bf16 v[8:11], v[24:27], a[224:227], v[8:11]
v_mfma_f32_16x16x32_bf16 v[16:19], v[24:27], a[228:231], v[16:19]
s_waitcnt lgkmcnt(5)
v_mfma_f32_16x16x32_bf16 v[4:7], v[28:31], a[232:235], v[4:7]
v_mfma_f32_16x16x32_bf16 v[12:15], v[28:31], a[236:239], v[12:15]
s_waitcnt lgkmcnt(4)
v_mfma_f32_16x16x32_bf16 v[8:11], v[32:35], a[232:235], v[8:11]
v_mfma_f32_16x16x32_bf16 v[16:19], v[32:35], a[236:239], v[16:19]
s_waitcnt lgkmcnt(3)
v_mfma_f32_16x16x32_bf16 v[4:7], v[36:39], a[240:243], v[4:7]
v_mfma_f32_16x16x32_bf16 v[12:15], v[36:39], a[244:247], v[12:15]
s_waitcnt lgkmcnt(2)
v_mfma_f32_16x16x32_bf16 v[8:11], v[40:43], a[240:243], v[8:11]
v_mfma_f32_16x16x32_bf16 v[16:19], v[40:43], a[244:247], v[16:19]
s_waitcnt lgkmcnt(1)
v_mfma_f32_16x16x32_bf16 v[4:7], v[44:47], a[248:251], v[4:7]
v_mfma_f32_16x16x32_bf16 v[12:15], v[44:47], a[252:255], v[12:15]
s_waitcnt lgkmcnt(0)
v_mfma_f32_16x16x32_bf16 v[8:11], v[48:51], a[248:251], v[8:11]
v_mfma_f32_16x16x32_bf16 v[16:19], v[48:51], a[252:255], v[16:19]
v_cvt_pk_bf16_f32 v52, v4, v5
v_cvt_pk_bf16_f32 v53, v6, v7
s_nop 1
v_cvt_pk_bf16_f32 v54, v8, v9
v_cvt_pk_bf16_f32 v55, v10, v11
buffer_store_dwordx4 v[52:55], v2, s[4:7], s62 offen sc1
v_cvt_pk_bf16_f32 v56, v12, v13
v_cvt_pk_bf16_f32 v57, v14, v15
v_cvt_pk_bf16_f32 v58, v16, v17
v_cvt_pk_bf16_f32 v59, v18, v19
buffer_store_dwordx4 v[56:59], v2, s[4:7], s68 offen sc1
QKVJ_23:
s_add_u32 s62, s62, 524288
s_add_u32 s68, s68, 524288
s_add_u32 s58, s58, 2
s_add_u32 s57, s57, 2
s_cmp_lt_u32 s57, 32
s_cbranch_scc1 QKV_LOOP
s_waitcnt vmcnt(0) lgkmcnt(0)
s_barrier
s_cmp_lg_u32 s49, 0
s_cbranch_scc1 PUB_24
v_mov_b32 v60, 0
v_mov_b32 v61, s58
buffer_store_dword v61, v60, s[4:7], s63 offen sc1
PUB_24:
s_cmp_lg_u32 s50, 0
s_cbranch_scc1 GW_NOW2
s_barrier
s_cmp_ge_u32 s74, 160
s_cbranch_scc1 GW_NOW2
s_and_b32 s51, s74, 15
s_lshl_b32 s55, s51, 8
s_lshl_b32 s51, s51, 2
s_add_u32 s51, s51, s49
s_mul_i32 s56, s51, 55296
s_add_u32 s56, s56, 255852544
v_lshlrev_b32 v4, 12, v3
v_and_b32 v5, 15, v1
v_lshl_add_u32 v4, v5, 4, v4
s_lshl_b32 s53, s49, 14
s_add_u32 s55, s55, s53
s_lshl_b32 s54, s49, 10
v_lshrrev_b32 v6, 2, v1
v_lshlrev_b32 v6, 8, v6
v_and_b32 v7, 3, v1
v_lshl_add_u32 v6, v7, 3, v6
s_lshl_b32 s51, s49, 6
v_add_u32 v6, s51, v6
v_add_u32 v7, 49152, v6
v_add_u32 v8, 98304, v6
s_add_u32 m0, s54, 0
s_add_u32 s53, s55, 0
buffer_load_dwordx4 v4, s[24:27], s53 offen lds
s_add_u32 m0, s54, 4096
s_add_u32 s53, s55, 65536
buffer_load_dwordx4 v4, s[24:27], s53 offen lds
s_add_u32 m0, s54, 8192
s_add_u32 s53, s55, 131072
buffer_load_dwordx4 v4, s[24:27], s53 offen lds
s_add_u32 m0, s54, 12288
s_add_u32 s53, s55, 196608
buffer_load_dwordx4 v4, s[24:27], s53 offen lds
s_add_u32 m0, s54, 16384
s_add_u32 s53, s55, 262144
buffer_load_dwordx4 v4, s[24:27], s53 offen lds
s_add_u32 m0, s54, 20480
s_add_u32 s53, s55, 327680
buffer_load_dwordx4 v4, s[24:27], s53 offen lds
s_add_u32 m0, s54, 24576
s_add_u32 s53, s55, 393216
buffer_load_dwordx4 v4, s[24:27], s53 offen lds
s_add_u32 m0, s54, 28672
s_add_u32 s53, s55, 458752
buffer_load_dwordx4 v4, s[24:27], s53 offen lds
s_add_u32 m0, s54, 32768
s_add_u32 s53, s55, 524288
buffer_load_dwordx4 v4, s[24:27], s53 offen lds
s_add_u32 m0, s54, 36864
s_add_u32 s53, s55, 589824
buffer_load_dwordx4 v4, s[24:27], s53 offen lds
s_add_u32 m0, s54, 40960
s_add_u32 s53, s55, 655360
buffer_load_dwordx4 v4, s[24:27], s53 offen lds
s_add_u32 m0, s54, 45056
s_add_u32 s53, s55, 720896
buffer_load_dwordx4 v4, s[24:27], s53 offen lds
s_add_u32 m0, s54, 49152
s_add_u32 s53, s55, 786432
buffer_load_dwordx4 v4, s[24:27], s53 offen lds
s_add_u32 m0, s54, 53248
s_add_u32 s53, s55, 851968
buffer_load_dwordx4 v4, s[24:27], s53 offen lds
s_add_u32 m0, s54, 57344
s_add_u32 s53, s55, 917504
buffer_load_dwordx4 v4, s[24:27], s53 offen lds
s_add_u32 m0, s54, 61440
s_add_u32 s53, s55, 983040
buffer_load_dwordx4 v4, s[24:27], s53 offen lds
s_add_u32 m0, s54, 65536
s_add_u32 s53, s55, 1048576
buffer_load_dwordx4 v4, s[24:27], s53 offen lds
s_add_u32 m0, s54, 69632
s_add_u32 s53, s55, 1114112
buffer_load_dwordx4 v4, s[24:27], s53 offen lds
s_add_u32 m0, s54, 73728
s_add_u32 s53, s55, 1179648
buffer_load_dwordx4 v4, s[24:27], s53 offen lds
s_add_u32 m0, s54, 77824
s_add_u32 s53, s55, 1245184
buffer_load_dwordx4 v4, s[24:27], s53 offen lds
s_add_u32 m0, s54, 81920
s_add_u32 s53, s55, 1310720
buffer_load_dwordx4 v4, s[24:27], s53 offen lds
s_add_u32 m0, s54, 86016
s_add_u32 s53, s55, 1376256
buffer_load_dwordx4 v4, s[24:27], s53 offen lds
s_add_u32 m0, s54, 90112
s_add_u32 s53, s55, 1441792
buffer_load_dwordx4 v4, s[24:27], s53 offen lds
s_add_u32 m0, s54, 94208
s_add_u32 s53, s55, 1507328
buffer_load_dwordx4 v4, s[24:27], s53 offen lds
s_add_u32 m0, s54, 98304
s_add_u32 s53, s55, 1572864
buffer_load_dwordx4 v4, s[24:27], s53 offen lds
s_add_u32 m0, s54, 102400
s_add_u32 s53, s55, 1638400
buffer_load_dwordx4 v4, s[24:27], s53 offen lds
s_add_u32 m0, s54, 106496
s_add_u32 s53, s55, 1703936
buffer_load_dwordx4 v4, s[24:27], s53 offen lds
s_add_u32 m0, s54, 110592
s_add_u32 s53, s55, 1769472
buffer_load_dwordx4 v4, s[24:27], s53 offen lds
s_add_u32 m0, s54, 114688
s_add_u32 s53, s55, 1835008
buffer_load_dwordx4 v4, s[24:27], s53 offen lds
s_add_u32 m0, s54, 118784
s_add_u32 s53, s55, 1900544
buffer_load_dwordx4 v4, s[24:27], s53 offen lds
s_add_u32 m0, s54, 122880
s_add_u32 s53, s55, 1966080
buffer_load_dwordx4 v4, s[24:27], s53 offen lds
s_add_u32 m0, s54, 126976
s_add_u32 s53, s55, 2031616
buffer_load_dwordx4 v4, s[24:27], s53 offen lds
s_add_u32 m0, s54, 131072
s_add_u32 s53, s55, 2097152
buffer_load_dwordx4 v4, s[24:27], s53 offen lds
s_add_u32 m0, s54, 135168
s_add_u32 s53, s55, 2162688
buffer_load_dwordx4 v4, s[24:27], s53 offen lds
s_add_u32 m0, s54, 139264
s_add_u32 s53, s55, 2228224
buffer_load_dwordx4 v4, s[24:27], s53 offen lds
s_add_u32 m0, s54, 143360
s_add_u32 s53, s55, 2293760
buffer_load_dwordx4 v4, s[24:27], s53 offen lds
s_waitcnt vmcnt(0) lgkmcnt(0)
s_barrier
ds_read_b64_tr_b16 v[136:137], v6 offset:0
ds_read_b64_tr_b16 v[138:139], v6 offset:4096
ds_read_b64_tr_b16 v[12:13], v6 offset:32
ds_read_b64_tr_b16 v[14:15], v6 offset:4128
ds_read_b64_tr_b16 v[140:141], v6 offset:8192
ds_read_b64_tr_b16 v[142:143], v6 offset:12288
ds_read_b64_tr_b16 v[16:17], v6 offset:8224
ds_read_b64_tr_b16 v[18:19], v6 offset:12320
ds_read_b64_tr_b16 v[144:145], v6 offset:16384
ds_read_b64_tr_b16 v[146:147], v6 offset:20480
ds_read_b64_tr_b16 v[20:21], v6 offset:16416
ds_read_b64_tr_b16 v[22:23], v6 offset:20512
s_waitcnt lgkmcnt(0)
ds_read_b64_tr_b16 v[148:149], v6 offset:24576
ds_read_b64_tr_b16 v[150:151], v6 offset:28672
ds_read_b64_tr_b16 v[24:25], v6 offset:24608
ds_read_b64_tr_b16 v[26:27], v6 offset:28704
ds_read_b64_tr_b16 v[152:153], v6 offset:32768
ds_read_b64_tr_b16 v[154:155], v6 offset:36864
ds_read_b64_tr_b16 v[28:29], v6 offset:32800
ds_read_b64_tr_b16 v[30:31], v6 offset:36896
ds_read_b64_tr_b16 v[156:157], v6 offset:40960
ds_read_b64_tr_b16 v[158:159], v6 offset:45056
ds_read_b64_tr_b16 v[32:33], v6 offset:40992
ds_read_b64_tr_b16 v[34:35], v6 offset:45088
s_waitcnt lgkmcnt(0)
ds_read_b64_tr_b16 v[160:161], v7 offset:0
ds_read_b64_tr_b16 v[162:163], v7 offset:4096
ds_read_b64_tr_b16 v[36:37], v7 offset:32
ds_read_b64_tr_b16 v[38:39], v7 offset:4128
ds_read_b64_tr_b16 v[164:165], v7 offset:8192
ds_read_b64_tr_b16 v[166:167], v7 offset:12288
ds_read_b64_tr_b16 v[40:41], v7 offset:8224
ds_read_b64_tr_b16 v[42:43], v7 offset:12320
ds_read_b64_tr_b16 v[168:169], v7 offset:16384
ds_read_b64_tr_b16 v[170:171], v7 offset:20480
ds_read_b64_tr_b16 v[44:45], v7 offset:16416
ds_read_b64_tr_b16 v[46:47], v7 offset:20512
s_waitcnt lgkmcnt(0)
ds_read_b64_tr_b16 v[172:173], v7 offset:24576
ds_read_b64_tr_b16 v[174:175], v7 offset:28672
ds_read_b64_tr_b16 v[48:49], v7 offset:24608
ds_read_b64_tr_b16 v[50:51], v7 offset:28704
ds_read_b64_tr_b16 v[176:177], v7 offset:32768
ds_read_b64_tr_b16 v[178:179], v7 offset:36864
ds_read_b64_tr_b16 v[52:53], v7 offset:32800
ds_read_b64_tr_b16 v[54:55], v7 offset:36896
ds_read_b64_tr_b16 v[180:181], v7 offset:40960
ds_read_b64_tr_b16 v[182:183], v7 offset:45056
ds_read_b64_tr_b16 v[56:57], v7 offset:40992
ds_read_b64_tr_b16 v[58:59], v7 offset:45088
s_waitcnt lgkmcnt(0)
ds_read_b64_tr_b16 v[184:185], v8 offset:0
ds_read_b64_tr_b16 v[186:187], v8 offset:4096
ds_read_b64_tr_b16 v[60:61], v8 offset:32
ds_read_b64_tr_b16 v[62:63], v8 offset:4128
ds_read_b64_tr_b16 v[188:189], v8 offset:8192
ds_read_b64_tr_b16 v[190:191], v8 offset:12288
ds_read_b64_tr_b16 v[64:65], v8 offset:8224
ds_read_b64_tr_b16 v[66:67], v8 offset:12320
ds_read_b64_tr_b16 v[192:193], v8 offset:16384
ds_read_b64_tr_b16 v[194:195], v8 offset:20480
ds_read_b64_tr_b16 v[68:69], v8 offset:16416
ds_read_b64_tr_b16 v[70:71], v8 offset:20512
s_waitcnt lgkmcnt(0)
ds_read_b64_tr_b16 v[196:197], v8 offset:24576
ds_read_b64_tr_b16 v[198:199], v8 offset:28672
ds_read_b64_tr_b16 v[72:73], v8 offset:24608
ds_read_b64_tr_b16 v[74:75], v8 offset:28704
ds_read_b64_tr_b16 v[200:201], v8 offset:32768
ds_read_b64_tr_b16 v[202:203], v8 offset:36864
ds_read_b64_tr_b16 v[76:77], v8 offset:32800
ds_read_b64_tr_b16 v[78:79], v8 offset:36896
ds_read_b64_tr_b16 v[204:205], v8 offset:40960
ds_read_b64_tr_b16 v[206:207], v8 offset:45056
ds_read_b64_tr_b16 v[80:81], v8 offset:40992
ds_read_b64_tr_b16 v[82:83], v8 offset:45088
s_waitcnt lgkmcnt(0)
s_waitcnt vmcnt(0) lgkmcnt(0)
s_add_u32 s53, s56, 0
buffer_store_dwordx4 v[12:15], v2, s[4:7], s53 offen offset:0 sc1
buffer_store_dwordx4 v[16:19], v2, s[4:7], s53 offen offset:1024 sc1
buffer_store_dwordx4 v[20:23], v2, s[4:7], s53 offen offset:2048 sc1
buffer_store_dwordx4 v[24:27], v2, s[4:7], s53 offen offset:3072 sc1
s_add_u32 s53, s56, 4096
buffer_store_dwordx4 v[28:31], v2, s[4:7], s53 offen offset:0 sc1
buffer_store_dwordx4 v[32:35], v2, s[4:7], s53 offen offset:1024 sc1
buffer_store_dwordx4 v[36:39], v2, s[4:7], s53 offen offset:2048 sc1
buffer_store_dwordx4 v[40:43], v2, s[4:7], s53 offen offset:3072 sc1
s_add_u32 s53, s56, 8192
buffer_store_dwordx4 v[44:47], v2, s[4:7], s53 offen offset:0 sc1
buffer_store_dwordx4 v[48:51], v2, s[4:7], s53 offen offset:1024 sc1
buffer_store_dwordx4 v[52:55], v2, s[4:7], s53 offen offset:2048 sc1
buffer_store_dwordx4 v[56:59], v2, s[4:7], s53 offen offset:3072 sc1
s_add_u32 s53, s56, 12288
buffer_store_dwordx4 v[60:63], v2, s[4:7], s53 offen offset:0 sc1
buffer_store_dwordx4 v[64:67], v2, s[4:7], s53 offen offset:1024 sc1
buffer_store_dwordx4 v[68:71], v2, s[4:7], s53 offen offset:2048 sc1
buffer_store_dwordx4 v[72:75], v2, s[4:7], s53 offen offset:3072 sc1
s_add_u32 s53, s56, 16384
buffer_store_dwordx4 v[76:79], v2, s[4:7], s53 offen offset:0 sc1
buffer_store_dwordx4 v[80:83], v2, s[4:7], s53 offen offset:1024 sc1
s_barrier
s_add_u32 m0, s54, 0
s_add_u32 s53, s55, 2359296
buffer_load_dwordx4 v4, s[24:27], s53 offen lds
s_add_u32 m0, s54, 4096
s_add_u32 s53, s55, 2424832
buffer_load_dwordx4 v4, s[24:27], s53 offen lds
s_add_u32 m0, s54, 8192
s_add_u32 s53, s55, 2490368
buffer_load_dwordx4 v4, s[24:27], s53 offen lds
s_add_u32 m0, s54, 12288
s_add_u32 s53, s55, 2555904
buffer_load_dwordx4 v4, s[24:27], s53 offen lds
s_add_u32 m0, s54, 16384
s_add_u32 s53, s55, 2621440
buffer_load_dwordx4 v4, s[24:27], s53 offen lds
s_add_u32 m0, s54, 20480
s_add_u32 s53, s55, 2686976
buffer_load_dwordx4 v4, s[24:27], s53 offen lds
s_add_u32 m0, s54, 24576
s_add_u32 s53, s55, 2752512
buffer_load_dwordx4 v4, s[24:27], s53 offen lds
s_add_u32 m0, s54, 28672
s_add_u32 s53, s55, 2818048
buffer_load_dwordx4 v4, s[24:27], s53 offen lds
s_add_u32 m0, s54, 32768
s_add_u32 s53, s55, 2883584
buffer_load_dwordx4 v4, s[24:27], s53 offen lds
s_add_u32 m0, s54, 36864
s_add_u32 s53, s55, 2949120
buffer_load_dwordx4 v4, s[24:27], s53 offen lds
s_add_u32 m0, s54, 40960
s_add_u32 s53, s55, 3014656
buffer_load_dwordx4 v4, s[24:27], s53 offen lds
s_add_u32 m0, s54, 45056
s_add_u32 s53, s55, 3080192
buffer_load_dwordx4 v4, s[24:27], s53 offen lds
s_add_u32 m0, s54, 49152
s_add_u32 s53, s55, 3145728
buffer_load_dwordx4 v4, s[24:27], s53 offen lds
s_add_u32 m0, s54, 53248
s_add_u32 s53, s55, 3211264
buffer_load_dwordx4 v4, s[24:27], s53 offen lds
s_add_u32 m0, s54, 57344
s_add_u32 s53, s55, 3276800
buffer_load_dwordx4 v4, s[24:27], s53 offen lds
s_add_u32 m0, s54, 61440
s_add_u32 s53, s55, 3342336
buffer_load_dwordx4 v4, s[24:27], s53 offen lds
s_add_u32 m0, s54, 65536
s_add_u32 s53, s55, 3407872
buffer_load_dwordx4 v4, s[24:27], s53 offen lds
s_add_u32 m0, s54, 69632
s_add_u32 s53, s55, 3473408
buffer_load_dwordx4 v4, s[24:27], s53 offen lds
s_add_u32 m0, s54, 73728
s_add_u32 s53, s55, 3538944
buffer_load_dwordx4 v4, s[24:27], s53 offen lds
s_add_u32 m0, s54, 77824
s_add_u32 s53, s55, 3604480
buffer_load_dwordx4 v4, s[24:27], s53 offen lds
s_add_u32 m0, s54, 81920
s_add_u32 s53, s55, 3670016
buffer_load_dwordx4 v4, s[24:27], s53 offen lds
s_add_u32 m0, s54, 86016
s_add_u32 s53, s55, 3735552
buffer_load_dwordx4 v4, s[24:27], s53 offen lds
s_add_u32 m0, s54, 90112
s_add_u32 s53, s55, 3801088
buffer_load_dwordx4 v4, s[24:27], s53 offen lds
s_add_u32 m0, s54, 94208
s_add_u32 s53, s55, 3866624
buffer_load_dwordx4 v4, s[24:27], s53 offen lds
s_add_u32 m0, s54, 98304
s_add_u32 s53, s55, 3932160
buffer_load_dwordx4 v4, s[24:27], s53 offen lds
s_add_u32 m0, s54, 102400
s_add_u32 s53, s55, 3997696
buffer_load_dwordx4 v4, s[24:27], s53 offen lds
s_add_u32 m0, s54, 106496
s_add_u32 s53, s55, 4063232
buffer_load_dwordx4 v4, s[24:27], s53 offen lds
s_add_u32 m0, s54, 110592
s_add_u32 s53, s55, 4128768
buffer_load_dwordx4 v4, s[24:27], s53 offen lds
s_add_u32 m0, s54, 114688
s_add_u32 s53, s55, 4194304
buffer_load_dwordx4 v4, s[24:27], s53 offen lds
s_add_u32 m0, s54, 118784
s_add_u32 s53, s55, 4259840
buffer_load_dwordx4 v4, s[24:27], s53 offen lds
s_add_u32 m0, s54, 122880
s_add_u32 s53, s55, 4325376
buffer_load_dwordx4 v4, s[24:27], s53 offen lds
s_add_u32 m0, s54, 126976
s_add_u32 s53, s55, 4390912
buffer_load_dwordx4 v4, s[24:27], s53 offen lds
s_add_u32 m0, s54, 131072
s_add_u32 s53, s55, 4456448
buffer_load_dwordx4 v4, s[24:27], s53 offen lds
s_add_u32 m0, s54, 135168
s_add_u32 s53, s55, 4521984
buffer_load_dwordx4 v4, s[24:27], s53 offen lds
s_add_u32 m0, s54, 139264
s_add_u32 s53, s55, 4587520
buffer_load_dwordx4 v4, s[24:27], s53 offen lds
s_add_u32 m0, s54, 143360
s_add_u32 s53, s55, 4653056
buffer_load_dwordx4 v4, s[24:27], s53 offen lds
s_waitcnt vmcnt(0) lgkmcnt(0)
s_barrier
ds_read_b64_tr_b16 v[208:209], v6 offset:0
ds_read_b64_tr_b16 v[210:211], v6 offset:4096
ds_read_b64_tr_b16 v[12:13], v6 offset:32
ds_read_b64_tr_b16 v[14:15], v6 offset:4128
ds_read_b64_tr_b16 v[212:213], v6 offset:8192
ds_read_b64_tr_b16 v[214:215], v6 offset:12288
ds_read_b64_tr_b16 v[16:17], v6 offset:8224
ds_read_b64_tr_b16 v[18:19], v6 offset:12320
ds_read_b64_tr_b16 v[216:217], v6 offset:16384
ds_read_b64_tr_b16 v[218:219], v6 offset:20480
ds_read_b64_tr_b16 v[20:21], v6 offset:16416
ds_read_b64_tr_b16 v[22:23], v6 offset:20512
s_waitcnt lgkmcnt(0)
ds_read_b64_tr_b16 v[220:221], v6 offset:24576
ds_read_b64_tr_b16 v[222:223], v6 offset:28672
ds_read_b64_tr_b16 v[24:25], v6 offset:24608
ds_read_b64_tr_b16 v[26:27], v6 offset:28704
ds_read_b64_tr_b16 v[224:225], v6 offset:32768
ds_read_b64_tr_b16 v[226:227], v6 offset:36864
ds_read_b64_tr_b16 v[28:29], v6 offset:32800
ds_read_b64_tr_b16 v[30:31], v6 offset:36896
ds_read_b64_tr_b16 v[228:229], v6 offset:40960
ds_read_b64_tr_b16 v[230:231], v6 offset:45056
ds_read_b64_tr_b16 v[32:33], v6 offset:40992
ds_read_b64_tr_b16 v[34:35], v6 offset:45088
s_waitcnt lgkmcnt(0)
ds_read_b64_tr_b16 v[232:233], v7 offset:0
ds_read_b64_tr_b16 v[234:235], v7 offset:4096
ds_read_b64_tr_b16 v[36:37], v7 offset:32
ds_read_b64_tr_b16 v[38:39], v7 offset:4128
ds_read_b64_tr_b16 v[236:237], v7 offset:8192
ds_read_b64_tr_b16 v[238:239], v7 offset:12288
ds_read_b64_tr_b16 v[40:41], v7 offset:8224
ds_read_b64_tr_b16 v[42:43], v7 offset:12320
ds_read_b64_tr_b16 v[240:241], v7 offset:16384
ds_read_b64_tr_b16 v[242:243], v7 offset:20480
ds_read_b64_tr_b16 v[44:45], v7 offset:16416
ds_read_b64_tr_b16 v[46:47], v7 offset:20512
s_waitcnt lgkmcnt(0)
ds_read_b64_tr_b16 v[244:245], v7 offset:24576
ds_read_b64_tr_b16 v[246:247], v7 offset:28672
ds_read_b64_tr_b16 v[48:49], v7 offset:24608
ds_read_b64_tr_b16 v[50:51], v7 offset:28704
ds_read_b64_tr_b16 v[248:249], v7 offset:32768
ds_read_b64_tr_b16 v[250:251], v7 offset:36864
ds_read_b64_tr_b16 v[52:53], v7 offset:32800
ds_read_b64_tr_b16 v[54:55], v7 offset:36896
ds_read_b64_tr_b16 v[252:253], v7 offset:40960
ds_read_b64_tr_b16 v[254:255], v7 offset:45056
ds_read_b64_tr_b16 v[56:57], v7 offset:40992
ds_read_b64_tr_b16 v[58:59], v7 offset:45088
s_waitcnt lgkmcnt(0)
ds_read_b64_tr_b16 a[0:1], v8 offset:0
ds_read_b64_tr_b16 a[2:3], v8 offset:4096
ds_read_b64_tr_b16 v[60:61], v8 offset:32
ds_read_b64_tr_b16 v[62:63], v8 offset:4128
ds_read_b64_tr_b16 a[4:5], v8 offset:8192
ds_read_b64_tr_b16 a[6:7], v8 offset:12288
ds_read_b64_tr_b16 v[64:65], v8 offset:8224
ds_read_b64_tr_b16 v[66:67], v8 offset:12320
ds_read_b64_tr_b16 a[8:9], v8 offset:16384
ds_read_b64_tr_b16 a[10:11], v8 offset:20480
ds_read_b64_tr_b16 v[68:69], v8 offset:16416
ds_read_b64_tr_b16 v[70:71], v8 offset:20512
s_waitcnt lgkmcnt(0)
ds_read_b64_tr_b16 a[12:13], v8 offset:24576
ds_read_b64_tr_b16 a[14:15], v8 offset:28672
ds_read_b64_tr_b16 v[72:73], v8 offset:24608
ds_read_b64_tr_b16 v[74:75], v8 offset:28704
ds_read_b64_tr_b16 a[16:17], v8 offset:32768
ds_read_b64_tr_b16 a[18:19], v8 offset:36864
ds_read_b64_tr_b16 v[76:77], v8 offset:32800
ds_read_b64_tr_b16 v[78:79], v8 offset:36896
ds_read_b64_tr_b16 a[20:21], v8 offset:40960
ds_read_b64_tr_b16 a[22:23], v8 offset:45056
ds_read_b64_tr_b16 v[80:81], v8 offset:40992
ds_read_b64_tr_b16 v[82:83], v8 offset:45088
s_waitcnt lgkmcnt(0)
s_waitcnt vmcnt(0) lgkmcnt(0)
s_add_u32 s53, s56, 18432
buffer_store_dwordx4 v[12:15], v2, s[4:7], s53 offen offset:0 sc1
buffer_store_dwordx4 v[16:19], v2, s[4:7], s53 offen offset:1024 sc1
buffer_store_dwordx4 v[20:23], v2, s[4:7], s53 offen offset:2048 sc1
buffer_store_dwordx4 v[24:27], v2, s[4:7], s53 offen offset:3072 sc1
s_add_u32 s53, s56, 22528
buffer_store_dwordx4 v[28:31], v2, s[4:7], s53 offen offset:0 sc1
buffer_store_dwordx4 v[32:35], v2, s[4:7], s53 offen offset:1024 sc1
buffer_store_dwordx4 v[36:39], v2, s[4:7], s53 offen offset:2048 sc1
buffer_store_dwordx4 v[40:43], v2, s[4:7], s53 offen offset:3072 sc1
s_add_u32 s53, s56, 26624
buffer_store_dwordx4 v[44:47], v2, s[4:7], s53 offen offset:0 sc1
buffer_store_dwordx4 v[48:51], v2, s[4:7], s53 offen offset:1024 sc1
buffer_store_dwordx4 v[52:55], v2, s[4:7], s53 offen offset:2048 sc1
buffer_store_dwordx4 v[56:59], v2, s[4:7], s53 offen offset:3072 sc1
s_add_u32 s53, s56, 30720
buffer_store_dwordx4 v[60:63], v2, s[4:7], s53 offen offset:0 sc1
buffer_store_dwordx4 v[64:67], v2, s[4:7], s53 offen offset:1024 sc1
buffer_store_dwordx4 v[68:71], v2, s[4:7], s53 offen offset:2048 sc1
buffer_store_dwordx4 v[72:75], v2, s[4:7], s53 offen offset:3072 sc1
s_add_u32 s53, s56, 34816
buffer_store_dwordx4 v[76:79], v2, s[4:7], s53 offen offset:0 sc1
buffer_store_dwordx4 v[80:83], v2, s[4:7], s53 offen offset:1024 sc1
s_barrier
s_add_u32 m0, s54, 0
s_add_u32 s53, s55, 4718592
buffer_load_dwordx4 v4, s[24:27], s53 offen lds
s_add_u32 m0, s54, 4096
s_add_u32 s53, s55, 4784128
buffer_load_dwordx4 v4, s[24:27], s53 offen lds
s_add_u32 m0, s54, 8192
s_add_u32 s53, s55, 4849664
buffer_load_dwordx4 v4, s[24:27], s53 offen lds
s_add_u32 m0, s54, 12288
s_add_u32 s53, s55, 4915200
buffer_load_dwordx4 v4, s[24:27], s53 offen lds
s_add_u32 m0, s54, 16384
s_add_u32 s53, s55, 4980736
buffer_load_dwordx4 v4, s[24:27], s53 offen lds
s_add_u32 m0, s54, 20480
s_add_u32 s53, s55, 5046272
buffer_load_dwordx4 v4, s[24:27], s53 offen lds
s_add_u32 m0, s54, 24576
s_add_u32 s53, s55, 5111808
buffer_load_dwordx4 v4, s[24:27], s53 offen lds
s_add_u32 m0, s54, 28672
s_add_u32 s53, s55, 5177344
buffer_load_dwordx4 v4, s[24:27], s53 offen lds
s_add_u32 m0, s54, 32768
s_add_u32 s53, s55, 5242880
buffer_load_dwordx4 v4, s[24:27], s53 offen lds
s_add_u32 m0, s54, 36864
s_add_u32 s53, s55, 5308416
buffer_load_dwordx4 v4, s[24:27], s53 offen lds
s_add_u32 m0, s54, 40960
s_add_u32 s53, s55, 5373952
buffer_load_dwordx4 v4, s[24:27], s53 offen lds
s_add_u32 m0, s54, 45056
s_add_u32 s53, s55, 5439488
buffer_load_dwordx4 v4, s[24:27], s53 offen lds
s_add_u32 m0, s54, 49152
s_add_u32 s53, s55, 5505024
buffer_load_dwordx4 v4, s[24:27], s53 offen lds
s_add_u32 m0, s54, 53248
s_add_u32 s53, s55, 5570560
buffer_load_dwordx4 v4, s[24:27], s53 offen lds
s_add_u32 m0, s54, 57344
s_add_u32 s53, s55, 5636096
buffer_load_dwordx4 v4, s[24:27], s53 offen lds
s_add_u32 m0, s54, 61440
s_add_u32 s53, s55, 5701632
buffer_load_dwordx4 v4, s[24:27], s53 offen lds
s_add_u32 m0, s54, 65536
s_add_u32 s53, s55, 5767168
buffer_load_dwordx4 v4, s[24:27], s53 offen lds
s_add_u32 m0, s54, 69632
s_add_u32 s53, s55, 5832704
buffer_load_dwordx4 v4, s[24:27], s53 offen lds
s_add_u32 m0, s54, 73728
s_add_u32 s53, s55, 5898240
buffer_load_dwordx4 v4, s[24:27], s53 offen lds
s_add_u32 m0, s54, 77824
s_add_u32 s53, s55, 5963776
buffer_load_dwordx4 v4, s[24:27], s53 offen lds
s_add_u32 m0, s54, 81920
s_add_u32 s53, s55, 6029312
buffer_load_dwordx4 v4, s[24:27], s53 offen lds
s_add_u32 m0, s54, 86016
s_add_u32 s53, s55, 6094848
buffer_load_dwordx4 v4, s[24:27], s53 offen lds
s_add_u32 m0, s54, 90112
s_add_u32 s53, s55, 6160384
buffer_load_dwordx4 v4, s[24:27], s53 offen lds
s_add_u32 m0, s54, 94208
s_add_u32 s53, s55, 6225920
buffer_load_dwordx4 v4, s[24:27], s53 offen lds
s_add_u32 m0, s54, 98304
s_add_u32 s53, s55, 6291456
buffer_load_dwordx4 v4, s[24:27], s53 offen lds
s_add_u32 m0, s54, 102400
s_add_u32 s53, s55, 6356992
buffer_load_dwordx4 v4, s[24:27], s53 offen lds
s_add_u32 m0, s54, 106496
s_add_u32 s53, s55, 6422528
buffer_load_dwordx4 v4, s[24:27], s53 offen lds
s_add_u32 m0, s54, 110592
s_add_u32 s53, s55, 6488064
buffer_load_dwordx4 v4, s[24:27], s53 offen lds
s_add_u32 m0, s54, 114688
s_add_u32 s53, s55, 6553600
buffer_load_dwordx4 v4, s[24:27], s53 offen lds
s_add_u32 m0, s54, 118784
s_add_u32 s53, s55, 6619136
buffer_load_dwordx4 v4, s[24:27], s53 offen lds
s_add_u32 m0, s54, 122880
s_add_u32 s53, s55, 6684672
buffer_load_dwordx4 v4, s[24:27], s53 offen lds
s_add_u32 m0, s54, 126976
s_add_u32 s53, s55, 6750208
buffer_load_dwordx4 v4, s[24:27], s53 offen lds
s_add_u32 m0, s54, 131072
s_add_u32 s53, s55, 6815744
buffer_load_dwordx4 v4, s[24:27], s53 offen lds
s_add_u32 m0, s54, 135168
s_add_u32 s53, s55, 6881280
buffer_load_dwordx4 v4, s[24:27], s53 offen lds
s_add_u32 m0, s54, 139264
s_add_u32 s53, s55, 6946816
buffer_load_dwordx4 v4, s[24:27], s53 offen lds
s_add_u32 m0, s54, 143360
s_add_u32 s53, s55, 7012352
buffer_load_dwordx4 v4, s[24:27], s53 offen lds
s_waitcnt vmcnt(0) lgkmcnt(0)
s_barrier
ds_read_b64_tr_b16 a[24:25], v6 offset:0
ds_read_b64_tr_b16 a[26:27], v6 offset:4096
ds_read_b64_tr_b16 v[12:13], v6 offset:32
ds_read_b64_tr_b16 v[14:15], v6 offset:4128
ds_read_b64_tr_b16 a[28:29], v6 offset:8192
ds_read_b64_tr_b16 a[30:31], v6 offset:12288
ds_read_b64_tr_b16 v[16:17], v6 offset:8224
ds_read_b64_tr_b16 v[18:19], v6 offset:12320
ds_read_b64_tr_b16 a[32:33], v6 offset:16384
ds_read_b64_tr_b16 a[34:35], v6 offset:20480
ds_read_b64_tr_b16 v[20:21], v6 offset:16416
ds_read_b64_tr_b16 v[22:23], v6 offset:20512
s_waitcnt lgkmcnt(0)
ds_read_b64_tr_b16 a[36:37], v6 offset:24576
ds_read_b64_tr_b16 a[38:39], v6 offset:28672
ds_read_b64_tr_b16 v[24:25], v6 offset:24608
ds_read_b64_tr_b16 v[26:27], v6 offset:28704
ds_read_b64_tr_b16 a[40:41], v6 offset:32768
ds_read_b64_tr_b16 a[42:43], v6 offset:36864
ds_read_b64_tr_b16 v[28:29], v6 offset:32800
ds_read_b64_tr_b16 v[30:31], v6 offset:36896
ds_read_b64_tr_b16 a[44:45], v6 offset:40960
ds_read_b64_tr_b16 a[46:47], v6 offset:45056
ds_read_b64_tr_b16 v[32:33], v6 offset:40992
ds_read_b64_tr_b16 v[34:35], v6 offset:45088
s_waitcnt lgkmcnt(0)
ds_read_b64_tr_b16 a[48:49], v7 offset:0
ds_read_b64_tr_b16 a[50:51], v7 offset:4096
ds_read_b64_tr_b16 v[36:37], v7 offset:32
ds_read_b64_tr_b16 v[38:39], v7 offset:4128
ds_read_b64_tr_b16 a[52:53], v7 offset:8192
ds_read_b64_tr_b16 a[54:55], v7 offset:12288
ds_read_b64_tr_b16 v[40:41], v7 offset:8224
ds_read_b64_tr_b16 v[42:43], v7 offset:12320
ds_read_b64_tr_b16 a[56:57], v7 offset:16384
ds_read_b64_tr_b16 a[58:59], v7 offset:20480
ds_read_b64_tr_b16 v[44:45], v7 offset:16416
ds_read_b64_tr_b16 v[46:47], v7 offset:20512
s_waitcnt lgkmcnt(0)
ds_read_b64_tr_b16 a[60:61], v7 offset:24576
ds_read_b64_tr_b16 a[62:63], v7 offset:28672
ds_read_b64_tr_b16 v[48:49], v7 offset:24608
ds_read_b64_tr_b16 v[50:51], v7 offset:28704
ds_read_b64_tr_b16 a[64:65], v7 offset:32768
ds_read_b64_tr_b16 a[66:67], v7 offset:36864
ds_read_b64_tr_b16 v[52:53], v7 offset:32800
ds_read_b64_tr_b16 v[54:55], v7 offset:36896
ds_read_b64_tr_b16 a[68:69], v7 offset:40960
ds_read_b64_tr_b16 a[70:71], v7 offset:45056
ds_read_b64_tr_b16 v[56:57], v7 offset:40992
ds_read_b64_tr_b16 v[58:59], v7 offset:45088
s_waitcnt lgkmcnt(0)
ds_read_b64_tr_b16 a[72:73], v8 offset:0
ds_read_b64_tr_b16 a[74:75], v8 offset:4096
ds_read_b64_tr_b16 v[60:61], v8 offset:32
ds_read_b64_tr_b16 v[62:63], v8 offset:4128
ds_read_b64_tr_b16 a[76:77], v8 offset:8192
ds_read_b64_tr_b16 a[78:79], v8 offset:12288
ds_read_b64_tr_b16 v[64:65], v8 offset:8224
ds_read_b64_tr_b16 v[66:67], v8 offset:12320
ds_read_b64_tr_b16 a[80:81], v8 offset:16384
ds_read_b64_tr_b16 a[82:83], v8 offset:20480
ds_read_b64_tr_b16 v[68:69], v8 offset:16416
ds_read_b64_tr_b16 v[70:71], v8 offset:20512
s_waitcnt lgkmcnt(0)
ds_read_b64_tr_b16 a[84:85], v8 offset:24576
ds_read_b64_tr_b16 a[86:87], v8 offset:28672
ds_read_b64_tr_b16 v[72:73], v8 offset:24608
ds_read_b64_tr_b16 v[74:75], v8 offset:28704
ds_read_b64_tr_b16 a[88:89], v8 offset:32768
ds_read_b64_tr_b16 a[90:91], v8 offset:36864
ds_read_b64_tr_b16 v[76:77], v8 offset:32800
ds_read_b64_tr_b16 v[78:79], v8 offset:36896
ds_read_b64_tr_b16 a[92:93], v8 offset:40960
ds_read_b64_tr_b16 a[94:95], v8 offset:45056
ds_read_b64_tr_b16 v[80:81], v8 offset:40992
ds_read_b64_tr_b16 v[82:83], v8 offset:45088
s_waitcnt lgkmcnt(0)
s_waitcnt vmcnt(0) lgkmcnt(0)
s_add_u32 s53, s56, 36864
buffer_store_dwordx4 v[12:15], v2, s[4:7], s53 offen offset:0 sc1
buffer_store_dwordx4 v[16:19], v2, s[4:7], s53 offen offset:1024 sc1
buffer_store_dwordx4 v[20:23], v2, s[4:7], s53 offen offset:2048 sc1
buffer_store_dwordx4 v[24:27], v2, s[4:7], s53 offen offset:3072 sc1
s_add_u32 s53, s56, 40960
buffer_store_dwordx4 v[28:31], v2, s[4:7], s53 offen offset:0 sc1
buffer_store_dwordx4 v[32:35], v2, s[4:7], s53 offen offset:1024 sc1
buffer_store_dwordx4 v[36:39], v2, s[4:7], s53 offen offset:2048 sc1
buffer_store_dwordx4 v[40:43], v2, s[4:7], s53 offen offset:3072 sc1
s_add_u32 s53, s56, 45056
buffer_store_dwordx4 v[44:47], v2, s[4:7], s53 offen offset:0 sc1
buffer_store_dwordx4 v[48:51], v2, s[4:7], s53 offen offset:1024 sc1
buffer_store_dwordx4 v[52:55], v2, s[4:7], s53 offen offset:2048 sc1
buffer_store_dwordx4 v[56:59], v2, s[4:7], s53 offen offset:3072 sc1
s_add_u32 s53, s56, 49152
buffer_store_dwordx4 v[60:63], v2, s[4:7], s53 offen offset:0 sc1
buffer_store_dwordx4 v[64:67], v2, s[4:7], s53 offen offset:1024 sc1
buffer_store_dwordx4 v[68:71], v2, s[4:7], s53 offen offset:2048 sc1
buffer_store_dwordx4 v[72:75], v2, s[4:7], s53 offen offset:3072 sc1
s_add_u32 s53, s56, 53248
buffer_store_dwordx4 v[76:79], v2, s[4:7], s53 offen offset:0 sc1
buffer_store_dwordx4 v[80:83], v2, s[4:7], s53 offen offset:1024 sc1
s_barrier
s_waitcnt vmcnt(0) lgkmcnt(0)
GW_NOW2:
v_mov_b64 v[104:105], 0
v_mov_b64 v[106:107], 0
v_mov_b64 v[108:109], 0
v_mov_b64 v[110:111], 0
v_mov_b64 v[112:113], 0
v_mov_b64 v[114:115], 0
v_mov_b64 v[116:117], 0
v_mov_b64 v[118:119], 0
v_mov_b64 v[120:121], 0
v_mov_b64 v[122:123], 0
v_mov_b64 v[124:125], 0
v_mov_b64 v[126:127], 0
v_mov_b64 v[128:129], 0
v_mov_b64 v[130:131], 0
v_mov_b64 v[132:133], 0
v_mov_b64 v[134:135], 0
s_mov_b32 s71, 0
GW_SEG:
s_mul_i32 s51, s71, 43
s_lshr_b32 s51, s51, 8
s_mul_i32 s51, s51, 6
s_sub_u32 s51, s71, s51
s_sub_u32 s52, s48, 140
s_and_b32 s57, s52, 7
s_lshr_b32 s52, s52, 3
s_cmp_lg_u32 s51, s52
s_cbranch_scc1 GW_NORED
v_and_b32 v98, 7, v1
v_lshrrev_b32 v99, 1, v98
v_and_b32 v98, 1, v98
v_lshlrev_b32 v98, 4, v98
v_mov_b32 v100, 0x3f80
v_lshlrev_b32 v98, v98, v100
s_mov_b32 s51, 0xff00ff00
s_mov_b32 s52, 0xff00ff00
s_mov_b32 s53, 0xff00ff00
v_cmp_eq_u32 vcc, 0, v99
s_nop 1
v_cndmask_b32 v80, 0, v98, vcc
v_cndmask_b32 v84, 0, v80, s[52:53]
v_cndmask_b32 v80, v80, 0, s[52:53]
v_cmp_eq_u32 vcc, 1, v99
s_nop 1
v_cndmask_b32 v81, 0, v98, vcc
v_cndmask_b32 v85, 0, v81, s[52:53]
v_cndmask_b32 v81, v81, 0, s[52:53]
v_cmp_eq_u32 vcc, 2, v99
s_nop 1
v_cndmask_b32 v82, 0, v98, vcc
v_cndmask_b32 v86, 0, v82, s[52:53]
v_cndmask_b32 v82, v82, 0, s[52:53]
v_cmp_eq_u32 vcc, 3, v99
s_nop 1
v_cndmask_b32 v83, 0, v98, vcc
v_cndmask_b32 v87, 0, v83, s[52:53]
v_cndmask_b32 v83, v83, 0, s[52:53]
s_mov_b32 s51, 40960
v_mul_lo_u32 v98, v3, s51
v_and_b32 v99, 15, v1
v_lshl_add_u32 v98, v99, 4, v98
s_lshl_b32 s54, s50, 6
s_add_u32 s54, s54, s71
s_mul_i32 s54, s54, 655360
s_mul_i32 s51, s57, 5120
s_add_u32 s54, s54, s51
s_mul_i32 s51, s49, 1280
s_add_u32 s54, s54, s51
s_add_u32 s54, s54, 171966464
v_and_b32 v102, 3, v1
v_bfe_u32 v101, v1, 2, 2
v_mul_u32_u24 v100, 1280, v102
v_lshl_add_u32 v100, v101, 4, v100
v_lshlrev_b32 v103, 8, v101
v_lshl_add_u32 v103, v102, 4, v103
v_and_b32 v99, 1, v3
v_lshl_add_u32 v100, v99, 3, v100
v_lshl_add_u32 v103, v99, 3, v103
v_lshrrev_b32 v99, 1, v3
v_lshl_add_u32 v100, v99, 6, v100
v_lshl_add_u32 v103, v99, 10, v103
v_lshlrev_b32 v102, 4, v102
s_lshl_b32 s51, s49, 2
v_add_u32 v101, s51, v102
s_lshl_b32 s51, s71, 3
s_add_u32 s51, s51, s57
s_mul_i32 s55, s51, 5120
s_mul_i32 s56, s49, 320
s_add_u32 s55, s55, s56
s_lshr_b32 s56, s51, 2
s_mul_i32 s56, s56, 20480
s_and_b32 s51, s51, 3
s_lshl_b32 s51, s51, 6
s_add_u32 s56, s56, s51
s_mul_i32 s51, s49, 5120
s_add_u32 s56, s56, s51
s_lshl_b32 s60, s50, 6
s_add_u32 s60, s60, s71
s_lshl_b32 s60, s60, 7
s_add_u32 s60, s60, 16384
s_cmp_lg_u32 s49, 0
s_cbranch_scc1 WFOK_26
v_min_u32 v88, 0, v1
v_lshlrev_b32 v88, 2, v88
s_mov_b32 s69, 0
WF_25:
buffer_load_dword v89, v88, s[4:7], s60 offen sc1
s_add_u32 s69, s69, 1
s_cmp_gt_u32 s69, 131072
s_cbranch_scc1 ABORT
s_waitcnt vmcnt(0)
v_cmp_gt_u32 vcc, 16, v89
s_cbranch_vccz WFOK_26
s_sleep 2
s_branch WF_25
WFOK_26:
s_barrier
s_add_u32 s61, s54, 0
buffer_load_dwordx4 v[4:7], v98, s[4:7], s61 offen offset:0 sc1
buffer_load_dwordx4 v[8:11], v98, s[4:7], s61 offen offset:256 sc1
buffer_load_dwordx4 v[12:15], v98, s[4:7], s61 offen offset:512 sc1
buffer_load_dwordx4 v[16:19], v98, s[4:7], s61 offen offset:768 sc1
buffer_load_dwordx4 v[20:23], v98, s[4:7], s61 offen offset:1024 sc1
s_add_u32 s61, s54, 163840
buffer_load_dwordx4 v[24:27], v98, s[4:7], s61 offen offset:0 sc1
buffer_load_dwordx4 v[28:31], v98, s[4:7], s61 offen offset:256 sc1
buffer_load_dwordx4 v[32:35], v98, s[4:7], s61 offen offset:512 sc1
buffer_load_dwordx4 v[36:39], v98, s[4:7], s61 offen offset:768 sc1
buffer_load_dwordx4 v[40:43], v98, s[4:7], s61 offen offset:1024 sc1
s_add_u32 s61, s54, 327680
buffer_load_dwordx4 v[44:47], v98, s[4:7], s61 offen offset:0 sc1
buffer_load_dwordx4 v[48:51], v98, s[4:7], s61 offen offset:256 sc1
buffer_load_dwordx4 v[52:55], v98, s[4:7], s61 offen offset:512 sc1
buffer_load_dwordx4 v[56:59], v98, s[4:7], s61 offen offset:768 sc1
buffer_load_dwordx4 v[60:63], v98, s[4:7], s61 offen offset:1024 sc1
s_add_u32 s61, s54, 491520
buffer_load_dwordx4 v[64:67], v98, s[4:7], s61 offen offset:0 sc1
s_waitcnt vmcnt(15)
v_mfma_f32_16x16x32_bf16 v[68:71], v[80:83], v[4:7], 0
buffer_load_dwordx4 v[4:7], v98, s[4:7], s61 offen offset:256 sc1
s_waitcnt vmcnt(15)
v_mfma_f32_16x16x32_bf16 v[68:71], v[84:87], v[8:11], v[68:71]
buffer_load_dwordx4 v[8:11], v98, s[4:7], s61 offen offset:512 sc1
s_waitcnt vmcnt(15)
v_mfma_f32_16x16x32_bf16 v[72:75], v[80:83], v[12:15], 0
buffer_load_dwordx4 v[12:15], v98, s[4:7], s61 offen offset:768 sc1
s_waitcnt vmcnt(15)
v_mfma_f32_16x16x32_bf16 v[72:75], v[84:87], v[16:19], v[72:75]
buffer_load_dwordx4 v[16:19], v98, s[4:7], s61 offen offset:1024 sc1
s_waitcnt vmcnt(15)
v_mfma_f32_16x16x32_bf16 v[76:79], v[80:83], v[20:23], 0
s_waitcnt vmcnt(14)
v_mfma_f32_16x16x32_bf16 v[68:71], v[80:83], v[24:27], v[68:71]
s_waitcnt vmcnt(13)
v_mfma_f32_16x16x32_bf16 v[68:71], v[84:87], v[28:31], v[68:71]
s_waitcnt vmcnt(12)
v_mfma_f32_16x16x32_bf16 v[72:75], v[80:83], v[32:35], v[72:75]
s_waitcnt vmcnt(11)
v_mfma_f32_16x16x32_bf16 v[72:75], v[84:87], v[36:39], v[72:75]
s_waitcnt vmcnt(10)
v_mfma_f32_16x16x32_bf16 v[76:79], v[80:83], v[40:43], v[76:79]
s_waitcnt vmcnt(9)
v_mfma_f32_16x16x32_bf16 v[68:71], v[80:83], v[44:47], v[68:71]
s_waitcnt vmcnt(8)
v_mfma_f32_16x16x32_bf16 v[68:71], v[84:87], v[48:51], v[68:71]
s_waitcnt vmcnt(7)
v_mfma_f32_16x16x32_bf16 v[72:75], v[80:83], v[52:55], v[72:75]
s_waitcnt vmcnt(6)
v_mfma_f32_16x16x32_bf16 v[72:75], v[84:87], v[56:59], v[72:75]
s_waitcnt vmcnt(5)
v_mfma_f32_16x16x32_bf16 v[76:79], v[80:83], v[60:63], v[76:79]
s_waitcnt vmcnt(4)
v_mfma_f32_16x16x32_bf16 v[68:71], v[80:83], v[64:67], v[68:71]
s_waitcnt vmcnt(3)
v_mfma_f32_16x16x32_bf16 v[68:71], v[84:87], v[4:7], v[68:71]
s_waitcnt vmcnt(2)
v_mfma_f32_16x16x32_bf16 v[72:75], v[80:83], v[8:11], v[72:75]
s_waitcnt vmcnt(1)
v_mfma_f32_16x16x32_bf16 v[72:75], v[84:87], v[12:15], v[72:75]
s_waitcnt vmcnt(0)
v_mfma_f32_16x16x32_bf16 v[76:79], v[80:83], v[16:19], v[76:79]
v_mov_b32 v90, 0x40000000
v_cndmask_b32 v98, v90, v100, s[66:67]
v_cndmask_b32 v99, v90, v103, s[66:67]
s_cmp_lg_u32 s50, 0
s_cbranch_scc1 REDL1_27
buffer_load_dwordx2 v[4:5], v100, s[12:15], s55 offen offset:0
buffer_load_dwordx2 v[6:7], v100, s[12:15], s55 offen offset:128
buffer_load_dwordx2 v[8:9], v98, s[12:15], s55 offen offset:256
s_branch REDJ_28
REDL1_27:
s_add_u32 s51, s56, 150994944
s_add_u32 s61, s51, 4096
buffer_load_dwordx2 v[4:5], v103, s[4:7], s51 offen offset:0 sc1
buffer_load_dwordx2 v[6:7], v103, s[4:7], s51 offen offset:2048 sc1
buffer_load_dwordx2 v[8:9], v99, s[4:7], s61 offen offset:0 sc1
REDJ_28:
v_cvt_pk_bf16_f32 v24, v68, v69
v_cvt_pk_bf16_f32 v25, v70, v71
v_cvt_pk_bf16_f32 v26, v72, v73
v_cvt_pk_bf16_f32 v27, v74, v75
v_cvt_pk_bf16_f32 v28, v76, v77
v_cvt_pk_bf16_f32 v29, v78, v79
v_and_b32 v69, 0xffff0000, v24
v_lshlrev_b32 v68, 16, v24
v_and_b32 v71, 0xffff0000, v25
v_lshlrev_b32 v70, 16, v25
v_and_b32 v73, 0xffff0000, v26
v_lshlrev_b32 v72, 16, v26
v_and_b32 v75, 0xffff0000, v27
v_lshlrev_b32 v74, 16, v27
v_and_b32 v77, 0xffff0000, v28
v_lshlrev_b32 v76, 16, v28
v_and_b32 v79, 0xffff0000, v29
v_lshlrev_b32 v78, 16, v29
s_waitcnt vmcnt(0) lgkmcnt(0)
v_and_b32 v13, 0xffff0000, v4
v_lshlrev_b32 v12, 16, v4
v_and_b32 v15, 0xffff0000, v5
v_lshlrev_b32 v14, 16, v5
v_and_b32 v17, 0xffff0000, v6
v_lshlrev_b32 v16, 16, v6
v_and_b32 v19, 0xffff0000, v7
v_lshlrev_b32 v18, 16, v7
v_and_b32 v21, 0xffff0000, v8
v_lshlrev_b32 v20, 16, v8
v_and_b32 v23, 0xffff0000, v9
v_lshlrev_b32 v22, 16, v9
v_pk_add_f32 v[12:13], v[12:13], v[68:69]
v_pk_add_f32 v[14:15], v[14:15], v[70:71]
v_pk_add_f32 v[16:17], v[16:17], v[72:73]
v_pk_add_f32 v[18:19], v[18:19], v[74:75]
v_pk_add_f32 v[20:21], v[20:21], v[76:77]
v_pk_add_f32 v[22:23], v[22:23], v[78:79]
v_cvt_pk_bf16_f32 v24, v12, v13
v_cvt_pk_bf16_f32 v25, v14, v15
v_cvt_pk_bf16_f32 v26, v16, v17
v_cvt_pk_bf16_f32 v27, v18, v19
v_cvt_pk_bf16_f32 v28, v20, v21
v_cvt_pk_bf16_f32 v29, v22, v23
s_mul_i32 s51, s50, 2621440
s_add_u32 s61, s51, s56
s_add_u32 s61, s61, 142606336
s_add_u32 s62, s61, 4096
s_add_u32 s55, s55, s51
s_add_u32 s55, s55, 155189248
buffer_store_dwordx2 v[24:25], v103, s[4:7], s61 offen offset:0 sc1
buffer_store_dwordx2 v[26:27], v103, s[4:7], s61 offen offset:2048 sc1
buffer_store_dwordx2 v[28:29], v99, s[4:7], s62 offen offset:0 sc1
v_and_b32 v13, 0xffff0000, v24
v_lshlrev_b32 v12, 16, v24
v_and_b32 v15, 0xffff0000, v25
v_lshlrev_b32 v14, 16, v25
v_and_b32 v17, 0xffff0000, v26
v_lshlrev_b32 v16, 16, v26
v_and_b32 v19, 0xffff0000, v27
v_lshlrev_b32 v18, 16, v27
v_and_b32 v21, 0xffff0000, v28
v_lshlrev_b32 v20, 16, v28
v_and_b32 v23, 0xffff0000, v29
v_lshlrev_b32 v22, 16, v29
v_pk_add_f32 v[88:89], v[12:13], v[14:15]
v_pk_add_f32 v[88:89], v[88:89], v[16:17]
v_pk_add_f32 v[88:89], v[88:89], v[18:19]
v_pk_add_f32 v[88:89], v[88:89], v[20:21]
v_pk_add_f32 v[88:89], v[88:89], v[22:23]
v_add_f32 v88, v88, v89
s_nop 1
v_add_f32_dpp v88, v88, v88 row_ror:4 row_mask:0xf bank_mask:0xf
s_nop 1
v_add_f32_dpp v88, v88, v88 row_ror:8 row_mask:0xf bank_mask:0xf
v_mov_b32 v89, v88
s_nop 1
v_permlane32_swap_b32 v88, v89
v_add_f32 v88, v88, v89
v_mov_b32 v89, v88
s_nop 1
v_permlane16_swap_b32 v88, v89
v_add_f32 v88, v88, v89
ds_write_b32 v101, v88 offset:0
s_waitcnt lgkmcnt(0)
s_barrier
ds_read_b128 v[90:93], v102 offset:0
s_waitcnt lgkmcnt(0)
v_add_f32 v88, v90, v91
v_add_f32 v92, v92, v93
v_add_f32 v88, v88, v92
v_mul_f32 v94, 0xbacccccd, v88
v_mov_b32 v95, v94
v_pk_add_f32 v[12:13], v[12:13], v[94:95]
v_pk_add_f32 v[14:15], v[14:15], v[94:95]
v_pk_add_f32 v[16:17], v[16:17], v[94:95]
v_pk_add_f32 v[18:19], v[18:19], v[94:95]
v_pk_add_f32 v[20:21], v[20:21], v[94:95]
v_pk_add_f32 v[22:23], v[22:23], v[94:95]
v_cndmask_b32 v20, 0, v20, s[66:67]
v_cndmask_b32 v21, 0, v21, s[66:67]
v_cndmask_b32 v22, 0, v22, s[66:67]
v_cndmask_b32 v23, 0, v23, s[66:67]
v_pk_mul_f32 v[88:89], v[12:13], v[12:13]
v_pk_fma_f32 v[88:89], v[14:15], v[14:15], v[88:89]
v_pk_fma_f32 v[88:89], v[16:17], v[16:17], v[88:89]
v_pk_fma_f32 v[88:89], v[18:19], v[18:19], v[88:89]
v_pk_fma_f32 v[88:89], v[20:21], v[20:21], v[88:89]
v_pk_fma_f32 v[88:89], v[22:23], v[22:23], v[88:89]
v_add_f32 v88, v88, v89
s_nop 1
v_add_f32_dpp v88, v88, v88 row_ror:4 row_mask:0xf bank_mask:0xf
s_nop 1
v_add_f32_dpp v88, v88, v88 row_ror:8 row_mask:0xf bank_mask:0xf
v_mov_b32 v89, v88
s_nop 1
v_permlane32_swap_b32 v88, v89
v_add_f32 v88, v88, v89
v_mov_b32 v89, v88
s_nop 1
v_permlane16_swap_b32 v88, v89
v_add_f32 v88, v88, v89
ds_write_b32 v101, v88 offset:256
s_waitcnt lgkmcnt(0)
s_barrier
ds_read_b128 v[90:93], v102 offset:256
s_waitcnt lgkmcnt(0)
v_add_f32 v88, v90, v91
v_add_f32 v92, v92, v93
v_add_f32 v88, v88, v92
v_mul_f32 v88, 0x3acccccd, v88
v_cvt_pk_bf16_f32 v88, v88, v88
v_and_b32 v88, 0xffff0000, v88
v_add_f32 v88, 0x3727c5ac, v88
v_cvt_pk_bf16_f32 v88, v88, v88
v_and_b32 v88, 0xffff0000, v88
v_sqrt_f32 v88, v88
v_cvt_pk_bf16_f32 v89, v94, v94
v_and_b32 v89, 0xffff0000, v89
v_cvt_pk_bf16_f32 v88, v88, v88
v_and_b32 v88, 0xffff0000, v88
v_rcp_f32 v96, v88
v_sub_f32 v89, v89, v94
v_mov_b32 v97, v96
v_mul_f32 v94, v89, v96
v_mov_b32 v95, v94
v_pk_fma_f32 v[12:13], v[12:13], v[96:97], v[94:95]
v_pk_fma_f32 v[14:15], v[14:15], v[96:97], v[94:95]
v_pk_fma_f32 v[16:17], v[16:17], v[96:97], v[94:95]
v_pk_fma_f32 v[18:19], v[18:19], v[96:97], v[94:95]
v_pk_fma_f32 v[20:21], v[20:21], v[96:97], v[94:95]
v_pk_fma_f32 v[22:23], v[22:23], v[96:97], v[94:95]
v_cndmask_b32 v20, 0, v20, s[66:67]
v_cndmask_b32 v21, 0, v21, s[66:67]
v_cndmask_b32 v22, 0, v22, s[66:67]
v_cndmask_b32 v23, 0, v23, s[66:67]
v_cvt_pk_bf16_f32 v30, v12, v13
v_cvt_pk_bf16_f32 v31, v14, v15
v_cvt_pk_bf16_f32 v32, v16, v17
v_cvt_pk_bf16_f32 v33, v18, v19
v_cvt_pk_bf16_f32 v34, v20, v21
v_cvt_pk_bf16_f32 v35, v22, v23
v_and_b32 v13, 0xffff0000, v30
v_lshlrev_b32 v12, 16, v30
v_and_b32 v15, 0xffff0000, v31
v_lshlrev_b32 v14, 16, v31
v_and_b32 v17, 0xffff0000, v32
v_lshlrev_b32 v16, 16, v32
v_and_b32 v19, 0xffff0000, v33
v_lshlrev_b32 v18, 16, v33
v_and_b32 v21, 0xffff0000, v34
v_lshlrev_b32 v20, 16, v34
v_and_b32 v23, 0xffff0000, v35
v_lshlrev_b32 v22, 16, v35
v_pk_add_f32 v[88:89], v[12:13], v[14:15]
v_pk_add_f32 v[88:89], v[88:89], v[16:17]
v_pk_add_f32 v[88:89], v[88:89], v[18:19]
v_pk_add_f32 v[88:89], v[88:89], v[20:21]
v_pk_add_f32 v[88:89], v[88:89], v[22:23]
v_add_f32 v88, v88, v89
s_nop 1
v_add_f32_dpp v88, v88, v88 row_ror:4 row_mask:0xf bank_mask:0xf
s_nop 1
v_add_f32_dpp v88, v88, v88 row_ror:8 row_mask:0xf bank_mask:0xf
v_mov_b32 v89, v88
s_nop 1
v_permlane32_swap_b32 v88, v89
v_add_f32 v88, v88, v89
v_mov_b32 v89, v88
s_nop 1
v_permlane16_swap_b32 v88, v89
v_add_f32 v88, v88, v89
ds_write_b32 v101, v88 offset:512
s_waitcnt lgkmcnt(0)
s_barrier
ds_read_b128 v[90:93], v102 offset:512
s_waitcnt lgkmcnt(0)
v_add_f32 v88, v90, v91
v_add_f32 v92, v92, v93
v_add_f32 v88, v88, v92
v_mul_f32 v94, 0xbacccccd, v88
v_mov_b32 v95, v94
v_pk_add_f32 v[12:13], v[12:13], v[94:95]
v_pk_add_f32 v[14:15], v[14:15], v[94:95]
v_pk_add_f32 v[16:17], v[16:17], v[94:95]
v_pk_add_f32 v[18:19], v[18:19], v[94:95]
v_pk_add_f32 v[20:21], v[20:21], v[94:95]
v_pk_add_f32 v[22:23], v[22:23], v[94:95]
v_cndmask_b32 v20, 0, v20, s[66:67]
v_cndmask_b32 v21, 0, v21, s[66:67]
v_cndmask_b32 v22, 0, v22, s[66:67]
v_cndmask_b32 v23, 0, v23, s[66:67]
v_pk_mul_f32 v[88:89], v[12:13], v[12:13]
v_pk_fma_f32 v[88:89], v[14:15], v[14:15], v[88:89]
v_pk_fma_f32 v[88:89], v[16:17], v[16:17], v[88:89]
v_pk_fma_f32 v[88:89], v[18:19], v[18:19], v[88:89]
v_pk_fma_f32 v[88:89], v[20:21], v[20:21], v[88:89]
v_pk_fma_f32 v[88:89], v[22:23], v[22:23], v[88:89]
v_add_f32 v88, v88, v89
s_nop 1
v_add_f32_dpp v88, v88, v88 row_ror:4 row_mask:0xf bank_mask:0xf
s_nop 1
v_add_f32_dpp v88, v88, v88 row_ror:8 row_mask:0xf bank_mask:0xf
v_mov_b32 v89, v88
s_nop 1
v_permlane32_swap_b32 v88, v89
v_add_f32 v88, v88, v89
v_mov_b32 v89, v88
s_nop 1
v_permlane16_swap_b32 v88, v89
v_add_f32 v88, v88, v89
ds_write_b32 v101, v88 offset:768
s_waitcnt lgkmcnt(0)
s_barrier
ds_read_b128 v[90:93], v102 offset:768
s_waitcnt lgkmcnt(0)
v_add_f32 v88, v90, v91
v_add_f32 v92, v92, v93
v_add_f32 v88, v88, v92
v_mul_f32 v88, 0x3acccccd, v88
v_cvt_pk_bf16_f32 v88, v88, v88
v_and_b32 v88, 0xffff0000, v88
v_add_f32 v88, 0x3727c5ac, v88
v_cvt_pk_bf16_f32 v88, v88, v88
v_and_b32 v88, 0xffff0000, v88
v_sqrt_f32 v88, v88
v_cvt_pk_bf16_f32 v89, v94, v94
v_and_b32 v89, 0xffff0000, v89
v_cvt_pk_bf16_f32 v88, v88, v88
v_and_b32 v88, 0xffff0000, v88
v_rcp_f32 v96, v88
v_sub_f32 v89, v89, v94
v_mov_b32 v97, v96
v_mul_f32 v94, v89, v96
v_mov_b32 v95, v94
v_pk_fma_f32 v[12:13], v[12:13], v[96:97], v[94:95]
v_pk_fma_f32 v[14:15], v[14:15], v[96:97], v[94:95]
v_pk_fma_f32 v[16:17], v[16:17], v[96:97], v[94:95]
v_pk_fma_f32 v[18:19], v[18:19], v[96:97], v[94:95]
v_pk_fma_f32 v[20:21], v[20:21], v[96:97], v[94:95]
v_pk_fma_f32 v[22:23], v[22:23], v[96:97], v[94:95]
v_cndmask_b32 v20, 0, v20, s[66:67]
v_cndmask_b32 v21, 0, v21, s[66:67]
v_cndmask_b32 v22, 0, v22, s[66:67]
v_cndmask_b32 v23, 0, v23, s[66:67]
v_cvt_pk_bf16_f32 v30, v12, v13
v_cvt_pk_bf16_f32 v31, v14, v15
v_cvt_pk_bf16_f32 v32, v16, v17
v_cvt_pk_bf16_f32 v33, v18, v19
v_cvt_pk_bf16_f32 v34, v20, v21
v_cvt_pk_bf16_f32 v35, v22, v23
buffer_store_dwordx2 v[30:31], v100, s[4:7], s55 offen offset:0 sc1
buffer_store_dwordx2 v[32:33], v100, s[4:7], s55 offen offset:128 sc1
buffer_store_dwordx2 v[34:35], v98, s[4:7], s55 offen offset:256 sc1
s_lshl_b32 s51, s50, 11
s_lshl_b32 s52, s71, 5
s_add_u32 s51, s51, s52
s_lshl_b32 s52, s57, 2
s_add_u32 s51, s51, s52
s_add_u32 s51, s51, 8192
s_waitcnt vmcnt(0) lgkmcnt(0)
s_barrier
s_cmp_lg_u32 s49, 0
s_cbranch_scc1 PUB_29
v_mov_b32 v88, 0
v_mov_b32 v89, 1
buffer_store_dword v89, v88, s[4:7], s51 offen sc1
PUB_29:
s_barrier
GW_NORED:
s_and_b32 s51, s71, 3
s_cmp_lg_u32 s51, 3
s_cbranch_scc1 GW_NOG1
s_cmp_ge_u32 s73, 135
s_cbranch_scc1 GW_NOG1
s_mul_i32 s55, s73, 9710
s_lshr_b32 s55, s55, 18
s_mul_i32 s51, s55, 27
s_sub_u32 s56, s73, s51
v_lshrrev_b32 v4, 3, v1
v_bfe_u32 v5, v1, 4, 1
v_lshlrev_b32 v5, 1, v5
s_and_b32 s51, s49, 1
s_lshl_b32 s51, s51, 2
v_or_b32 v5, s51, v5
v_and_b32 v6, 7, v1
v_xor_b32 v5, v5, v6
v_mul_u32_u24 v4, 3456, v4
v_lshl_add_u32 v4, v5, 4, v4
s_lshr_b32 s51, s71, 2
s_mul_i32 s52, s51, 442368
s_mul_i32 s53, s49, 27648
s_add_u32 s52, s52, s53
s_lshl_b32 s53, s56, 7
s_add_u32 s52, s52, s53
s_lshl_b32 s54, s49, 10
s_add_u32 m0, s54, 33792
s_add_u32 s53, s52, 0
buffer_load_dwordx4 v4, s[20:23], s53 offen lds
s_add_u32 m0, s54, 37888
s_add_u32 s53, s52, 110592
buffer_load_dwordx4 v4, s[20:23], s53 offen lds
s_add_u32 m0, s54, 41984
s_add_u32 s53, s52, 221184
buffer_load_dwordx4 v4, s[20:23], s53 offen lds
s_add_u32 m0, s54, 46080
s_add_u32 s53, s52, 331776
buffer_load_dwordx4 v4, s[20:23], s53 offen lds
v_lshlrev_b32 v5, 2, v3
v_and_b32 v4, 15, v1
v_xor_b32 v5, v5, v4
v_mul_u32_u24 v4, 1280, v3
v_lshl_add_u32 v4, v5, 4, v4
s_mul_i32 s52, s51, 163840
s_mul_i32 s53, s49, 5120
s_add_u32 s52, s52, s53
s_lshl_b32 s53, s55, 8
s_add_u32 s52, s52, s53
s_mul_i32 s53, s50, 2621440
s_add_u32 s52, s52, s53
s_add_u32 s52, s52, 155189248
s_lshl_b32 s60, s50, 11
s_lshl_b32 s51, s51, 7
s_add_u32 s60, s60, s51
s_add_u32 s60, s60, 8192
s_cmp_lg_u32 s49, 0
s_cbranch_scc1 WFOK_31
v_min_u32 v6, 31, v1
v_lshlrev_b32 v6, 2, v6
s_mov_b32 s69, 0
WF_30:
buffer_load_dword v7, v6, s[4:7], s60 offen sc1
s_add_u32 s69, s69, 1
s_cmp_gt_u32 s69, 131072
s_cbranch_scc1 ABORT
s_waitcnt vmcnt(0)
v_cmp_gt_u32 vcc, 1, v7
s_cbranch_vccz WFOK_31
s_sleep 6
s_branch WF_30
WFOK_31:
s_barrier
s_add_u32 m0, s54, 1024
s_add_u32 s53, s52, 0
buffer_load_dwordx4 v4, s[4:7], s53 offen sc1 lds
s_add_u32 m0, s54, 5120
s_add_u32 s53, s52, 20480
buffer_load_dwordx4 v4, s[4:7], s53 offen sc1 lds
s_add_u32 m0, s54, 9216
s_add_u32 s53, s52, 40960
buffer_load_dwordx4 v4, s[4:7], s53 offen sc1 lds
s_add_u32 m0, s54, 13312
s_add_u32 s53, s52, 61440
buffer_load_dwordx4 v4, s[4:7], s53 offen sc1 lds
s_add_u32 m0, s54, 17408
s_add_u32 s53, s52, 81920
buffer_load_dwordx4 v4, s[4:7], s53 offen sc1 lds
s_add_u32 m0, s54, 21504
s_add_u32 s53, s52, 102400
buffer_load_dwordx4 v4, s[4:7], s53 offen sc1 lds
s_add_u32 m0, s54, 25600
s_add_u32 s53, s52, 122880
buffer_load_dwordx4 v4, s[4:7], s53 offen sc1 lds
s_add_u32 m0, s54, 29696
s_add_u32 s53, s52, 143360
buffer_load_dwordx4 v4, s[4:7], s53 offen sc1 lds
v_bfe_u32 v5, v1, 2, 2
v_lshl_add_u32 v4, v3, 3, v5
s_and_b32 s51, s49, 1
s_lshl_b32 s51, s51, 1
s_add_u32 s52, s51, 0
v_xor_b32 v6, s52, v5
v_lshlrev_b32 v6, 6, v6
v_lshl_add_u32 v6, v4, 8, v6
v_and_b32 v8, 3, v1
v_lshl_add_u32 v6, v8, 4, v6
s_add_u32 s52, s51, 1
v_xor_b32 v7, s52, v5
v_lshlrev_b32 v7, 6, v7
v_lshl_add_u32 v7, v4, 8, v7
v_and_b32 v8, 3, v1
v_lshl_add_u32 v7, v8, 4, v7
v_lshrrev_b32 v5, 1, v5
v_and_b32 v9, 1, v3
v_lshl_add_u32 v5, v9, 1, v5
v_lshlrev_b32 v4, 7, v4
v_lshl_add_u32 v4, v8, 3, v4
s_lshr_b32 s51, s49, 1
s_lshl_b32 s51, s51, 1
s_add_u32 s52, s51, 0
v_xor_b32 v8, s52, v5
v_lshl_add_u32 v8, v8, 5, v4
s_add_u32 s52, s51, 1
v_xor_b32 v9, s52, v5
v_lshl_add_u32 v9, v9, 5, v4
s_waitcnt vmcnt(0) lgkmcnt(0)
s_barrier
ds_read_b64_tr_b16 v[44:45], v8 offset:33792
ds_read_b64_tr_b16 v[46:47], v8 offset:34304
ds_read_b64_tr_b16 v[48:49], v9 offset:33792
ds_read_b64_tr_b16 v[50:51], v9 offset:34304
ds_read_b64_tr_b16 v[12:13], v6 offset:1024
ds_read_b64_tr_b16 v[14:15], v6 offset:2048
ds_read_b64_tr_b16 v[16:17], v6 offset:1032
ds_read_b64_tr_b16 v[18:19], v6 offset:2056
ds_read_b64_tr_b16 v[20:21], v7 offset:1024
ds_read_b64_tr_b16 v[22:23], v7 offset:2048
ds_read_b64_tr_b16 v[24:25], v7 offset:1032
ds_read_b64_tr_b16 v[26:27], v7 offset:2056
s_waitcnt lgkmcnt(0)
ds_read_b64_tr_b16 v[52:53], v8 offset:37888
ds_read_b64_tr_b16 v[54:55], v8 offset:38400
ds_read_b64_tr_b16 v[56:57], v9 offset:37888
ds_read_b64_tr_b16 v[58:59], v9 offset:38400
ds_read_b64_tr_b16 v[28:29], v6 offset:9216
ds_read_b64_tr_b16 v[30:31], v6 offset:10240
ds_read_b64_tr_b16 v[32:33], v6 offset:9224
ds_read_b64_tr_b16 v[34:35], v6 offset:10248
ds_read_b64_tr_b16 v[36:37], v7 offset:9216
ds_read_b64_tr_b16 v[38:39], v7 offset:10240
ds_read_b64_tr_b16 v[40:41], v7 offset:9224
ds_read_b64_tr_b16 v[42:43], v7 offset:10248
v_mfma_f32_16x16x32_bf16 v[104:107], v[44:47], v[12:15], v[104:107]
v_mfma_f32_16x16x32_bf16 v[108:111], v[44:47], v[16:19], v[108:111]
v_mfma_f32_16x16x32_bf16 v[112:115], v[44:47], v[20:23], v[112:115]
v_mfma_f32_16x16x32_bf16 v[116:119], v[44:47], v[24:27], v[116:119]
v_mfma_f32_16x16x32_bf16 v[120:123], v[48:51], v[12:15], v[120:123]
v_mfma_f32_16x16x32_bf16 v[124:127], v[48:51], v[16:19], v[124:127]
v_mfma_f32_16x16x32_bf16 v[128:131], v[48:51], v[20:23], v[128:131]
v_mfma_f32_16x16x32_bf16 v[132:135], v[48:51], v[24:27], v[132:135]
s_waitcnt lgkmcnt(0)
ds_read_b64_tr_b16 v[44:45], v8 offset:41984
ds_read_b64_tr_b16 v[46:47], v8 offset:42496
ds_read_b64_tr_b16 v[48:49], v9 offset:41984
ds_read_b64_tr_b16 v[50:51], v9 offset:42496
ds_read_b64_tr_b16 v[12:13], v6 offset:17408
ds_read_b64_tr_b16 v[14:15], v6 offset:18432
ds_read_b64_tr_b16 v[16:17], v6 offset:17416
ds_read_b64_tr_b16 v[18:19], v6 offset:18440
ds_read_b64_tr_b16 v[20:21], v7 offset:17408
ds_read_b64_tr_b16 v[22:23], v7 offset:18432
ds_read_b64_tr_b16 v[24:25], v7 offset:17416
ds_read_b64_tr_b16 v[26:27], v7 offset:18440
v_mfma_f32_16x16x32_bf16 v[104:107], v[52:55], v[28:31], v[104:107]
v_mfma_f32_16x16x32_bf16 v[108:111], v[52:55], v[32:35], v[108:111]
v_mfma_f32_16x16x32_bf16 v[112:115], v[52:55], v[36:39], v[112:115]
v_mfma_f32_16x16x32_bf16 v[116:119], v[52:55], v[40:43], v[116:119]
v_mfma_f32_16x16x32_bf16 v[120:123], v[56:59], v[28:31], v[120:123]
v_mfma_f32_16x16x32_bf16 v[124:127], v[56:59], v[32:35], v[124:127]
v_mfma_f32_16x16x32_bf16 v[128:131], v[56:59], v[36:39], v[128:131]
v_mfma_f32_16x16x32_bf16 v[132:135], v[56:59], v[40:43], v[132:135]
s_waitcnt lgkmcnt(0)
ds_read_b64_tr_b16 v[52:53], v8 offset:46080
ds_read_b64_tr_b16 v[54:55], v8 offset:46592
ds_read_b64_tr_b16 v[56:57], v9 offset:46080
ds_read_b64_tr_b16 v[58:59], v9 offset:46592
ds_read_b64_tr_b16 v[28:29], v6 offset:25600
ds_read_b64_tr_b16 v[30:31], v6 offset:26624
ds_read_b64_tr_b16 v[32:33], v6 offset:25608
ds_read_b64_tr_b16 v[34:35], v6 offset:26632
ds_read_b64_tr_b16 v[36:37], v7 offset:25600
ds_read_b64_tr_b16 v[38:39], v7 offset:26624
ds_read_b64_tr_b16 v[40:41], v7 offset:25608
ds_read_b64_tr_b16 v[42:43], v7 offset:26632
v_mfma_f32_16x16x32_bf16 v[104:107], v[44:47], v[12:15], v[104:107]
v_mfma_f32_16x16x32_bf16 v[108:111], v[44:47], v[16:19], v[108:111]
v_mfma_f32_16x16x32_bf16 v[112:115], v[44:47], v[20:23], v[112:115]
v_mfma_f32_16x16x32_bf16 v[116:119], v[44:47], v[24:27], v[116:119]
v_mfma_f32_16x16x32_bf16 v[120:123], v[48:51], v[12:15], v[120:123]
v_mfma_f32_16x16x32_bf16 v[124:127], v[48:51], v[16:19], v[124:127]
v_mfma_f32_16x16x32_bf16 v[128:131], v[48:51], v[20:23], v[128:131]
v_mfma_f32_16x16x32_bf16 v[132:135], v[48:51], v[24:27], v[132:135]
s_waitcnt lgkmcnt(0)
v_mfma_f32_16x16x32_bf16 v[104:107], v[52:55], v[28:31], v[104:107]
v_mfma_f32_16x16x32_bf16 v[108:111], v[52:55], v[32:35], v[108:111]
v_mfma_f32_16x16x32_bf16 v[112:115], v[52:55], v[36:39], v[112:115]
v_mfma_f32_16x16x32_bf16 v[116:119], v[52:55], v[40:43], v[116:119]
v_mfma_f32_16x16x32_bf16 v[120:123], v[56:59], v[28:31], v[120:123]
v_mfma_f32_16x16x32_bf16 v[124:127], v[56:59], v[32:35], v[124:127]
v_mfma_f32_16x16x32_bf16 v[128:131], v[56:59], v[36:39], v[128:131]
v_mfma_f32_16x16x32_bf16 v[132:135], v[56:59], v[40:43], v[132:135]
s_barrier
GW_NOG1:
s_add_u32 s71, s71, 1
s_cmp_lt_u32 s71, 64
s_cbranch_scc1 GW_SEG
s_cmp_ge_u32 s73, 135
s_cbranch_scc1 GW_NOG1F
s_mul_i32 s55, s73, 9710
s_lshr_b32 s55, s55, 18
s_mul_i32 s51, s55, 27
s_sub_u32 s56, s73, s51
s_lshr_b32 s51, s49, 1
s_lshl_b32 s52, s56, 1
s_add_u32 s52, s52, s51
s_lshl_b32 s53, s52, 6
v_lshlrev_b32 v4, 3, v3
buffer_load_dwordx2 v[6:7], v4, s[28:31], s53 offen
buffer_load_dwordx2 v[8:9], v4, s[28:31], s53 offen offset:32
s_and_b32 s51, s49, 1
s_lshl_b32 s51, s51, 2
s_lshl_b32 s54, s55, 3
s_add_u32 s51, s51, s54
s_mul_i32 s51, s51, 54
s_add_u32 s51, s51, s52
s_lshl_b32 s51, s51, 10
s_mul_i32 s52, s50, 2211840
s_add_u32 s51, s51, s52
s_add_u32 s51, s51, 163577856
s_mov_b32 s53, 0xbdd2d3e8
v_mov_b32 v5, 0xc0135761
s_waitcnt vmcnt(0)
v_and_b32 v11, 0xffff0000, v6
v_lshlrev_b32 v10, 16, v6
v_and_b32 v13, 0xffff0000, v7
v_lshlrev_b32 v12, 16, v7
v_and_b32 v15, 0xffff0000, v8
v_lshlrev_b32 v14, 16, v8
v_and_b32 v17, 0xffff0000, v9
v_lshlrev_b32 v16, 16, v9
v_mov_b32 v36, s53
v_mov_b32 v38, v5
v_mov_b32 v40, 1.0
v_mov_b32 v37, s53
v_mov_b32 v39, v5
v_mov_b32 v41, 1.0
v_pk_add_f32 v[104:105], v[104:105], v[10:11]
v_pk_add_f32 v[106:107], v[106:107], v[12:13]
v_pk_add_f32 v[120:121], v[120:121], v[14:15]
v_pk_add_f32 v[122:123], v[122:123], v[16:17]
v_pk_mul_f32 v[44:45], v[104:105], v[104:105]
v_pk_mul_f32 v[46:47], v[106:107], v[106:107]
v_pk_mul_f32 v[48:49], v[120:121], v[120:121]
v_pk_mul_f32 v[50:51], v[122:123], v[122:123]
v_pk_fma_f32 v[44:45], v[44:45], v[36:37], v[38:39]
v_pk_fma_f32 v[46:47], v[46:47], v[36:37], v[38:39]
v_pk_fma_f32 v[48:49], v[48:49], v[36:37], v[38:39]
v_pk_fma_f32 v[50:51], v[50:51], v[36:37], v[38:39]
v_pk_mul_f32 v[44:45], v[44:45], v[104:105]
v_pk_mul_f32 v[46:47], v[46:47], v[106:107]
v_pk_mul_f32 v[48:49], v[48:49], v[120:121]
v_pk_mul_f32 v[50:51], v[50:51], v[122:123]
v_exp_f32 v44, v44
v_exp_f32 v45, v45
v_exp_f32 v46, v46
v_exp_f32 v47, v47
v_exp_f32 v48, v48
v_exp_f32 v49, v49
v_exp_f32 v50, v50
v_exp_f32 v51, v51
v_pk_add_f32 v[44:45], v[44:45], v[40:41]
v_pk_add_f32 v[46:47], v[46:47], v[40:41]
v_pk_add_f32 v[48:49], v[48:49], v[40:41]
v_pk_add_f32 v[50:51], v[50:51], v[40:41]
v_rcp_f32 v44, v44
v_rcp_f32 v45, v45
v_rcp_f32 v46, v46
v_rcp_f32 v47, v47
v_rcp_f32 v48, v48
v_rcp_f32 v49, v49
v_rcp_f32 v50, v50
v_rcp_f32 v51, v51
v_pk_mul_f32 v[44:45], v[44:45], v[104:105]
v_pk_mul_f32 v[46:47], v[46:47], v[106:107]
v_pk_mul_f32 v[48:49], v[48:49], v[120:121]
v_pk_mul_f32 v[50:51], v[50:51], v[122:123]
v_cvt_pk_bf16_f32 v28, v44, v45
v_cvt_pk_bf16_f32 v29, v46, v47
v_cvt_pk_bf16_f32 v30, v48, v49
v_cvt_pk_bf16_f32 v31, v50, v51
buffer_store_dwordx4 v[28:31], v2, s[4:7], s51 offen sc1
s_add_u32 s51, s51, 55296
v_pk_add_f32 v[108:109], v[108:109], v[10:11]
v_pk_add_f32 v[110:111], v[110:111], v[12:13]
v_pk_add_f32 v[124:125], v[124:125], v[14:15]
v_pk_add_f32 v[126:127], v[126:127], v[16:17]
v_pk_mul_f32 v[52:53], v[108:109], v[108:109]
v_pk_mul_f32 v[54:55], v[110:111], v[110:111]
v_pk_mul_f32 v[56:57], v[124:125], v[124:125]
v_pk_mul_f32 v[58:59], v[126:127], v[126:127]
v_pk_fma_f32 v[52:53], v[52:53], v[36:37], v[38:39]
v_pk_fma_f32 v[54:55], v[54:55], v[36:37], v[38:39]
v_pk_fma_f32 v[56:57], v[56:57], v[36:37], v[38:39]
v_pk_fma_f32 v[58:59], v[58:59], v[36:37], v[38:39]
v_pk_mul_f32 v[52:53], v[52:53], v[108:109]
v_pk_mul_f32 v[54:55], v[54:55], v[110:111]
v_pk_mul_f32 v[56:57], v[56:57], v[124:125]
v_pk_mul_f32 v[58:59], v[58:59], v[126:127]
v_exp_f32 v52, v52
v_exp_f32 v53, v53
v_exp_f32 v54, v54
v_exp_f32 v55, v55
v_exp_f32 v56, v56
v_exp_f32 v57, v57
v_exp_f32 v58, v58
v_exp_f32 v59, v59
v_pk_add_f32 v[52:53], v[52:53], v[40:41]
v_pk_add_f32 v[54:55], v[54:55], v[40:41]
v_pk_add_f32 v[56:57], v[56:57], v[40:41]
v_pk_add_f32 v[58:59], v[58:59], v[40:41]
v_rcp_f32 v52, v52
v_rcp_f32 v53, v53
v_rcp_f32 v54, v54
v_rcp_f32 v55, v55
v_rcp_f32 v56, v56
v_rcp_f32 v57, v57
v_rcp_f32 v58, v58
v_rcp_f32 v59, v59
v_pk_mul_f32 v[52:53], v[52:53], v[108:109]
v_pk_mul_f32 v[54:55], v[54:55], v[110:111]
v_pk_mul_f32 v[56:57], v[56:57], v[124:125]
v_pk_mul_f32 v[58:59], v[58:59], v[126:127]
v_cvt_pk_bf16_f32 v32, v52, v53
v_cvt_pk_bf16_f32 v33, v54, v55
v_cvt_pk_bf16_f32 v34, v56, v57
v_cvt_pk_bf16_f32 v35, v58, v59
buffer_store_dwordx4 v[32:35], v2, s[4:7], s51 offen sc1
s_add_u32 s51, s51, 55296
v_pk_add_f32 v[112:113], v[112:113], v[10:11]
v_pk_add_f32 v[114:115], v[114:115], v[12:13]
v_pk_add_f32 v[128:129], v[128:129], v[14:15]
v_pk_add_f32 v[130:131], v[130:131], v[16:17]
v_pk_mul_f32 v[44:45], v[112:113], v[112:113]
v_pk_mul_f32 v[46:47], v[114:115], v[114:115]
v_pk_mul_f32 v[48:49], v[128:129], v[128:129]
v_pk_mul_f32 v[50:51], v[130:131], v[130:131]
v_pk_fma_f32 v[44:45], v[44:45], v[36:37], v[38:39]
v_pk_fma_f32 v[46:47], v[46:47], v[36:37], v[38:39]
v_pk_fma_f32 v[48:49], v[48:49], v[36:37], v[38:39]
v_pk_fma_f32 v[50:51], v[50:51], v[36:37], v[38:39]
v_pk_mul_f32 v[44:45], v[44:45], v[112:113]
v_pk_mul_f32 v[46:47], v[46:47], v[114:115]
v_pk_mul_f32 v[48:49], v[48:49], v[128:129]
v_pk_mul_f32 v[50:51], v[50:51], v[130:131]
v_exp_f32 v44, v44
v_exp_f32 v45, v45
v_exp_f32 v46, v46
v_exp_f32 v47, v47
v_exp_f32 v48, v48
v_exp_f32 v49, v49
v_exp_f32 v50, v50
v_exp_f32 v51, v51
v_pk_add_f32 v[44:45], v[44:45], v[40:41]
v_pk_add_f32 v[46:47], v[46:47], v[40:41]
v_pk_add_f32 v[48:49], v[48:49], v[40:41]
v_pk_add_f32 v[50:51], v[50:51], v[40:41]
v_rcp_f32 v44, v44
v_rcp_f32 v45, v45
v_rcp_f32 v46, v46
v_rcp_f32 v47, v47
v_rcp_f32 v48, v48
v_rcp_f32 v49, v49
v_rcp_f32 v50, v50
v_rcp_f32 v51, v51
v_pk_mul_f32 v[44:45], v[44:45], v[112:113]
v_pk_mul_f32 v[46:47], v[46:47], v[114:115]
v_pk_mul_f32 v[48:49], v[48:49], v[128:129]
v_pk_mul_f32 v[50:51], v[50:51], v[130:131]
v_cvt_pk_bf16_f32 v28, v44, v45
v_cvt_pk_bf16_f32 v29, v46, v47
v_cvt_pk_bf16_f32 v30, v48, v49
v_cvt_pk_bf16_f32 v31, v50, v51
buffer_store_dwordx4 v[28:31], v2, s[4:7], s51 offen sc1
s_add_u32 s51, s51, 55296
v_pk_add_f32 v[116:117], v[116:117], v[10:11]
v_pk_add_f32 v[118:119], v[118:119], v[12:13]
v_pk_add_f32 v[132:133], v[132:133], v[14:15]
v_pk_add_f32 v[134:135], v[134:135], v[16:17]
v_pk_mul_f32 v[52:53], v[116:117], v[116:117]
v_pk_mul_f32 v[54:55], v[118:119], v[118:119]
v_pk_mul_f32 v[56:57], v[132:133], v[132:133]
v_pk_mul_f32 v[58:59], v[134:135], v[134:135]
v_pk_fma_f32 v[52:53], v[52:53], v[36:37], v[38:39]
v_pk_fma_f32 v[54:55], v[54:55], v[36:37], v[38:39]
v_pk_fma_f32 v[56:57], v[56:57], v[36:37], v[38:39]
v_pk_fma_f32 v[58:59], v[58:59], v[36:37], v[38:39]
v_pk_mul_f32 v[52:53], v[52:53], v[116:117]
v_pk_mul_f32 v[54:55], v[54:55], v[118:119]
v_pk_mul_f32 v[56:57], v[56:57], v[132:133]
v_pk_mul_f32 v[58:59], v[58:59], v[134:135]
v_exp_f32 v52, v52
v_exp_f32 v53, v53
v_exp_f32 v54, v54
v_exp_f32 v55, v55
v_exp_f32 v56, v56
v_exp_f32 v57, v57
v_exp_f32 v58, v58
v_exp_f32 v59, v59
v_pk_add_f32 v[52:53], v[52:53], v[40:41]
v_pk_add_f32 v[54:55], v[54:55], v[40:41]
v_pk_add_f32 v[56:57], v[56:57], v[40:41]
v_pk_add_f32 v[58:59], v[58:59], v[40:41]
v_rcp_f32 v52, v52
v_rcp_f32 v53, v53
v_rcp_f32 v54, v54
v_rcp_f32 v55, v55
v_rcp_f32 v56, v56
v_rcp_f32 v57, v57
v_rcp_f32 v58, v58
v_rcp_f32 v59, v59
v_pk_mul_f32 v[52:53], v[52:53], v[116:117]
v_pk_mul_f32 v[54:55], v[54:55], v[118:119]
v_pk_mul_f32 v[56:57], v[56:57], v[132:133]
v_pk_mul_f32 v[58:59], v[58:59], v[134:135]
v_cvt_pk_bf16_f32 v32, v52, v53
v_cvt_pk_bf16_f32 v33, v54, v55
v_cvt_pk_bf16_f32 v34, v56, v57
v_cvt_pk_bf16_f32 v35, v58, v59
buffer_store_dwordx4 v[32:35], v2, s[4:7], s51 offen sc1
s_add_u32 s51, s51, 55296
s_mul_i32 s51, s50, 640
s_lshl_b32 s52, s55, 7
s_add_u32 s51, s51, s52
s_lshl_b32 s52, s56, 2
s_add_u32 s51, s51, s52
s_add_u32 s51, s51, 12288
s_waitcnt vmcnt(0) lgkmcnt(0)
s_barrier
s_cmp_lg_u32 s49, 0
s_cbranch_scc1 PUB_32
v_mov_b32 v4, 0
v_mov_b32 v5, 1
buffer_store_dword v5, v4, s[4:7], s51 offen sc1
PUB_32:
GW_NOG1F:
s_cmp_ge_u32 s74, 160
s_cbranch_scc1 G2_DONE
s_and_b32 s55, s74, 15
s_lshr_b32 s56, s74, 4
s_lshl_b32 s51, s55, 2
s_add_u32 s51, s51, s49
s_mul_i32 s62, s51, 55296
s_add_u32 s62, s62, 255852544
s_add_u32 s63, s62, 0
buffer_load_dwordx4 v[40:43], v2, s[4:7], s63 offen offset:0
buffer_load_dwordx4 v[44:47], v2, s[4:7], s63 offen offset:1024
buffer_load_dwordx4 v[48:51], v2, s[4:7], s63 offen offset:2048
buffer_load_dwordx4 v[52:55], v2, s[4:7], s63 offen offset:3072
s_add_u32 s63, s62, 4096
buffer_load_dwordx4 v[56:59], v2, s[4:7], s63 offen offset:0
buffer_load_dwordx4 v[60:63], v2, s[4:7], s63 offen offset:1024
buffer_load_dwordx4 v[64:67], v2, s[4:7], s63 offen offset:2048
buffer_load_dwordx4 v[68:71], v2, s[4:7], s63 offen offset:3072
s_add_u32 s63, s62, 8192
buffer_load_dwordx4 v[72:75], v2, s[4:7], s63 offen offset:0
buffer_load_dwordx4 v[76:79], v2, s[4:7], s63 offen offset:1024
buffer_load_dwordx4 v[80:83], v2, s[4:7], s63 offen offset:2048
v_and_b32 v4, 15, v1
v_lshlrev_b32 v5, 1, v4
s_lshl_b32 s51, s51, 1
s_lshl_b32 s52, s51, 5
buffer_load_ushort v100, v5, s[40:43], s52 offen
buffer_load_ushort v102, v5, s[40:43], s52 offen offset:32
s_mul_i32 s68, s51, 20480
s_lshl_b32 s52, s56, 11
s_add_u32 s68, s68, s52
v_mul_u32_u24 v6, 1280, v4
v_lshl_add_u32 v6, v3, 4, v6
s_mul_i32 s70, s51, 20480
s_lshl_b32 s52, s56, 7
s_add_u32 s70, s70, s52
s_lshl_b32 s51, s56, 2
s_add_u32 s51, s51, s49
s_mul_i32 s61, s51, 55296
s_mul_i32 s52, s50, 2211840
s_add_u32 s61, s61, s52
s_add_u32 s61, s61, 163577856
s_mul_i32 s54, s49, 6144
s_mul_i32 s60, s50, 640
s_lshr_b32 s52, s56, 1
s_lshl_b32 s52, s52, 7
s_add_u32 s60, s60, s52
s_add_u32 s60, s60, 12288
v_add_u32 v5, 49152, v2
v_add_u32 v7, 98304, v2
s_cmp_lg_u32 s49, 0
s_cbranch_scc1 WFOK_34
v_min_u32 v16, 26, v1
v_lshlrev_b32 v16, 2, v16
s_mov_b32 s69, 0
WF_33:
buffer_load_dword v17, v16, s[4:7], s60 offen sc1
s_add_u32 s69, s69, 1
s_cmp_gt_u32 s69, 131072
s_cbranch_scc1 ABORT
s_waitcnt vmcnt(0)
v_cmp_gt_u32 vcc, 1, v17
s_cbranch_vccz WFOK_34
s_sleep 1
s_branch WF_33
WFOK_34:
s_barrier
s_add_u32 m0, s54, 0
s_add_u32 s52, s61, 0
buffer_load_dwordx4 v2, s[4:7], s52 offen offset:0 sc1 lds
buffer_load_dwordx4 v2, s[4:7], s52 offen offset:1024 sc1 lds
buffer_load_dwordx4 v2, s[4:7], s52 offen offset:2048 sc1 lds
s_add_u32 m0, s54, 3072
s_add_u32 s52, s61, 3072
buffer_load_dwordx4 v2, s[4:7], s52 offen offset:0 sc1 lds
buffer_load_dwordx4 v2, s[4:7], s52 offen offset:1024 sc1 lds
buffer_load_dwordx4 v2, s[4:7], s52 offen offset:2048 sc1 lds
s_add_u32 m0, s54, 24576
s_add_u32 s52, s61, 6144
buffer_load_dwordx4 v2, s[4:7], s52 offen offset:0 sc1 lds
buffer_load_dwordx4 v2, s[4:7], s52 offen offset:1024 sc1 lds
buffer_load_dwordx4 v2, s[4:7], s52 offen offset:2048 sc1 lds
s_add_u32 m0, s54, 27648
s_add_u32 s52, s61, 9216
buffer_load_dwordx4 v2, s[4:7], s52 offen offset:0 sc1 lds
buffer_load_dwordx4 v2, s[4:7], s52 offen offset:1024 sc1 lds
buffer_load_dwordx4 v2, s[4:7], s52 offen offset:2048 sc1 lds
s_add_u32 m0, s54, 49152
s_add_u32 s52, s61, 12288
buffer_load_dwordx4 v2, s[4:7], s52 offen offset:0 sc1 lds
buffer_load_dwordx4 v2, s[4:7], s52 offen offset:1024 sc1 lds
buffer_load_dwordx4 v2, s[4:7], s52 offen offset:2048 sc1 lds
s_add_u32 m0, s54, 52224
s_add_u32 s52, s61, 15360
buffer_load_dwordx4 v2, s[4:7], s52 offen offset:0 sc1 lds
buffer_load_dwordx4 v2, s[4:7], s52 offen offset:1024 sc1 lds
buffer_load_dwordx4 v2, s[4:7], s52 offen offset:2048 sc1 lds
s_add_u32 m0, s54, 73728
s_add_u32 s52, s61, 18432
buffer_load_dwordx4 v2, s[4:7], s52 offen offset:0 sc1 lds
buffer_load_dwordx4 v2, s[4:7], s52 offen offset:1024 sc1 lds
buffer_load_dwordx4 v2, s[4:7], s52 offen offset:2048 sc1 lds
s_add_u32 m0, s54, 76800
s_add_u32 s52, s61, 21504
buffer_load_dwordx4 v2, s[4:7], s52 offen offset:0 sc1 lds
buffer_load_dwordx4 v2, s[4:7], s52 offen offset:1024 sc1 lds
buffer_load_dwordx4 v2, s[4:7], s52 offen offset:2048 sc1 lds
s_add_u32 m0, s54, 98304
s_add_u32 s52, s61, 24576
buffer_load_dwordx4 v2, s[4:7], s52 offen offset:0 sc1 lds
buffer_load_dwordx4 v2, s[4:7], s52 offen offset:1024 sc1 lds
buffer_load_dwordx4 v2, s[4:7], s52 offen offset:2048 sc1 lds
s_add_u32 m0, s54, 101376
s_add_u32 s52, s61, 27648
buffer_load_dwordx4 v2, s[4:7], s52 offen offset:0 sc1 lds
buffer_load_dwordx4 v2, s[4:7], s52 offen offset:1024 sc1 lds
buffer_load_dwordx4 v2, s[4:7], s52 offen offset:2048 sc1 lds
s_mul_i32 s52, s50, 2621440
s_add_u32 s52, s52, s68
s_add_u32 s52, s52, 142606336
s_add_u32 s51, s52, 20480
buffer_load_dwordx4 v[84:87], v2, s[4:7], s52 offen offset:0 sc1
buffer_load_dwordx4 v[88:91], v2, s[4:7], s52 offen offset:1024 sc1
buffer_load_dwordx4 v[92:95], v2, s[4:7], s51 offen offset:0 sc1
buffer_load_dwordx4 v[96:99], v2, s[4:7], s51 offen offset:1024 sc1
s_waitcnt vmcnt(28)
s_waitcnt vmcnt(22)
s_barrier
ds_read_b128 v[8:11], v2 offset:0
ds_read_b128 v[12:15], v2 offset:6144
ds_read_b128 v[16:19], v2 offset:12288
ds_read_b128 v[20:23], v2 offset:18432
ds_read_b128 v[24:27], v2 offset:1024
ds_read_b128 v[28:31], v2 offset:7168
ds_read_b128 v[32:35], v2 offset:13312
ds_read_b128 v[36:39], v2 offset:19456
s_waitcnt lgkmcnt(6)
v_mfma_f32_16x16x32_bf16 v[104:107], v[8:11], v[136:139], 0
v_mfma_f32_16x16x32_bf16 v[120:123], v[8:11], v[40:43], 0
ds_read_b128 v[8:11], v2 offset:2048
v_mfma_f32_16x16x32_bf16 v[108:111], v[12:15], v[136:139], 0
v_mfma_f32_16x16x32_bf16 v[124:127], v[12:15], v[40:43], 0
ds_read_b128 v[12:15], v2 offset:8192
s_waitcnt lgkmcnt(6)
v_mfma_f32_16x16x32_bf16 v[112:115], v[16:19], v[136:139], 0
v_mfma_f32_16x16x32_bf16 v[128:131], v[16:19], v[40:43], 0
ds_read_b128 v[16:19], v2 offset:14336
v_mfma_f32_16x16x32_bf16 v[116:119], v[20:23], v[136:139], 0
v_mfma_f32_16x16x32_bf16 v[132:135], v[20:23], v[40:43], 0
ds_read_b128 v[20:23], v2 offset:20480
buffer_load_dwordx4 v[40:43], v2, s[4:7], s63 offen offset:3072
s_waitcnt lgkmcnt(6)
v_mfma_f32_16x16x32_bf16 v[104:107], v[24:27], v[140:143], v[104:107]
v_mfma_f32_16x16x32_bf16 v[120:123], v[24:27], v[44:47], v[120:123]
ds_read_b128 v[24:27], v2 offset:3072
v_mfma_f32_16x16x32_bf16 v[108:111], v[28:31], v[140:143], v[108:111]
v_mfma_f32_16x16x32_bf16 v[124:127], v[28:31], v[44:47], v[124:127]
ds_read_b128 v[28:31], v2 offset:9216
s_waitcnt lgkmcnt(6)
v_mfma_f32_16x16x32_bf16 v[112:115], v[32:35], v[140:143], v[112:115]
v_mfma_f32_16x16x32_bf16 v[128:131], v[32:35], v[44:47], v[128:131]
ds_read_b128 v[32:35], v2 offset:15360
v_mfma_f32_16x16x32_bf16 v[116:119], v[36:39], v[140:143], v[116:119]
v_mfma_f32_16x16x32_bf16 v[132:135], v[36:39], v[44:47], v[132:135]
ds_read_b128 v[36:39], v2 offset:21504
s_add_u32 s63, s62, 12288
buffer_load_dwordx4 v[44:47], v2, s[4:7], s63 offen offset:0
s_waitcnt lgkmcnt(6)
v_mfma_f32_16x16x32_bf16 v[104:107], v[8:11], v[144:147], v[104:107]
v_mfma_f32_16x16x32_bf16 v[120:123], v[8:11], v[48:51], v[120:123]
ds_read_b128 v[8:11], v2 offset:4096
v_mfma_f32_16x16x32_bf16 v[108:111], v[12:15], v[144:147], v[108:111]
v_mfma_f32_16x16x32_bf16 v[124:127], v[12:15], v[48:51], v[124:127]
ds_read_b128 v[12:15], v2 offset:10240
s_waitcnt lgkmcnt(6)
v_mfma_f32_16x16x32_bf16 v[112:115], v[16:19], v[144:147], v[112:115]
v_mfma_f32_16x16x32_bf16 v[128:131], v[16:19], v[48:51], v[128:131]
ds_read_b128 v[16:19], v2 offset:16384
v_mfma_f32_16x16x32_bf16 v[116:119], v[20:23], v[144:147], v[116:119]
v_mfma_f32_16x16x32_bf16 v[132:135], v[20:23], v[48:51], v[132:135]
ds_read_b128 v[20:23], v2 offset:22528
buffer_load_dwordx4 v[48:51], v2, s[4:7], s63 offen offset:1024
s_waitcnt lgkmcnt(6)
v_mfma_f32_16x16x32_bf16 v[104:107], v[24:27], v[148:151], v[104:107]
v_mfma_f32_16x16x32_bf16 v[120:123], v[24:27], v[52:55], v[120:123]
ds_read_b128 v[24:27], v2 offset:5120
v_mfma_f32_16x16x32_bf16 v[108:111], v[28:31], v[148:151], v[108:111]
v_mfma_f32_16x16x32_bf16 v[124:127], v[28:31], v[52:55], v[124:127]
ds_read_b128 v[28:31], v2 offset:11264
s_waitcnt lgkmcnt(6)
v_mfma_f32_16x16x32_bf16 v[112:115], v[32:35], v[148:151], v[112:115]
v_mfma_f32_16x16x32_bf16 v[128:131], v[32:35], v[52:55], v[128:131]
ds_read_b128 v[32:35], v2 offset:17408
v_mfma_f32_16x16x32_bf16 v[116:119], v[36:39], v[148:151], v[116:119]
v_mfma_f32_16x16x32_bf16 v[132:135], v[36:39], v[52:55], v[132:135]
ds_read_b128 v[36:39], v2 offset:23552
buffer_load_dwordx4 v[52:55], v2, s[4:7], s63 offen offset:2048
s_waitcnt lgkmcnt(6)
v_mfma_f32_16x16x32_bf16 v[104:107], v[8:11], v[152:155], v[104:107]
v_mfma_f32_16x16x32_bf16 v[120:123], v[8:11], v[56:59], v[120:123]
ds_read_b128 v[8:11], v2 offset:24576
v_mfma_f32_16x16x32_bf16 v[108:111], v[12:15], v[152:155], v[108:111]
v_mfma_f32_16x16x32_bf16 v[124:127], v[12:15], v[56:59], v[124:127]
ds_read_b128 v[12:15], v2 offset:30720
s_waitcnt lgkmcnt(6)
v_mfma_f32_16x16x32_bf16 v[112:115], v[16:19], v[152:155], v[112:115]
v_mfma_f32_16x16x32_bf16 v[128:131], v[16:19], v[56:59], v[128:131]
ds_read_b128 v[16:19], v2 offset:36864
v_mfma_f32_16x16x32_bf16 v[116:119], v[20:23], v[152:155], v[116:119]
v_mfma_f32_16x16x32_bf16 v[132:135], v[20:23], v[56:59], v[132:135]
ds_read_b128 v[20:23], v2 offset:43008
buffer_load_dwordx4 v[56:59], v2, s[4:7], s63 offen offset:3072
s_waitcnt lgkmcnt(6)
v_mfma_f32_16x16x32_bf16 v[104:107], v[24:27], v[156:159], v[104:107]
v_mfma_f32_16x16x32_bf16 v[120:123], v[24:27], v[60:63], v[120:123]
ds_read_b128 v[24:27], v2 offset:25600
v_mfma_f32_16x16x32_bf16 v[108:111], v[28:31], v[156:159], v[108:111]
v_mfma_f32_16x16x32_bf16 v[124:127], v[28:31], v[60:63], v[124:127]
ds_read_b128 v[28:31], v2 offset:31744
s_waitcnt lgkmcnt(6)
v_mfma_f32_16x16x32_bf16 v[112:115], v[32:35], v[156:159], v[112:115]
v_mfma_f32_16x16x32_bf16 v[128:131], v[32:35], v[60:63], v[128:131]
ds_read_b128 v[32:35], v2 offset:37888
v_mfma_f32_16x16x32_bf16 v[116:119], v[36:39], v[156:159], v[116:119]
v_mfma_f32_16x16x32_bf16 v[132:135], v[36:39], v[60:63], v[132:135]
ds_read_b128 v[36:39], v2 offset:44032
s_add_u32 s63, s62, 16384
buffer_load_dwordx4 v[60:63], v2, s[4:7], s63 offen offset:0
s_waitcnt vmcnt(22)
s_barrier
s_add_u32 m0, s54, 122880
s_add_u32 s52, s61, 30720
buffer_load_dwordx4 v2, s[4:7], s52 offen offset:0 sc1 lds
buffer_load_dwordx4 v2, s[4:7], s52 offen offset:1024 sc1 lds
buffer_load_dwordx4 v2, s[4:7], s52 offen offset:2048 sc1 lds
s_add_u32 m0, s54, 125952
s_add_u32 s52, s61, 33792
buffer_load_dwordx4 v2, s[4:7], s52 offen offset:0 sc1 lds
buffer_load_dwordx4 v2, s[4:7], s52 offen offset:1024 sc1 lds
buffer_load_dwordx4 v2, s[4:7], s52 offen offset:2048 sc1 lds
s_waitcnt lgkmcnt(6)
v_mfma_f32_16x16x32_bf16 v[104:107], v[8:11], v[160:163], v[104:107]
v_mfma_f32_16x16x32_bf16 v[120:123], v[8:11], v[64:67], v[120:123]
ds_read_b128 v[8:11], v2 offset:26624
v_mfma_f32_16x16x32_bf16 v[108:111], v[12:15], v[160:163], v[108:111]
v_mfma_f32_16x16x32_bf16 v[124:127], v[12:15], v[64:67], v[124:127]
ds_read_b128 v[12:15], v2 offset:32768
s_waitcnt lgkmcnt(6)
v_mfma_f32_16x16x32_bf16 v[112:115], v[16:19], v[160:163], v[112:115]
v_mfma_f32_16x16x32_bf16 v[128:131], v[16:19], v[64:67], v[128:131]
ds_read_b128 v[16:19], v2 offset:38912
v_mfma_f32_16x16x32_bf16 v[116:119], v[20:23], v[160:163], v[116:119]
v_mfma_f32_16x16x32_bf16 v[132:135], v[20:23], v[64:67], v[132:135]
ds_read_b128 v[20:23], v2 offset:45056
buffer_load_dwordx4 v[64:67], v2, s[4:7], s63 offen offset:1024
s_waitcnt lgkmcnt(6)
v_mfma_f32_16x16x32_bf16 v[104:107], v[24:27], v[164:167], v[104:107]
v_mfma_f32_16x16x32_bf16 v[120:123], v[24:27], v[68:71], v[120:123]
ds_read_b128 v[24:27], v2 offset:27648
v_mfma_f32_16x16x32_bf16 v[108:111], v[28:31], v[164:167], v[108:111]
v_mfma_f32_16x16x32_bf16 v[124:127], v[28:31], v[68:71], v[124:127]
ds_read_b128 v[28:31], v2 offset:33792
s_waitcnt lgkmcnt(6)
v_mfma_f32_16x16x32_bf16 v[112:115], v[32:35], v[164:167], v[112:115]
v_mfma_f32_16x16x32_bf16 v[128:131], v[32:35], v[68:71], v[128:131]
ds_read_b128 v[32:35], v2 offset:39936
v_mfma_f32_16x16x32_bf16 v[116:119], v[36:39], v[164:167], v[116:119]
v_mfma_f32_16x16x32_bf16 v[132:135], v[36:39], v[68:71], v[132:135]
ds_read_b128 v[36:39], v2 offset:46080
buffer_load_dwordx4 v[68:71], v2, s[4:7], s63 offen offset:2048
s_waitcnt lgkmcnt(6)
v_mfma_f32_16x16x32_bf16 v[104:107], v[8:11], v[168:171], v[104:107]
v_mfma_f32_16x16x32_bf16 v[120:123], v[8:11], v[72:75], v[120:123]
ds_read_b128 v[8:11], v2 offset:28672
v_mfma_f32_16x16x32_bf16 v[108:111], v[12:15], v[168:171], v[108:111]
v_mfma_f32_16x16x32_bf16 v[124:127], v[12:15], v[72:75], v[124:127]
ds_read_b128 v[12:15], v2 offset:34816
s_waitcnt lgkmcnt(6)
v_mfma_f32_16x16x32_bf16 v[112:115], v[16:19], v[168:171], v[112:115]
v_mfma_f32_16x16x32_bf16 v[128:131], v[16:19], v[72:75], v[128:131]
ds_read_b128 v[16:19], v2 offset:40960
v_mfma_f32_16x16x32_bf16 v[116:119], v[20:23], v[168:171], v[116:119]
v_mfma_f32_16x16x32_bf16 v[132:135], v[20:23], v[72:75], v[132:135]
ds_read_b128 v[20:23], v2 offset:47104
buffer_load_dwordx4 v[72:75], v2, s[4:7], s63 offen offset:3072
s_waitcnt lgkmcnt(6)
v_mfma_f32_16x16x32_bf16 v[104:107], v[24:27], v[172:175], v[104:107]
v_mfma_f32_16x16x32_bf16 v[120:123], v[24:27], v[76:79], v[120:123]
ds_read_b128 v[24:27], v2 offset:29696
v_mfma_f32_16x16x32_bf16 v[108:111], v[28:31], v[172:175], v[108:111]
v_mfma_f32_16x16x32_bf16 v[124:127], v[28:31], v[76:79], v[124:127]
ds_read_b128 v[28:31], v2 offset:35840
s_waitcnt lgkmcnt(6)
v_mfma_f32_16x16x32_bf16 v[112:115], v[32:35], v[172:175], v[112:115]
v_mfma_f32_16x16x32_bf16 v[128:131], v[32:35], v[76:79], v[128:131]
ds_read_b128 v[32:35], v2 offset:41984
v_mfma_f32_16x16x32_bf16 v[116:119], v[36:39], v[172:175], v[116:119]
v_mfma_f32_16x16x32_bf16 v[132:135], v[36:39], v[76:79], v[132:135]
ds_read_b128 v[36:39], v2 offset:48128
s_add_u32 s63, s62, 20480
buffer_load_dwordx4 v[76:79], v2, s[4:7], s63 offen offset:0
s_waitcnt lgkmcnt(6)
v_mfma_f32_16x16x32_bf16 v[104:107], v[8:11], v[176:179], v[104:107]
v_mfma_f32_16x16x32_bf16 v[120:123], v[8:11], v[80:83], v[120:123]
ds_read_b128 v[8:11], v5 offset:0
v_mfma_f32_16x16x32_bf16 v[108:111], v[12:15], v[176:179], v[108:111]
v_mfma_f32_16x16x32_bf16 v[124:127], v[12:15], v[80:83], v[124:127]
ds_read_b128 v[12:15], v5 offset:6144
s_waitcnt lgkmcnt(6)
v_mfma_f32_16x16x32_bf16 v[112:115], v[16:19], v[176:179], v[112:115]
v_mfma_f32_16x16x32_bf16 v[128:131], v[16:19], v[80:83], v[128:131]
ds_read_b128 v[16:19], v5 offset:12288
v_mfma_f32_16x16x32_bf16 v[116:119], v[20:23], v[176:179], v[116:119]
v_mfma_f32_16x16x32_bf16 v[132:135], v[20:23], v[80:83], v[132:135]
ds_read_b128 v[20:23], v5 offset:18432
buffer_load_dwordx4 v[80:83], v2, s[4:7], s63 offen offset:1024
s_waitcnt vmcnt(16)
s_waitcnt lgkmcnt(6)
v_mfma_f32_16x16x32_bf16 v[104:107], v[24:27], v[180:183], v[104:107]
v_mfma_f32_16x16x32_bf16 v[120:123], v[24:27], v[40:43], v[120:123]
ds_read_b128 v[24:27], v5 offset:1024
v_mfma_f32_16x16x32_bf16 v[108:111], v[28:31], v[180:183], v[108:111]
v_mfma_f32_16x16x32_bf16 v[124:127], v[28:31], v[40:43], v[124:127]
ds_read_b128 v[28:31], v5 offset:7168
s_waitcnt lgkmcnt(6)
v_mfma_f32_16x16x32_bf16 v[112:115], v[32:35], v[180:183], v[112:115]
v_mfma_f32_16x16x32_bf16 v[128:131], v[32:35], v[40:43], v[128:131]
ds_read_b128 v[32:35], v5 offset:13312
v_mfma_f32_16x16x32_bf16 v[116:119], v[36:39], v[180:183], v[116:119]
v_mfma_f32_16x16x32_bf16 v[132:135], v[36:39], v[40:43], v[132:135]
ds_read_b128 v[36:39], v5 offset:19456
buffer_load_dwordx4 v[40:43], v2, s[4:7], s63 offen offset:2048
s_barrier
s_add_u32 m0, s54, 0
s_add_u32 s52, s61, 36864
buffer_load_dwordx4 v2, s[4:7], s52 offen offset:0 sc1 lds
buffer_load_dwordx4 v2, s[4:7], s52 offen offset:1024 sc1 lds
buffer_load_dwordx4 v2, s[4:7], s52 offen offset:2048 sc1 lds
s_add_u32 m0, s54, 3072
s_add_u32 s52, s61, 39936
buffer_load_dwordx4 v2, s[4:7], s52 offen offset:0 sc1 lds
buffer_load_dwordx4 v2, s[4:7], s52 offen offset:1024 sc1 lds
buffer_load_dwordx4 v2, s[4:7], s52 offen offset:2048 sc1 lds
s_waitcnt vmcnt(22)
s_waitcnt lgkmcnt(6)
v_mfma_f32_16x16x32_bf16 v[104:107], v[8:11], v[184:187], v[104:107]
v_mfma_f32_16x16x32_bf16 v[120:123], v[8:11], v[44:47], v[120:123]
ds_read_b128 v[8:11], v5 offset:2048
v_mfma_f32_16x16x32_bf16 v[108:111], v[12:15], v[184:187], v[108:111]
v_mfma_f32_16x16x32_bf16 v[124:127], v[12:15], v[44:47], v[124:127]
ds_read_b128 v[12:15], v5 offset:8192
s_waitcnt lgkmcnt(6)
v_mfma_f32_16x16x32_bf16 v[112:115], v[16:19], v[184:187], v[112:115]
v_mfma_f32_16x16x32_bf16 v[128:131], v[16:19], v[44:47], v[128:131]
ds_read_b128 v[16:19], v5 offset:14336
v_mfma_f32_16x16x32_bf16 v[116:119], v[20:23], v[184:187], v[116:119]
v_mfma_f32_16x16x32_bf16 v[132:135], v[20:23], v[44:47], v[132:135]
ds_read_b128 v[20:23], v5 offset:20480
buffer_load_dwordx4 v[44:47], v2, s[4:7], s63 offen offset:3072
s_waitcnt vmcnt(22)
s_waitcnt lgkmcnt(6)
v_mfma_f32_16x16x32_bf16 v[104:107], v[24:27], v[188:191], v[104:107]
v_mfma_f32_16x16x32_bf16 v[120:123], v[24:27], v[48:51], v[120:123]
ds_read_b128 v[24:27], v5 offset:3072
v_mfma_f32_16x16x32_bf16 v[108:111], v[28:31], v[188:191], v[108:111]
v_mfma_f32_16x16x32_bf16 v[124:127], v[28:31], v[48:51], v[124:127]
ds_read_b128 v[28:31], v5 offset:9216
s_waitcnt lgkmcnt(6)
v_mfma_f32_16x16x32_bf16 v[112:115], v[32:35], v[188:191], v[112:115]
v_mfma_f32_16x16x32_bf16 v[128:131], v[32:35], v[48:51], v[128:131]
ds_read_b128 v[32:35], v5 offset:15360
v_mfma_f32_16x16x32_bf16 v[116:119], v[36:39], v[188:191], v[116:119]
v_mfma_f32_16x16x32_bf16 v[132:135], v[36:39], v[48:51], v[132:135]
ds_read_b128 v[36:39], v5 offset:21504
s_add_u32 s63, s62, 24576
buffer_load_dwordx4 v[48:51], v2, s[4:7], s63 offen offset:0
s_waitcnt vmcnt(22)
s_waitcnt lgkmcnt(6)
v_mfma_f32_16x16x32_bf16 v[104:107], v[8:11], v[192:195], v[104:107]
v_mfma_f32_16x16x32_bf16 v[120:123], v[8:11], v[52:55], v[120:123]
ds_read_b128 v[8:11], v5 offset:4096
v_mfma_f32_16x16x32_bf16 v[108:111], v[12:15], v[192:195], v[108:111]
v_mfma_f32_16x16x32_bf16 v[124:127], v[12:15], v[52:55], v[124:127]
ds_read_b128 v[12:15], v5 offset:10240
s_waitcnt lgkmcnt(6)
v_mfma_f32_16x16x32_bf16 v[112:115], v[16:19], v[192:195], v[112:115]
v_mfma_f32_16x16x32_bf16 v[128:131], v[16:19], v[52:55], v[128:131]
ds_read_b128 v[16:19], v5 offset:16384
v_mfma_f32_16x16x32_bf16 v[116:119], v[20:23], v[192:195], v[116:119]
v_mfma_f32_16x16x32_bf16 v[132:135], v[20:23], v[52:55], v[132:135]
ds_read_b128 v[20:23], v5 offset:22528
buffer_load_dwordx4 v[52:55], v2, s[4:7], s63 offen offset:1024
s_waitcnt vmcnt(22)
s_waitcnt lgkmcnt(6)
v_mfma_f32_16x16x32_bf16 v[104:107], v[24:27], v[196:199], v[104:107]
v_mfma_f32_16x16x32_bf16 v[120:123], v[24:27], v[56:59], v[120:123]
ds_read_b128 v[24:27], v5 offset:5120
v_mfma_f32_16x16x32_bf16 v[108:111], v[28:31], v[196:199], v[108:111]
v_mfma_f32_16x16x32_bf16 v[124:127], v[28:31], v[56:59], v[124:127]
ds_read_b128 v[28:31], v5 offset:11264
s_waitcnt lgkmcnt(6)
v_mfma_f32_16x16x32_bf16 v[112:115], v[32:35], v[196:199], v[112:115]
v_mfma_f32_16x16x32_bf16 v[128:131], v[32:35], v[56:59], v[128:131]
ds_read_b128 v[32:35], v5 offset:17408
v_mfma_f32_16x16x32_bf16 v[116:119], v[36:39], v[196:199], v[116:119]
v_mfma_f32_16x16x32_bf16 v[132:135], v[36:39], v[56:59], v[132:135]
ds_read_b128 v[36:39], v5 offset:23552
buffer_load_dwordx4 v[56:59], v2, s[4:7], s63 offen offset:2048
s_waitcnt vmcnt(22)
s_waitcnt lgkmcnt(6)
v_mfma_f32_16x16x32_bf16 v[104:107], v[8:11], v[200:203], v[104:107]
v_mfma_f32_16x16x32_bf16 v[120:123], v[8:11], v[60:63], v[120:123]
ds_read_b128 v[8:11], v5 offset:24576
v_mfma_f32_16x16x32_bf16 v[108:111], v[12:15], v[200:203], v[108:111]
v_mfma_f32_16x16x32_bf16 v[124:127], v[12:15], v[60:63], v[124:127]
ds_read_b128 v[12:15], v5 offset:30720
s_waitcnt lgkmcnt(6)
v_mfma_f32_16x16x32_bf16 v[112:115], v[16:19], v[200:203], v[112:115]
v_mfma_f32_16x16x32_bf16 v[128:131], v[16:19], v[60:63], v[128:131]
ds_read_b128 v[16:19], v5 offset:36864
v_mfma_f32_16x16x32_bf16 v[116:119], v[20:23], v[200:203], v[116:119]
v_mfma_f32_16x16x32_bf16 v[132:135], v[20:23], v[60:63], v[132:135]
ds_read_b128 v[20:23], v5 offset:43008
buffer_load_dwordx4 v[60:63], v2, s[4:7], s63 offen offset:3072
s_waitcnt vmcnt(16)
s_waitcnt lgkmcnt(6)
v_mfma_f32_16x16x32_bf16 v[104:107], v[24:27], v[204:207], v[104:107]
v_mfma_f32_16x16x32_bf16 v[120:123], v[24:27], v[64:67], v[120:123]
ds_read_b128 v[24:27], v5 offset:25600
v_mfma_f32_16x16x32_bf16 v[108:111], v[28:31], v[204:207], v[108:111]
v_mfma_f32_16x16x32_bf16 v[124:127], v[28:31], v[64:67], v[124:127]
ds_read_b128 v[28:31], v5 offset:31744
s_waitcnt lgkmcnt(6)
v_mfma_f32_16x16x32_bf16 v[112:115], v[32:35], v[204:207], v[112:115]
v_mfma_f32_16x16x32_bf16 v[128:131], v[32:35], v[64:67], v[128:131]
ds_read_b128 v[32:35], v5 offset:37888
v_mfma_f32_16x16x32_bf16 v[116:119], v[36:39], v[204:207], v[116:119]
v_mfma_f32_16x16x32_bf16 v[132:135], v[36:39], v[64:67], v[132:135]
ds_read_b128 v[36:39], v5 offset:44032
s_add_u32 s63, s62, 28672
buffer_load_dwordx4 v[64:67], v2, s[4:7], s63 offen offset:0
s_barrier
s_add_u32 m0, s54, 24576
s_add_u32 s52, s61, 43008
buffer_load_dwordx4 v2, s[4:7], s52 offen offset:0 sc1 lds
buffer_load_dwordx4 v2, s[4:7], s52 offen offset:1024 sc1 lds
buffer_load_dwordx4 v2, s[4:7], s52 offen offset:2048 sc1 lds
s_add_u32 m0, s54, 27648
s_add_u32 s52, s61, 46080
buffer_load_dwordx4 v2, s[4:7], s52 offen offset:0 sc1 lds
buffer_load_dwordx4 v2, s[4:7], s52 offen offset:1024 sc1 lds
buffer_load_dwordx4 v2, s[4:7], s52 offen offset:2048 sc1 lds
s_waitcnt vmcnt(22)
s_waitcnt lgkmcnt(6)
v_mfma_f32_16x16x32_bf16 v[104:107], v[8:11], v[208:211], v[104:107]
v_mfma_f32_16x16x32_bf16 v[120:123], v[8:11], v[68:71], v[120:123]
ds_read_b128 v[8:11], v5 offset:26624
v_mfma_f32_16x16x32_bf16 v[108:111], v[12:15], v[208:211], v[108:111]
v_mfma_f32_16x16x32_bf16 v[124:127], v[12:15], v[68:71], v[124:127]
ds_read_b128 v[12:15], v5 offset:32768
s_waitcnt lgkmcnt(6)
v_mfma_f32_16x16x32_bf16 v[112:115], v[16:19], v[208:211], v[112:115]
v_mfma_f32_16x16x32_bf16 v[128:131], v[16:19], v[68:71], v[128:131]
ds_read_b128 v[16:19], v5 offset:38912
v_mfma_f32_16x16x32_bf16 v[116:119], v[20:23], v[208:211], v[116:119]
v_mfma_f32_16x16x32_bf16 v[132:135], v[20:23], v[68:71], v[132:135]
ds_read_b128 v[20:23], v5 offset:45056
buffer_load_dwordx4 v[68:71], v2, s[4:7], s63 offen offset:1024
s_waitcnt vmcnt(22)
s_waitcnt lgkmcnt(6)
v_mfma_f32_16x16x32_bf16 v[104:107], v[24:27], v[212:215], v[104:107]
v_mfma_f32_16x16x32_bf16 v[120:123], v[24:27], v[72:75], v[120:123]
ds_read_b128 v[24:27], v5 offset:27648
v_mfma_f32_16x16x32_bf16 v[108:111], v[28:31], v[212:215], v[108:111]
v_mfma_f32_16x16x32_bf16 v[124:127], v[28:31], v[72:75], v[124:127]
ds_read_b128 v[28:31], v5 offset:33792
s_waitcnt lgkmcnt(6)
v_mfma_f32_16x16x32_bf16 v[112:115], v[32:35], v[212:215], v[112:115]
v_mfma_f32_16x16x32_bf16 v[128:131], v[32:35], v[72:75], v[128:131]
ds_read_b128 v[32:35], v5 offset:39936
v_mfma_f32_16x16x32_bf16 v[116:119], v[36:39], v[212:215], v[116:119]
v_mfma_f32_16x16x32_bf16 v[132:135], v[36:39], v[72:75], v[132:135]
ds_read_b128 v[36:39], v5 offset:46080
buffer_load_dwordx4 v[72:75], v2, s[4:7], s63 offen offset:2048
s_waitcnt vmcnt(22)
s_waitcnt lgkmcnt(6)
v_mfma_f32_16x16x32_bf16 v[104:107], v[8:11], v[216:219], v[104:107]
v_mfma_f32_16x16x32_bf16 v[120:123], v[8:11], v[76:79], v[120:123]
ds_read_b128 v[8:11], v5 offset:28672
v_mfma_f32_16x16x32_bf16 v[108:111], v[12:15], v[216:219], v[108:111]
v_mfma_f32_16x16x32_bf16 v[124:127], v[12:15], v[76:79], v[124:127]
ds_read_b128 v[12:15], v5 offset:34816
s_waitcnt lgkmcnt(6)
v_mfma_f32_16x16x32_bf16 v[112:115], v[16:19], v[216:219], v[112:115]
v_mfma_f32_16x16x32_bf16 v[128:131], v[16:19], v[76:79], v[128:131]
ds_read_b128 v[16:19], v5 offset:40960
v_mfma_f32_16x16x32_bf16 v[116:119], v[20:23], v[216:219], v[116:119]
v_mfma_f32_16x16x32_bf16 v[132:135], v[20:23], v[76:79], v[132:135]
ds_read_b128 v[20:23], v5 offset:47104
buffer_load_dwordx4 v[76:79], v2, s[4:7], s63 offen offset:3072
s_waitcnt vmcnt(22)
s_waitcnt lgkmcnt(6)
v_mfma_f32_16x16x32_bf16 v[104:107], v[24:27], v[220:223], v[104:107]
v_mfma_f32_16x16x32_bf16 v[120:123], v[24:27], v[80:83], v[120:123]
ds_read_b128 v[24:27], v5 offset:29696
v_mfma_f32_16x16x32_bf16 v[108:111], v[28:31], v[220:223], v[108:111]
v_mfma_f32_16x16x32_bf16 v[124:127], v[28:31], v[80:83], v[124:127]
ds_read_b128 v[28:31], v5 offset:35840
s_waitcnt lgkmcnt(6)
v_mfma_f32_16x16x32_bf16 v[112:115], v[32:35], v[220:223], v[112:115]
v_mfma_f32_16x16x32_bf16 v[128:131], v[32:35], v[80:83], v[128:131]
ds_read_b128 v[32:35], v5 offset:41984
v_mfma_f32_16x16x32_bf16 v[116:119], v[36:39], v[220:223], v[116:119]
v_mfma_f32_16x16x32_bf16 v[132:135], v[36:39], v[80:83], v[132:135]
ds_read_b128 v[36:39], v5 offset:48128
s_add_u32 s63, s62, 32768
buffer_load_dwordx4 v[80:83], v2, s[4:7], s63 offen offset:0
s_waitcnt vmcnt(22)
s_waitcnt lgkmcnt(6)
v_mfma_f32_16x16x32_bf16 v[104:107], v[8:11], v[224:227], v[104:107]
v_mfma_f32_16x16x32_bf16 v[120:123], v[8:11], v[40:43], v[120:123]
ds_read_b128 v[8:11], v7 offset:0
v_mfma_f32_16x16x32_bf16 v[108:111], v[12:15], v[224:227], v[108:111]
v_mfma_f32_16x16x32_bf16 v[124:127], v[12:15], v[40:43], v[124:127]
ds_read_b128 v[12:15], v7 offset:6144
s_waitcnt lgkmcnt(6)
v_mfma_f32_16x16x32_bf16 v[112:115], v[16:19], v[224:227], v[112:115]
v_mfma_f32_16x16x32_bf16 v[128:131], v[16:19], v[40:43], v[128:131]
ds_read_b128 v[16:19], v7 offset:12288
v_mfma_f32_16x16x32_bf16 v[116:119], v[20:23], v[224:227], v[116:119]
v_mfma_f32_16x16x32_bf16 v[132:135], v[20:23], v[40:43], v[132:135]
ds_read_b128 v[20:23], v7 offset:18432
buffer_load_dwordx4 v[40:43], v2, s[4:7], s63 offen offset:1024
s_waitcnt vmcnt(16)
s_waitcnt lgkmcnt(6)
v_mfma_f32_16x16x32_bf16 v[104:107], v[24:27], v[228:231], v[104:107]
v_mfma_f32_16x16x32_bf16 v[120:123], v[24:27], v[44:47], v[120:123]
ds_read_b128 v[24:27], v7 offset:1024
v_mfma_f32_16x16x32_bf16 v[108:111], v[28:31], v[228:231], v[108:111]
v_mfma_f32_16x16x32_bf16 v[124:127], v[28:31], v[44:47], v[124:127]
ds_read_b128 v[28:31], v7 offset:7168
s_waitcnt lgkmcnt(6)
v_mfma_f32_16x16x32_bf16 v[112:115], v[32:35], v[228:231], v[112:115]
v_mfma_f32_16x16x32_bf16 v[128:131], v[32:35], v[44:47], v[128:131]
ds_read_b128 v[32:35], v7 offset:13312
v_mfma_f32_16x16x32_bf16 v[116:119], v[36:39], v[228:231], v[116:119]
v_mfma_f32_16x16x32_bf16 v[132:135], v[36:39], v[44:47], v[132:135]
ds_read_b128 v[36:39], v7 offset:19456
buffer_load_dwordx4 v[44:47], v2, s[4:7], s63 offen offset:2048
s_barrier
s_add_u32 m0, s54, 49152
s_add_u32 s52, s61, 49152
buffer_load_dwordx4 v2, s[4:7], s52 offen offset:0 sc1 lds
buffer_load_dwordx4 v2, s[4:7], s52 offen offset:1024 sc1 lds
buffer_load_dwordx4 v2, s[4:7], s52 offen offset:2048 sc1 lds
s_add_u32 m0, s54, 52224
s_add_u32 s52, s61, 52224
buffer_load_dwordx4 v2, s[4:7], s52 offen offset:0 sc1 lds
buffer_load_dwordx4 v2, s[4:7], s52 offen offset:1024 sc1 lds
buffer_load_dwordx4 v2, s[4:7], s52 offen offset:2048 sc1 lds
s_waitcnt vmcnt(22)
s_waitcnt lgkmcnt(6)
v_mfma_f32_16x16x32_bf16 v[104:107], v[8:11], v[232:235], v[104:107]
v_mfma_f32_16x16x32_bf16 v[120:123], v[8:11], v[48:51], v[120:123]
ds_read_b128 v[8:11], v7 offset:2048
v_mfma_f32_16x16x32_bf16 v[108:111], v[12:15], v[232:235], v[108:111]
v_mfma_f32_16x16x32_bf16 v[124:127], v[12:15], v[48:51], v[124:127]
ds_read_b128 v[12:15], v7 offset:8192
s_waitcnt lgkmcnt(6)
v_mfma_f32_16x16x32_bf16 v[112:115], v[16:19], v[232:235], v[112:115]
v_mfma_f32_16x16x32_bf16 v[128:131], v[16:19], v[48:51], v[128:131]
ds_read_b128 v[16:19], v7 offset:14336
v_mfma_f32_16x16x32_bf16 v[116:119], v[20:23], v[232:235], v[116:119]
v_mfma_f32_16x16x32_bf16 v[132:135], v[20:23], v[48:51], v[132:135]
ds_read_b128 v[20:23], v7 offset:20480
buffer_load_dwordx4 v[48:51], v2, s[4:7], s63 offen offset:3072
s_waitcnt vmcnt(22)
s_waitcnt lgkmcnt(6)
v_mfma_f32_16x16x32_bf16 v[104:107], v[24:27], v[236:239], v[104:107]
v_mfma_f32_16x16x32_bf16 v[120:123], v[24:27], v[52:55], v[120:123]
ds_read_b128 v[24:27], v7 offset:3072
v_mfma_f32_16x16x32_bf16 v[108:111], v[28:31], v[236:239], v[108:111]
v_mfma_f32_16x16x32_bf16 v[124:127], v[28:31], v[52:55], v[124:127]
ds_read_b128 v[28:31], v7 offset:9216
s_waitcnt lgkmcnt(6)
v_mfma_f32_16x16x32_bf16 v[112:115], v[32:35], v[236:239], v[112:115]
v_mfma_f32_16x16x32_bf16 v[128:131], v[32:35], v[52:55], v[128:131]
ds_read_b128 v[32:35], v7 offset:15360
v_mfma_f32_16x16x32_bf16 v[116:119], v[36:39], v[236:239], v[116:119]
v_mfma_f32_16x16x32_bf16 v[132:135], v[36:39], v[52:55], v[132:135]
ds_read_b128 v[36:39], v7 offset:21504
s_add_u32 s63, s62, 36864
buffer_load_dwordx4 v[52:55], v2, s[4:7], s63 offen offset:0
s_waitcnt vmcnt(22)
s_waitcnt lgkmcnt(6)
v_mfma_f32_16x16x32_bf16 v[104:107], v[8:11], v[240:243], v[104:107]
v_mfma_f32_16x16x32_bf16 v[120:123], v[8:11], v[56:59], v[120:123]
ds_read_b128 v[8:11], v7 offset:4096
v_mfma_f32_16x16x32_bf16 v[108:111], v[12:15], v[240:243], v[108:111]
v_mfma_f32_16x16x32_bf16 v[124:127], v[12:15], v[56:59], v[124:127]
ds_read_b128 v[12:15], v7 offset:10240
s_waitcnt lgkmcnt(6)
v_mfma_f32_16x16x32_bf16 v[112:115], v[16:19], v[240:243], v[112:115]
v_mfma_f32_16x16x32_bf16 v[128:131], v[16:19], v[56:59], v[128:131]
ds_read_b128 v[16:19], v7 offset:16384
v_mfma_f32_16x16x32_bf16 v[116:119], v[20:23], v[240:243], v[116:119]
v_mfma_f32_16x16x32_bf16 v[132:135], v[20:23], v[56:59], v[132:135]
ds_read_b128 v[20:23], v7 offset:22528
buffer_load_dwordx4 v[56:59], v2, s[4:7], s63 offen offset:1024
s_waitcnt vmcnt(22)
s_waitcnt lgkmcnt(6)
v_mfma_f32_16x16x32_bf16 v[104:107], v[24:27], v[244:247], v[104:107]
v_mfma_f32_16x16x32_bf16 v[120:123], v[24:27], v[60:63], v[120:123]
ds_read_b128 v[24:27], v7 offset:5120
v_mfma_f32_16x16x32_bf16 v[108:111], v[28:31], v[244:247], v[108:111]
v_mfma_f32_16x16x32_bf16 v[124:127], v[28:31], v[60:63], v[124:127]
ds_read_b128 v[28:31], v7 offset:11264
s_waitcnt lgkmcnt(6)
v_mfma_f32_16x16x32_bf16 v[112:115], v[32:35], v[244:247], v[112:115]
v_mfma_f32_16x16x32_bf16 v[128:131], v[32:35], v[60:63], v[128:131]
ds_read_b128 v[32:35], v7 offset:17408
v_mfma_f32_16x16x32_bf16 v[116:119], v[36:39], v[244:247], v[116:119]
v_mfma_f32_16x16x32_bf16 v[132:135], v[36:39], v[60:63], v[132:135]
ds_read_b128 v[36:39], v7 offset:23552
buffer_load_dwordx4 v[60:63], v2, s[4:7], s63 offen offset:2048
s_waitcnt vmcnt(22)
s_waitcnt lgkmcnt(6)
v_mfma_f32_16x16x32_bf16 v[104:107], v[8:11], v[248:251], v[104:107]
v_mfma_f32_16x16x32_bf16 v[120:123], v[8:11], v[64:67], v[120:123]
ds_read_b128 v[8:11], v7 offset:24576
v_mfma_f32_16x16x32_bf16 v[108:111], v[12:15], v[248:251], v[108:111]
v_mfma_f32_16x16x32_bf16 v[124:127], v[12:15], v[64:67], v[124:127]
ds_read_b128 v[12:15], v7 offset:30720
s_waitcnt lgkmcnt(6)
v_mfma_f32_16x16x32_bf16 v[112:115], v[16:19], v[248:251], v[112:115]
v_mfma_f32_16x16x32_bf16 v[128:131], v[16:19], v[64:67], v[128:131]
ds_read_b128 v[16:19], v7 offset:36864
v_mfma_f32_16x16x32_bf16 v[116:119], v[20:23], v[248:251], v[116:119]
v_mfma_f32_16x16x32_bf16 v[132:135], v[20:23], v[64:67], v[132:135]
ds_read_b128 v[20:23], v7 offset:43008
buffer_load_dwordx4 v[64:67], v2, s[4:7], s63 offen offset:3072
s_waitcnt vmcnt(16)
s_waitcnt lgkmcnt(6)
v_mfma_f32_16x16x32_bf16 v[104:107], v[24:27], v[252:255], v[104:107]
v_mfma_f32_16x16x32_bf16 v[120:123], v[24:27], v[68:71], v[120:123]
ds_read_b128 v[24:27], v7 offset:25600
v_mfma_f32_16x16x32_bf16 v[108:111], v[28:31], v[252:255], v[108:111]
v_mfma_f32_16x16x32_bf16 v[124:127], v[28:31], v[68:71], v[124:127]
ds_read_b128 v[28:31], v7 offset:31744
s_waitcnt lgkmcnt(6)
v_mfma_f32_16x16x32_bf16 v[112:115], v[32:35], v[252:255], v[112:115]
v_mfma_f32_16x16x32_bf16 v[128:131], v[32:35], v[68:71], v[128:131]
ds_read_b128 v[32:35], v7 offset:37888
v_mfma_f32_16x16x32_bf16 v[116:119], v[36:39], v[252:255], v[116:119]
v_mfma_f32_16x16x32_bf16 v[132:135], v[36:39], v[68:71], v[132:135]
ds_read_b128 v[36:39], v7 offset:44032
s_add_u32 s63, s62, 40960
buffer_load_dwordx4 v[68:71], v2, s[4:7], s63 offen offset:0
s_barrier
s_waitcnt vmcnt(16)
s_waitcnt lgkmcnt(6)
v_mfma_f32_16x16x32_bf16 v[104:107], v[8:11], a[0:3], v[104:107]
v_mfma_f32_16x16x32_bf16 v[120:123], v[8:11], v[72:75], v[120:123]
ds_read_b128 v[8:11], v7 offset:26624
v_mfma_f32_16x16x32_bf16 v[108:111], v[12:15], a[0:3], v[108:111]
v_mfma_f32_16x16x32_bf16 v[124:127], v[12:15], v[72:75], v[124:127]
ds_read_b128 v[12:15], v7 offset:32768
s_waitcnt lgkmcnt(6)
v_mfma_f32_16x16x32_bf16 v[112:115], v[16:19], a[0:3], v[112:115]
v_mfma_f32_16x16x32_bf16 v[128:131], v[16:19], v[72:75], v[128:131]
ds_read_b128 v[16:19], v7 offset:38912
v_mfma_f32_16x16x32_bf16 v[116:119], v[20:23], a[0:3], v[116:119]
v_mfma_f32_16x16x32_bf16 v[132:135], v[20:23], v[72:75], v[132:135]
ds_read_b128 v[20:23], v7 offset:45056
buffer_load_dwordx4 v[72:75], v2, s[4:7], s63 offen offset:1024
s_waitcnt vmcnt(16)
s_waitcnt lgkmcnt(6)
v_mfma_f32_16x16x32_bf16 v[104:107], v[24:27], a[4:7], v[104:107]
v_mfma_f32_16x16x32_bf16 v[120:123], v[24:27], v[76:79], v[120:123]
ds_read_b128 v[24:27], v7 offset:27648
v_mfma_f32_16x16x32_bf16 v[108:111], v[28:31], a[4:7], v[108:111]
v_mfma_f32_16x16x32_bf16 v[124:127], v[28:31], v[76:79], v[124:127]
ds_read_b128 v[28:31], v7 offset:33792
s_waitcnt lgkmcnt(6)
v_mfma_f32_16x16x32_bf16 v[112:115], v[32:35], a[4:7], v[112:115]
v_mfma_f32_16x16x32_bf16 v[128:131], v[32:35], v[76:79], v[128:131]
ds_read_b128 v[32:35], v7 offset:39936
v_mfma_f32_16x16x32_bf16 v[116:119], v[36:39], a[4:7], v[116:119]
v_mfma_f32_16x16x32_bf16 v[132:135], v[36:39], v[76:79], v[132:135]
ds_read_b128 v[36:39], v7 offset:46080
buffer_load_dwordx4 v[76:79], v2, s[4:7], s63 offen offset:2048
s_waitcnt vmcnt(16)
s_waitcnt lgkmcnt(6)
v_mfma_f32_16x16x32_bf16 v[104:107], v[8:11], a[8:11], v[104:107]
v_mfma_f32_16x16x32_bf16 v[120:123], v[8:11], v[80:83], v[120:123]
ds_read_b128 v[8:11], v7 offset:28672
v_mfma_f32_16x16x32_bf16 v[108:111], v[12:15], a[8:11], v[108:111]
v_mfma_f32_16x16x32_bf16 v[124:127], v[12:15], v[80:83], v[124:127]
ds_read_b128 v[12:15], v7 offset:34816
s_waitcnt lgkmcnt(6)
v_mfma_f32_16x16x32_bf16 v[112:115], v[16:19], a[8:11], v[112:115]
v_mfma_f32_16x16x32_bf16 v[128:131], v[16:19], v[80:83], v[128:131]
ds_read_b128 v[16:19], v7 offset:40960
v_mfma_f32_16x16x32_bf16 v[116:119], v[20:23], a[8:11], v[116:119]
v_mfma_f32_16x16x32_bf16 v[132:135], v[20:23], v[80:83], v[132:135]
ds_read_b128 v[20:23], v7 offset:47104
buffer_load_dwordx4 v[80:83], v2, s[4:7], s63 offen offset:3072
s_waitcnt vmcnt(16)
s_waitcnt lgkmcnt(6)
v_mfma_f32_16x16x32_bf16 v[104:107], v[24:27], a[12:15], v[104:107]
v_mfma_f32_16x16x32_bf16 v[120:123], v[24:27], v[40:43], v[120:123]
ds_read_b128 v[24:27], v7 offset:29696
v_mfma_f32_16x16x32_bf16 v[108:111], v[28:31], a[12:15], v[108:111]
v_mfma_f32_16x16x32_bf16 v[124:127], v[28:31], v[40:43], v[124:127]
ds_read_b128 v[28:31], v7 offset:35840
s_waitcnt lgkmcnt(6)
v_mfma_f32_16x16x32_bf16 v[112:115], v[32:35], a[12:15], v[112:115]
v_mfma_f32_16x16x32_bf16 v[128:131], v[32:35], v[40:43], v[128:131]
ds_read_b128 v[32:35], v7 offset:41984
v_mfma_f32_16x16x32_bf16 v[116:119], v[36:39], a[12:15], v[116:119]
v_mfma_f32_16x16x32_bf16 v[132:135], v[36:39], v[40:43], v[132:135]
ds_read_b128 v[36:39], v7 offset:48128
s_add_u32 s63, s62, 45056
buffer_load_dwordx4 v[40:43], v2, s[4:7], s63 offen offset:0
s_waitcnt vmcnt(16)
s_waitcnt lgkmcnt(6)
v_mfma_f32_16x16x32_bf16 v[104:107], v[8:11], a[16:19], v[104:107]
v_mfma_f32_16x16x32_bf16 v[120:123], v[8:11], v[44:47], v[120:123]
ds_read_b128 v[8:11], v2 offset:0
v_mfma_f32_16x16x32_bf16 v[108:111], v[12:15], a[16:19], v[108:111]
v_mfma_f32_16x16x32_bf16 v[124:127], v[12:15], v[44:47], v[124:127]
ds_read_b128 v[12:15], v2 offset:6144
s_waitcnt lgkmcnt(6)
v_mfma_f32_16x16x32_bf16 v[112:115], v[16:19], a[16:19], v[112:115]
v_mfma_f32_16x16x32_bf16 v[128:131], v[16:19], v[44:47], v[128:131]
ds_read_b128 v[16:19], v2 offset:12288
v_mfma_f32_16x16x32_bf16 v[116:119], v[20:23], a[16:19], v[116:119]
v_mfma_f32_16x16x32_bf16 v[132:135], v[20:23], v[44:47], v[132:135]
ds_read_b128 v[20:23], v2 offset:18432
buffer_load_dwordx4 v[44:47], v2, s[4:7], s63 offen offset:1024
s_waitcnt vmcnt(10)
s_waitcnt lgkmcnt(6)
v_mfma_f32_16x16x32_bf16 v[104:107], v[24:27], a[20:23], v[104:107]
v_mfma_f32_16x16x32_bf16 v[120:123], v[24:27], v[48:51], v[120:123]
ds_read_b128 v[24:27], v2 offset:1024
v_mfma_f32_16x16x32_bf16 v[108:111], v[28:31], a[20:23], v[108:111]
v_mfma_f32_16x16x32_bf16 v[124:127], v[28:31], v[48:51], v[124:127]
ds_read_b128 v[28:31], v2 offset:7168
s_waitcnt lgkmcnt(6)
v_mfma_f32_16x16x32_bf16 v[112:115], v[32:35], a[20:23], v[112:115]
v_mfma_f32_16x16x32_bf16 v[128:131], v[32:35], v[48:51], v[128:131]
ds_read_b128 v[32:35], v2 offset:13312
v_mfma_f32_16x16x32_bf16 v[116:119], v[36:39], a[20:23], v[116:119]
v_mfma_f32_16x16x32_bf16 v[132:135], v[36:39], v[48:51], v[132:135]
ds_read_b128 v[36:39], v2 offset:19456
buffer_load_dwordx4 v[48:51], v2, s[4:7], s63 offen offset:2048
s_barrier
s_waitcnt vmcnt(10)
s_waitcnt lgkmcnt(6)
v_mfma_f32_16x16x32_bf16 v[104:107], v[8:11], a[24:27], v[104:107]
v_mfma_f32_16x16x32_bf16 v[120:123], v[8:11], v[52:55], v[120:123]
ds_read_b128 v[8:11], v2 offset:2048
v_mfma_f32_16x16x32_bf16 v[108:111], v[12:15], a[24:27], v[108:111]
v_mfma_f32_16x16x32_bf16 v[124:127], v[12:15], v[52:55], v[124:127]
ds_read_b128 v[12:15], v2 offset:8192
s_waitcnt lgkmcnt(6)
v_mfma_f32_16x16x32_bf16 v[112:115], v[16:19], a[24:27], v[112:115]
v_mfma_f32_16x16x32_bf16 v[128:131], v[16:19], v[52:55], v[128:131]
ds_read_b128 v[16:19], v2 offset:14336
v_mfma_f32_16x16x32_bf16 v[116:119], v[20:23], a[24:27], v[116:119]
v_mfma_f32_16x16x32_bf16 v[132:135], v[20:23], v[52:55], v[132:135]
ds_read_b128 v[20:23], v2 offset:20480
buffer_load_dwordx4 v[52:55], v2, s[4:7], s63 offen offset:3072
s_waitcnt vmcnt(10)
s_waitcnt lgkmcnt(6)
v_mfma_f32_16x16x32_bf16 v[104:107], v[24:27], a[28:31], v[104:107]
v_mfma_f32_16x16x32_bf16 v[120:123], v[24:27], v[56:59], v[120:123]
ds_read_b128 v[24:27], v2 offset:3072
v_mfma_f32_16x16x32_bf16 v[108:111], v[28:31], a[28:31], v[108:111]
v_mfma_f32_16x16x32_bf16 v[124:127], v[28:31], v[56:59], v[124:127]
ds_read_b128 v[28:31], v2 offset:9216
s_waitcnt lgkmcnt(6)
v_mfma_f32_16x16x32_bf16 v[112:115], v[32:35], a[28:31], v[112:115]
v_mfma_f32_16x16x32_bf16 v[128:131], v[32:35], v[56:59], v[128:131]
ds_read_b128 v[32:35], v2 offset:15360
v_mfma_f32_16x16x32_bf16 v[116:119], v[36:39], a[28:31], v[116:119]
v_mfma_f32_16x16x32_bf16 v[132:135], v[36:39], v[56:59], v[132:135]
ds_read_b128 v[36:39], v2 offset:21504
s_add_u32 s63, s62, 49152
buffer_load_dwordx4 v[56:59], v2, s[4:7], s63 offen offset:0
s_waitcnt vmcnt(10)
s_waitcnt lgkmcnt(6)
v_mfma_f32_16x16x32_bf16 v[104:107], v[8:11], a[32:35], v[104:107]
v_mfma_f32_16x16x32_bf16 v[120:123], v[8:11], v[60:63], v[120:123]
ds_read_b128 v[8:11], v2 offset:4096
v_mfma_f32_16x16x32_bf16 v[108:111], v[12:15], a[32:35], v[108:111]
v_mfma_f32_16x16x32_bf16 v[124:127], v[12:15], v[60:63], v[124:127]
ds_read_b128 v[12:15], v2 offset:10240
s_waitcnt lgkmcnt(6)
v_mfma_f32_16x16x32_bf16 v[112:115], v[16:19], a[32:35], v[112:115]
v_mfma_f32_16x16x32_bf16 v[128:131], v[16:19], v[60:63], v[128:131]
ds_read_b128 v[16:19], v2 offset:16384
v_mfma_f32_16x16x32_bf16 v[116:119], v[20:23], a[32:35], v[116:119]
v_mfma_f32_16x16x32_bf16 v[132:135], v[20:23], v[60:63], v[132:135]
ds_read_b128 v[20:23], v2 offset:22528
buffer_load_dwordx4 v[60:63], v2, s[4:7], s63 offen offset:1024
s_waitcnt vmcnt(10)
s_waitcnt lgkmcnt(6)
v_mfma_f32_16x16x32_bf16 v[104:107], v[24:27], a[36:39], v[104:107]
v_mfma_f32_16x16x32_bf16 v[120:123], v[24:27], v[64:67], v[120:123]
ds_read_b128 v[24:27], v2 offset:5120
v_mfma_f32_16x16x32_bf16 v[108:111], v[28:31], a[36:39], v[108:111]
v_mfma_f32_16x16x32_bf16 v[124:127], v[28:31], v[64:67], v[124:127]
ds_read_b128 v[28:31], v2 offset:11264
s_waitcnt lgkmcnt(6)
v_mfma_f32_16x16x32_bf16 v[112:115], v[32:35], a[36:39], v[112:115]
v_mfma_f32_16x16x32_bf16 v[128:131], v[32:35], v[64:67], v[128:131]
ds_read_b128 v[32:35], v2 offset:17408
v_mfma_f32_16x16x32_bf16 v[116:119], v[36:39], a[36:39], v[116:119]
v_mfma_f32_16x16x32_bf16 v[132:135], v[36:39], v[64:67], v[132:135]
ds_read_b128 v[36:39], v2 offset:23552
buffer_load_dwordx4 v[64:67], v2, s[4:7], s63 offen offset:2048
s_waitcnt vmcnt(10)
s_waitcnt lgkmcnt(6)
v_mfma_f32_16x16x32_bf16 v[104:107], v[8:11], a[40:43], v[104:107]
v_mfma_f32_16x16x32_bf16 v[120:123], v[8:11], v[68:71], v[120:123]
ds_read_b128 v[8:11], v2 offset:24576
v_mfma_f32_16x16x32_bf16 v[108:111], v[12:15], a[40:43], v[108:111]
v_mfma_f32_16x16x32_bf16 v[124:127], v[12:15], v[68:71], v[124:127]
ds_read_b128 v[12:15], v2 offset:30720
s_waitcnt lgkmcnt(6)
v_mfma_f32_16x16x32_bf16 v[112:115], v[16:19], a[40:43], v[112:115]
v_mfma_f32_16x16x32_bf16 v[128:131], v[16:19], v[68:71], v[128:131]
ds_read_b128 v[16:19], v2 offset:36864
v_mfma_f32_16x16x32_bf16 v[116:119], v[20:23], a[40:43], v[116:119]
v_mfma_f32_16x16x32_bf16 v[132:135], v[20:23], v[68:71], v[132:135]
ds_read_b128 v[20:23], v2 offset:43008
buffer_load_dwordx4 v[68:71], v2, s[4:7], s63 offen offset:3072
s_waitcnt vmcnt(10)
s_waitcnt lgkmcnt(6)
v_mfma_f32_16x16x32_bf16 v[104:107], v[24:27], a[44:47], v[104:107]
v_mfma_f32_16x16x32_bf16 v[120:123], v[24:27], v[72:75], v[120:123]
ds_read_b128 v[24:27], v2 offset:25600
v_mfma_f32_16x16x32_bf16 v[108:111], v[28:31], a[44:47], v[108:111]
v_mfma_f32_16x16x32_bf16 v[124:127], v[28:31], v[72:75], v[124:127]
ds_read_b128 v[28:31], v2 offset:31744
s_waitcnt lgkmcnt(6)
v_mfma_f32_16x16x32_bf16 v[112:115], v[32:35], a[44:47], v[112:115]
v_mfma_f32_16x16x32_bf16 v[128:131], v[32:35], v[72:75], v[128:131]
ds_read_b128 v[32:35], v2 offset:37888
v_mfma_f32_16x16x32_bf16 v[116:119], v[36:39], a[44:47], v[116:119]
v_mfma_f32_16x16x32_bf16 v[132:135], v[36:39], v[72:75], v[132:135]
ds_read_b128 v[36:39], v2 offset:44032
s_add_u32 s63, s62, 53248
buffer_load_dwordx4 v[72:75], v2, s[4:7], s63 offen offset:0
s_barrier
s_waitcnt vmcnt(10)
s_waitcnt lgkmcnt(6)
v_mfma_f32_16x16x32_bf16 v[104:107], v[8:11], a[48:51], v[104:107]
v_mfma_f32_16x16x32_bf16 v[120:123], v[8:11], v[76:79], v[120:123]
ds_read_b128 v[8:11], v2 offset:26624
v_mfma_f32_16x16x32_bf16 v[108:111], v[12:15], a[48:51], v[108:111]
v_mfma_f32_16x16x32_bf16 v[124:127], v[12:15], v[76:79], v[124:127]
ds_read_b128 v[12:15], v2 offset:32768
s_waitcnt lgkmcnt(6)
v_mfma_f32_16x16x32_bf16 v[112:115], v[16:19], a[48:51], v[112:115]
v_mfma_f32_16x16x32_bf16 v[128:131], v[16:19], v[76:79], v[128:131]
ds_read_b128 v[16:19], v2 offset:38912
v_mfma_f32_16x16x32_bf16 v[116:119], v[20:23], a[48:51], v[116:119]
v_mfma_f32_16x16x32_bf16 v[132:135], v[20:23], v[76:79], v[132:135]
ds_read_b128 v[20:23], v2 offset:45056
buffer_load_dwordx4 v[76:79], v2, s[4:7], s63 offen offset:1024
s_waitcnt vmcnt(10)
s_waitcnt lgkmcnt(6)
v_mfma_f32_16x16x32_bf16 v[104:107], v[24:27], a[52:55], v[104:107]
v_mfma_f32_16x16x32_bf16 v[120:123], v[24:27], v[80:83], v[120:123]
ds_read_b128 v[24:27], v2 offset:27648
v_mfma_f32_16x16x32_bf16 v[108:111], v[28:31], a[52:55], v[108:111]
v_mfma_f32_16x16x32_bf16 v[124:127], v[28:31], v[80:83], v[124:127]
ds_read_b128 v[28:31], v2 offset:33792
s_waitcnt lgkmcnt(6)
v_mfma_f32_16x16x32_bf16 v[112:115], v[32:35], a[52:55], v[112:115]
v_mfma_f32_16x16x32_bf16 v[128:131], v[32:35], v[80:83], v[128:131]
ds_read_b128 v[32:35], v2 offset:39936
v_mfma_f32_16x16x32_bf16 v[116:119], v[36:39], a[52:55], v[116:119]
v_mfma_f32_16x16x32_bf16 v[132:135], v[36:39], v[80:83], v[132:135]
ds_read_b128 v[36:39], v2 offset:46080
s_waitcnt vmcnt(9)
s_waitcnt lgkmcnt(6)
v_mfma_f32_16x16x32_bf16 v[104:107], v[8:11], a[56:59], v[104:107]
v_mfma_f32_16x16x32_bf16 v[120:123], v[8:11], v[40:43], v[120:123]
ds_read_b128 v[8:11], v2 offset:28672
v_mfma_f32_16x16x32_bf16 v[108:111], v[12:15], a[56:59], v[108:111]
v_mfma_f32_16x16x32_bf16 v[124:127], v[12:15], v[40:43], v[124:127]
ds_read_b128 v[12:15], v2 offset:34816
s_waitcnt lgkmcnt(6)
v_mfma_f32_16x16x32_bf16 v[112:115], v[16:19], a[56:59], v[112:115]
v_mfma_f32_16x16x32_bf16 v[128:131], v[16:19], v[40:43], v[128:131]
ds_read_b128 v[16:19], v2 offset:40960
v_mfma_f32_16x16x32_bf16 v[116:119], v[20:23], a[56:59], v[116:119]
v_mfma_f32_16x16x32_bf16 v[132:135], v[20:23], v[40:43], v[132:135]
ds_read_b128 v[20:23], v2 offset:47104
s_waitcnt vmcnt(8)
s_waitcnt lgkmcnt(6)
v_mfma_f32_16x16x32_bf16 v[104:107], v[24:27], a[60:63], v[104:107]
v_mfma_f32_16x16x32_bf16 v[120:123], v[24:27], v[44:47], v[120:123]
ds_read_b128 v[24:27], v2 offset:29696
v_mfma_f32_16x16x32_bf16 v[108:111], v[28:31], a[60:63], v[108:111]
v_mfma_f32_16x16x32_bf16 v[124:127], v[28:31], v[44:47], v[124:127]
ds_read_b128 v[28:31], v2 offset:35840
s_waitcnt lgkmcnt(6)
v_mfma_f32_16x16x32_bf16 v[112:115], v[32:35], a[60:63], v[112:115]
v_mfma_f32_16x16x32_bf16 v[128:131], v[32:35], v[44:47], v[128:131]
ds_read_b128 v[32:35], v2 offset:41984
v_mfma_f32_16x16x32_bf16 v[116:119], v[36:39], a[60:63], v[116:119]
v_mfma_f32_16x16x32_bf16 v[132:135], v[36:39], v[44:47], v[132:135]
ds_read_b128 v[36:39], v2 offset:48128
s_waitcnt vmcnt(7)
s_waitcnt lgkmcnt(6)
v_mfma_f32_16x16x32_bf16 v[104:107], v[8:11], a[64:67], v[104:107]
v_mfma_f32_16x16x32_bf16 v[120:123], v[8:11], v[48:51], v[120:123]
ds_read_b128 v[8:11], v5 offset:0
v_mfma_f32_16x16x32_bf16 v[108:111], v[12:15], a[64:67], v[108:111]
v_mfma_f32_16x16x32_bf16 v[124:127], v[12:15], v[48:51], v[124:127]
ds_read_b128 v[12:15], v5 offset:6144
s_waitcnt lgkmcnt(6)
v_mfma_f32_16x16x32_bf16 v[112:115], v[16:19], a[64:67], v[112:115]
v_mfma_f32_16x16x32_bf16 v[128:131], v[16:19], v[48:51], v[128:131]
ds_read_b128 v[16:19], v5 offset:12288
v_mfma_f32_16x16x32_bf16 v[116:119], v[20:23], a[64:67], v[116:119]
v_mfma_f32_16x16x32_bf16 v[132:135], v[20:23], v[48:51], v[132:135]
ds_read_b128 v[20:23], v5 offset:18432
s_waitcnt vmcnt(6)
s_waitcnt lgkmcnt(6)
v_mfma_f32_16x16x32_bf16 v[104:107], v[24:27], a[68:71], v[104:107]
v_mfma_f32_16x16x32_bf16 v[120:123], v[24:27], v[52:55], v[120:123]
ds_read_b128 v[24:27], v5 offset:1024
v_mfma_f32_16x16x32_bf16 v[108:111], v[28:31], a[68:71], v[108:111]
v_mfma_f32_16x16x32_bf16 v[124:127], v[28:31], v[52:55], v[124:127]
ds_read_b128 v[28:31], v5 offset:7168
s_waitcnt lgkmcnt(6)
v_mfma_f32_16x16x32_bf16 v[112:115], v[32:35], a[68:71], v[112:115]
v_mfma_f32_16x16x32_bf16 v[128:131], v[32:35], v[52:55], v[128:131]
ds_read_b128 v[32:35], v5 offset:13312
v_mfma_f32_16x16x32_bf16 v[116:119], v[36:39], a[68:71], v[116:119]
v_mfma_f32_16x16x32_bf16 v[132:135], v[36:39], v[52:55], v[132:135]
ds_read_b128 v[36:39], v5 offset:19456
s_barrier
s_waitcnt vmcnt(5)
s_waitcnt lgkmcnt(6)
v_mfma_f32_16x16x32_bf16 v[104:107], v[8:11], a[72:75], v[104:107]
v_mfma_f32_16x16x32_bf16 v[120:123], v[8:11], v[56:59], v[120:123]
ds_read_b128 v[8:11], v5 offset:2048
v_mfma_f32_16x16x32_bf16 v[108:111], v[12:15], a[72:75], v[108:111]
v_mfma_f32_16x16x32_bf16 v[124:127], v[12:15], v[56:59], v[124:127]
ds_read_b128 v[12:15], v5 offset:8192
s_waitcnt lgkmcnt(6)
v_mfma_f32_16x16x32_bf16 v[112:115], v[16:19], a[72:75], v[112:115]
v_mfma_f32_16x16x32_bf16 v[128:131], v[16:19], v[56:59], v[128:131]
ds_read_b128 v[16:19], v5 offset:14336
v_mfma_f32_16x16x32_bf16 v[116:119], v[20:23], a[72:75], v[116:119]
v_mfma_f32_16x16x32_bf16 v[132:135], v[20:23], v[56:59], v[132:135]
ds_read_b128 v[20:23], v5 offset:20480
s_waitcnt vmcnt(4)
s_waitcnt lgkmcnt(6)
v_mfma_f32_16x16x32_bf16 v[104:107], v[24:27], a[76:79], v[104:107]
v_mfma_f32_16x16x32_bf16 v[120:123], v[24:27], v[60:63], v[120:123]
ds_read_b128 v[24:27], v5 offset:3072
v_mfma_f32_16x16x32_bf16 v[108:111], v[28:31], a[76:79], v[108:111]
v_mfma_f32_16x16x32_bf16 v[124:127], v[28:31], v[60:63], v[124:127]
ds_read_b128 v[28:31], v5 offset:9216
s_waitcnt lgkmcnt(6)
v_mfma_f32_16x16x32_bf16 v[112:115], v[32:35], a[76:79], v[112:115]
v_mfma_f32_16x16x32_bf16 v[128:131], v[32:35], v[60:63], v[128:131]
ds_read_b128 v[32:35], v5 offset:15360
v_mfma_f32_16x16x32_bf16 v[116:119], v[36:39], a[76:79], v[116:119]
v_mfma_f32_16x16x32_bf16 v[132:135], v[36:39], v[60:63], v[132:135]
ds_read_b128 v[36:39], v5 offset:21504
s_waitcnt vmcnt(3)
s_waitcnt lgkmcnt(6)
v_mfma_f32_16x16x32_bf16 v[104:107], v[8:11], a[80:83], v[104:107]
v_mfma_f32_16x16x32_bf16 v[120:123], v[8:11], v[64:67], v[120:123]
ds_read_b128 v[8:11], v5 offset:4096
v_mfma_f32_16x16x32_bf16 v[108:111], v[12:15], a[80:83], v[108:111]
v_mfma_f32_16x16x32_bf16 v[124:127], v[12:15], v[64:67], v[124:127]
ds_read_b128 v[12:15], v5 offset:10240
s_waitcnt lgkmcnt(6)
v_mfma_f32_16x16x32_bf16 v[112:115], v[16:19], a[80:83], v[112:115]
v_mfma_f32_16x16x32_bf16 v[128:131], v[16:19], v[64:67], v[128:131]
ds_read_b128 v[16:19], v5 offset:16384
v_mfma_f32_16x16x32_bf16 v[116:119], v[20:23], a[80:83], v[116:119]
v_mfma_f32_16x16x32_bf16 v[132:135], v[20:23], v[64:67], v[132:135]
ds_read_b128 v[20:23], v5 offset:22528
s_waitcnt vmcnt(2)
s_waitcnt lgkmcnt(6)
v_mfma_f32_16x16x32_bf16 v[104:107], v[24:27], a[84:87], v[104:107]
v_mfma_f32_16x16x32_bf16 v[120:123], v[24:27], v[68:71], v[120:123]
ds_read_b128 v[24:27], v5 offset:5120
v_mfma_f32_16x16x32_bf16 v[108:111], v[28:31], a[84:87], v[108:111]
v_mfma_f32_16x16x32_bf16 v[124:127], v[28:31], v[68:71], v[124:127]
ds_read_b128 v[28:31], v5 offset:11264
s_waitcnt lgkmcnt(6)
v_mfma_f32_16x16x32_bf16 v[112:115], v[32:35], a[84:87], v[112:115]
v_mfma_f32_16x16x32_bf16 v[128:131], v[32:35], v[68:71], v[128:131]
ds_read_b128 v[32:35], v5 offset:17408
v_mfma_f32_16x16x32_bf16 v[116:119], v[36:39], a[84:87], v[116:119]
v_mfma_f32_16x16x32_bf16 v[132:135], v[36:39], v[68:71], v[132:135]
ds_read_b128 v[36:39], v5 offset:23552
s_waitcnt vmcnt(1)
s_waitcnt lgkmcnt(6)
v_mfma_f32_16x16x32_bf16 v[104:107], v[8:11], a[88:91], v[104:107]
v_mfma_f32_16x16x32_bf16 v[120:123], v[8:11], v[72:75], v[120:123]
v_mfma_f32_16x16x32_bf16 v[108:111], v[12:15], a[88:91], v[108:111]
v_mfma_f32_16x16x32_bf16 v[124:127], v[12:15], v[72:75], v[124:127]
s_waitcnt lgkmcnt(4)
v_mfma_f32_16x16x32_bf16 v[112:115], v[16:19], a[88:91], v[112:115]
v_mfma_f32_16x16x32_bf16 v[128:131], v[16:19], v[72:75], v[128:131]
v_mfma_f32_16x16x32_bf16 v[116:119], v[20:23], a[88:91], v[116:119]
v_mfma_f32_16x16x32_bf16 v[132:135], v[20:23], v[72:75], v[132:135]
s_waitcnt vmcnt(0)
s_waitcnt lgkmcnt(2)
v_mfma_f32_16x16x32_bf16 v[104:107], v[24:27], a[92:95], v[104:107]
v_mfma_f32_16x16x32_bf16 v[120:123], v[24:27], v[76:79], v[120:123]
v_mfma_f32_16x16x32_bf16 v[108:111], v[28:31], a[92:95], v[108:111]
v_mfma_f32_16x16x32_bf16 v[124:127], v[28:31], v[76:79], v[124:127]
s_waitcnt lgkmcnt(0)
v_mfma_f32_16x16x32_bf16 v[112:115], v[32:35], a[92:95], v[112:115]
v_mfma_f32_16x16x32_bf16 v[128:131], v[32:35], v[76:79], v[128:131]
v_mfma_f32_16x16x32_bf16 v[116:119], v[36:39], a[92:95], v[116:119]
v_mfma_f32_16x16x32_bf16 v[132:135], v[36:39], v[76:79], v[132:135]
s_waitcnt vmcnt(0) lgkmcnt(0)
v_lshlrev_b32 v100, 16, v100
v_mov_b32 v101, v100
v_lshlrev_b32 v102, 16, v102
v_mov_b32 v103, v102
s_add_u32 s52, s68, 150994944
s_add_u32 s51, s52, 20480
s_add_u32 s53, s70, 20480
v_cvt_pk_bf16_f32 v8, v104, v105
v_cvt_pk_bf16_f32 v9, v106, v107
v_cvt_pk_bf16_f32 v10, v108, v109
v_cvt_pk_bf16_f32 v11, v110, v111
v_and_b32 v105, 0xffff0000, v8
v_lshlrev_b32 v104, 16, v8
v_and_b32 v107, 0xffff0000, v9
v_lshlrev_b32 v106, 16, v9
v_and_b32 v109, 0xffff0000, v10
v_lshlrev_b32 v108, 16, v10
v_and_b32 v111, 0xffff0000, v11
v_lshlrev_b32 v110, 16, v11
v_pk_add_f32 v[104:105], v[104:105], v[100:101]
v_pk_add_f32 v[106:107], v[106:107], v[100:101]
v_pk_add_f32 v[108:109], v[108:109], v[100:101]
v_pk_add_f32 v[110:111], v[110:111], v[100:101]
v_cvt_pk_bf16_f32 v8, v104, v105
v_cvt_pk_bf16_f32 v9, v106, v107
v_cvt_pk_bf16_f32 v10, v108, v109
v_cvt_pk_bf16_f32 v11, v110, v111
v_and_b32 v105, 0xffff0000, v8
v_lshlrev_b32 v104, 16, v8
v_and_b32 v107, 0xffff0000, v9
v_lshlrev_b32 v106, 16, v9
v_and_b32 v109, 0xffff0000, v10
v_lshlrev_b32 v108, 16, v10
v_and_b32 v111, 0xffff0000, v11
v_lshlrev_b32 v110, 16, v11
v_and_b32 v17, 0xffff0000, v84
v_lshlrev_b32 v16, 16, v84
v_and_b32 v19, 0xffff0000, v85
v_lshlrev_b32 v18, 16, v85
v_and_b32 v21, 0xffff0000, v86
v_lshlrev_b32 v20, 16, v86
v_and_b32 v23, 0xffff0000, v87
v_lshlrev_b32 v22, 16, v87
v_pk_add_f32 v[104:105], v[104:105], v[16:17]
v_pk_add_f32 v[106:107], v[106:107], v[18:19]
v_pk_add_f32 v[108:109], v[108:109], v[20:21]
v_pk_add_f32 v[110:111], v[110:111], v[22:23]
v_cvt_pk_bf16_f32 v84, v104, v105
v_cvt_pk_bf16_f32 v85, v106, v107
v_cvt_pk_bf16_f32 v86, v108, v109
v_cvt_pk_bf16_f32 v87, v110, v111
v_cvt_pk_bf16_f32 v8, v112, v113
v_cvt_pk_bf16_f32 v9, v114, v115
v_cvt_pk_bf16_f32 v10, v116, v117
v_cvt_pk_bf16_f32 v11, v118, v119
v_and_b32 v113, 0xffff0000, v8
v_lshlrev_b32 v112, 16, v8
v_and_b32 v115, 0xffff0000, v9
v_lshlrev_b32 v114, 16, v9
v_and_b32 v117, 0xffff0000, v10
v_lshlrev_b32 v116, 16, v10
v_and_b32 v119, 0xffff0000, v11
v_lshlrev_b32 v118, 16, v11
v_pk_add_f32 v[112:113], v[112:113], v[100:101]
v_pk_add_f32 v[114:115], v[114:115], v[100:101]
v_pk_add_f32 v[116:117], v[116:117], v[100:101]
v_pk_add_f32 v[118:119], v[118:119], v[100:101]
v_cvt_pk_bf16_f32 v8, v112, v113
v_cvt_pk_bf16_f32 v9, v114, v115
v_cvt_pk_bf16_f32 v10, v116, v117
v_cvt_pk_bf16_f32 v11, v118, v119
v_and_b32 v113, 0xffff0000, v8
v_lshlrev_b32 v112, 16, v8
v_and_b32 v115, 0xffff0000, v9
v_lshlrev_b32 v114, 16, v9
v_and_b32 v117, 0xffff0000, v10
v_lshlrev_b32 v116, 16, v10
v_and_b32 v119, 0xffff0000, v11
v_lshlrev_b32 v118, 16, v11
v_and_b32 v17, 0xffff0000, v88
v_lshlrev_b32 v16, 16, v88
v_and_b32 v19, 0xffff0000, v89
v_lshlrev_b32 v18, 16, v89
v_and_b32 v21, 0xffff0000, v90
v_lshlrev_b32 v20, 16, v90
v_and_b32 v23, 0xffff0000, v91
v_lshlrev_b32 v22, 16, v91
v_pk_add_f32 v[112:113], v[112:113], v[16:17]
v_pk_add_f32 v[114:115], v[114:115], v[18:19]
v_pk_add_f32 v[116:117], v[116:117], v[20:21]
v_pk_add_f32 v[118:119], v[118:119], v[22:23]
v_cvt_pk_bf16_f32 v88, v112, v113
v_cvt_pk_bf16_f32 v89, v114, v115
v_cvt_pk_bf16_f32 v90, v116, v117
v_cvt_pk_bf16_f32 v91, v118, v119
v_cvt_pk_bf16_f32 v8, v120, v121
v_cvt_pk_bf16_f32 v9, v122, v123
v_cvt_pk_bf16_f32 v10, v124, v125
v_cvt_pk_bf16_f32 v11, v126, v127
v_and_b32 v121, 0xffff0000, v8
v_lshlrev_b32 v120, 16, v8
v_and_b32 v123, 0xffff0000, v9
v_lshlrev_b32 v122, 16, v9
v_and_b32 v125, 0xffff0000, v10
v_lshlrev_b32 v124, 16, v10
v_and_b32 v127, 0xffff0000, v11
v_lshlrev_b32 v126, 16, v11
v_pk_add_f32 v[120:121], v[120:121], v[102:103]
v_pk_add_f32 v[122:123], v[122:123], v[102:103]
v_pk_add_f32 v[124:125], v[124:125], v[102:103]
v_pk_add_f32 v[126:127], v[126:127], v[102:103]
v_cvt_pk_bf16_f32 v8, v120, v121
v_cvt_pk_bf16_f32 v9, v122, v123
v_cvt_pk_bf16_f32 v10, v124, v125
v_cvt_pk_bf16_f32 v11, v126, v127
v_and_b32 v121, 0xffff0000, v8
v_lshlrev_b32 v120, 16, v8
v_and_b32 v123, 0xffff0000, v9
v_lshlrev_b32 v122, 16, v9
v_and_b32 v125, 0xffff0000, v10
v_lshlrev_b32 v124, 16, v10
v_and_b32 v127, 0xffff0000, v11
v_lshlrev_b32 v126, 16, v11
v_and_b32 v17, 0xffff0000, v92
v_lshlrev_b32 v16, 16, v92
v_and_b32 v19, 0xffff0000, v93
v_lshlrev_b32 v18, 16, v93
v_and_b32 v21, 0xffff0000, v94
v_lshlrev_b32 v20, 16, v94
v_and_b32 v23, 0xffff0000, v95
v_lshlrev_b32 v22, 16, v95
v_pk_add_f32 v[120:121], v[120:121], v[16:17]
v_pk_add_f32 v[122:123], v[122:123], v[18:19]
v_pk_add_f32 v[124:125], v[124:125], v[20:21]
v_pk_add_f32 v[126:127], v[126:127], v[22:23]
v_cvt_pk_bf16_f32 v92, v120, v121
v_cvt_pk_bf16_f32 v93, v122, v123
v_cvt_pk_bf16_f32 v94, v124, v125
v_cvt_pk_bf16_f32 v95, v126, v127
v_cvt_pk_bf16_f32 v8, v128, v129
v_cvt_pk_bf16_f32 v9, v130, v131
v_cvt_pk_bf16_f32 v10, v132, v133
v_cvt_pk_bf16_f32 v11, v134, v135
v_and_b32 v129, 0xffff0000, v8
v_lshlrev_b32 v128, 16, v8
v_and_b32 v131, 0xffff0000, v9
v_lshlrev_b32 v130, 16, v9
v_and_b32 v133, 0xffff0000, v10
v_lshlrev_b32 v132, 16, v10
v_and_b32 v135, 0xffff0000, v11
v_lshlrev_b32 v134, 16, v11
v_pk_add_f32 v[128:129], v[128:129], v[102:103]
v_pk_add_f32 v[130:131], v[130:131], v[102:103]
v_pk_add_f32 v[132:133], v[132:133], v[102:103]
v_pk_add_f32 v[134:135], v[134:135], v[102:103]
v_cvt_pk_bf16_f32 v8, v128, v129
v_cvt_pk_bf16_f32 v9, v130, v131
v_cvt_pk_bf16_f32 v10, v132, v133
v_cvt_pk_bf16_f32 v11, v134, v135
v_and_b32 v129, 0xffff0000, v8
v_lshlrev_b32 v128, 16, v8
v_and_b32 v131, 0xffff0000, v9
v_lshlrev_b32 v130, 16, v9
v_and_b32 v133, 0xffff0000, v10
v_lshlrev_b32 v132, 16, v10
v_and_b32 v135, 0xffff0000, v11
v_lshlrev_b32 v134, 16, v11
v_and_b32 v17, 0xffff0000, v96
v_lshlrev_b32 v16, 16, v96
v_and_b32 v19, 0xffff0000, v97
v_lshlrev_b32 v18, 16, v97
v_and_b32 v21, 0xffff0000, v98
v_lshlrev_b32 v20, 16, v98
v_and_b32 v23, 0xffff0000, v99
v_lshlrev_b32 v22, 16, v99
v_pk_add_f32 v[128:129], v[128:129], v[16:17]
v_pk_add_f32 v[130:131], v[130:131], v[18:19]
v_pk_add_f32 v[132:133], v[132:133], v[20:21]
v_pk_add_f32 v[134:135], v[134:135], v[22:23]
v_cvt_pk_bf16_f32 v96, v128, v129
v_cvt_pk_bf16_f32 v97, v130, v131
v_cvt_pk_bf16_f32 v98, v132, v133
v_cvt_pk_bf16_f32 v99, v134, v135
s_cmp_lg_u32 s50, 0
s_cbranch_scc1 G2L1_35
v_and_b32 v105, 0xffff0000, v84
v_lshlrev_b32 v104, 16, v84
v_and_b32 v107, 0xffff0000, v85
v_lshlrev_b32 v106, 16, v85
v_and_b32 v109, 0xffff0000, v86
v_lshlrev_b32 v108, 16, v86
v_and_b32 v111, 0xffff0000, v87
v_lshlrev_b32 v110, 16, v87
v_and_b32 v113, 0xffff0000, v88
v_lshlrev_b32 v112, 16, v88
v_and_b32 v115, 0xffff0000, v89
v_lshlrev_b32 v114, 16, v89
v_and_b32 v117, 0xffff0000, v90
v_lshlrev_b32 v116, 16, v90
v_and_b32 v119, 0xffff0000, v91
v_lshlrev_b32 v118, 16, v91
v_and_b32 v121, 0xffff0000, v92
v_lshlrev_b32 v120, 16, v92
v_and_b32 v123, 0xffff0000, v93
v_lshlrev_b32 v122, 16, v93
v_and_b32 v125, 0xffff0000, v94
v_lshlrev_b32 v124, 16, v94
v_and_b32 v127, 0xffff0000, v95
v_lshlrev_b32 v126, 16, v95
v_and_b32 v129, 0xffff0000, v96
v_lshlrev_b32 v128, 16, v96
v_and_b32 v131, 0xffff0000, v97
v_lshlrev_b32 v130, 16, v97
v_and_b32 v133, 0xffff0000, v98
v_lshlrev_b32 v132, 16, v98
v_and_b32 v135, 0xffff0000, v99
v_lshlrev_b32 v134, 16, v99
v_pk_add_f32 v[8:9], v[104:105], v[106:107]
v_pk_mul_f32 v[10:11], v[104:105], v[104:105]
v_pk_fma_f32 v[10:11], v[106:107], v[106:107], v[10:11]
v_pk_add_f32 v[8:9], v[8:9], v[108:109]
v_pk_fma_f32 v[10:11], v[108:109], v[108:109], v[10:11]
v_pk_add_f32 v[8:9], v[8:9], v[110:111]
v_pk_fma_f32 v[10:11], v[110:111], v[110:111], v[10:11]
v_pk_add_f32 v[8:9], v[8:9], v[112:113]
v_pk_fma_f32 v[10:11], v[112:113], v[112:113], v[10:11]
v_pk_add_f32 v[8:9], v[8:9], v[114:115]
v_pk_fma_f32 v[10:11], v[114:115], v[114:115], v[10:11]
v_pk_add_f32 v[8:9], v[8:9], v[116:117]
v_pk_fma_f32 v[10:11], v[116:117], v[116:117], v[10:11]
v_pk_add_f32 v[8:9], v[8:9], v[118:119]
v_pk_fma_f32 v[10:11], v[118:119], v[118:119], v[10:11]
v_add_f32 v40, v8, v9
v_add_f32 v41, v10, v11
v_pk_add_f32 v[8:9], v[120:121], v[122:123]
v_pk_mul_f32 v[10:11], v[120:121], v[120:121]
v_pk_fma_f32 v[10:11], v[122:123], v[122:123], v[10:11]
v_pk_add_f32 v[8:9], v[8:9], v[124:125]
v_pk_fma_f32 v[10:11], v[124:125], v[124:125], v[10:11]
v_pk_add_f32 v[8:9], v[8:9], v[126:127]
v_pk_fma_f32 v[10:11], v[126:127], v[126:127], v[10:11]
v_pk_add_f32 v[8:9], v[8:9], v[128:129]
v_pk_fma_f32 v[10:11], v[128:129], v[128:129], v[10:11]
v_pk_add_f32 v[8:9], v[8:9], v[130:131]
v_pk_fma_f32 v[10:11], v[130:131], v[130:131], v[10:11]
v_pk_add_f32 v[8:9], v[8:9], v[132:133]
v_pk_fma_f32 v[10:11], v[132:133], v[132:133], v[10:11]
v_pk_add_f32 v[8:9], v[8:9], v[134:135]
v_pk_fma_f32 v[10:11], v[134:135], v[134:135], v[10:11]
v_add_f32 v42, v8, v9
v_add_f32 v43, v10, v11
v_mov_b32 v8, v40
s_nop 1
v_permlane32_swap_b32 v40, v8
v_add_f32 v40, v40, v8
v_mov_b32 v8, v40
s_nop 1
v_permlane16_swap_b32 v40, v8
v_add_f32 v40, v40, v8
v_mov_b32 v9, v41
s_nop 1
v_permlane32_swap_b32 v41, v9
v_add_f32 v41, v41, v9
v_mov_b32 v9, v41
s_nop 1
v_permlane16_swap_b32 v41, v9
v_add_f32 v41, v41, v9
v_mov_b32 v10, v42
s_nop 1
v_permlane32_swap_b32 v42, v10
v_add_f32 v42, v42, v10
v_mov_b32 v10, v42
s_nop 1
v_permlane16_swap_b32 v42, v10
v_add_f32 v42, v42, v10
v_mov_b32 v11, v43
s_nop 1
v_permlane32_swap_b32 v43, v11
v_add_f32 v43, v43, v11
v_mov_b32 v11, v43
s_nop 1
v_permlane16_swap_b32 v43, v11
v_add_f32 v43, v43, v11
v_cmp_gt_u32 vcc, 16, v1
s_nop 1
v_cndmask_b32 v40, v42, v40, vcc
v_cndmask_b32 v41, v43, v41, vcc
v_min_u32 v40, -2, v40
v_min_u32 v41, -2, v41
v_and_b32 v4, 31, v1
v_lshlrev_b32 v4, 3, v4
s_mul_i32 s53, s55, 10240
s_lshl_b32 s54, s49, 8
s_add_u32 s53, s53, s54
s_add_u32 s53, s53, 1179648
s_lshl_b32 s54, s56, 10
s_add_u32 s54, s54, s53
s_mov_b64 exec, s[66:67]
buffer_store_dwordx2 v[40:41], v4, s[4:7], s54 offen sc1
s_mov_b64 exec, -1
buffer_store_dwordx4 v[84:87], v2, s[4:7], s52 offen offset:0 sc1
buffer_store_dwordx4 v[88:91], v2, s[4:7], s52 offen offset:1024 sc1
buffer_store_dwordx4 v[92:95], v2, s[4:7], s51 offen offset:0 sc1
buffer_store_dwordx4 v[96:99], v2, s[4:7], s51 offen offset:1024 sc1
v_lshrrev_b32 v5, 5, v1
v_mul_u32_u24 v5, 5120, v5
v_add_u32 v5, v5, v4
s_add_u32 s54, s53, 4096
s_mov_b32 s69, 0
G2_ST:
buffer_load_dwordx2 v[44:45], v5, s[4:7], s53 offen offset:0 sc1
buffer_load_dwordx2 v[46:47], v5, s[4:7], s53 offen offset:1024 sc1
buffer_load_dwordx2 v[48:49], v5, s[4:7], s53 offen offset:2048 sc1
buffer_load_dwordx2 v[50:51], v5, s[4:7], s53 offen offset:3072 sc1
buffer_load_dwordx2 v[52:53], v5, s[4:7], s54 offen offset:0 sc1
s_add_u32 s69, s69, 1
s_cmp_gt_u32 s69, 131072
s_cbranch_scc1 ABORT
s_waitcnt vmcnt(0)
v_max3_u32 v8, v44, v45, v46
v_max3_u32 v8, v8, v47, v48
v_max3_u32 v8, v8, v49, v50
v_max3_u32 v8, v8, v51, v52
v_max_u32 v8, v8, v53
v_cmp_eq_u32 vcc, -1, v8
s_cbranch_vccnz G2_ST
v_pk_add_f32 v[44:45], v[44:45], v[46:47]
v_pk_add_f32 v[44:45], v[44:45], v[48:49]
v_pk_add_f32 v[44:45], v[44:45], v[50:51]
v_pk_add_f32 v[44:45], v[44:45], v[52:53]
v_mov_b64 v[8:9], v[44:45]
s_nop 1
v_permlane32_swap_b32 v44, v8
v_permlane32_swap_b32 v45, v9
v_pk_add_f32 v[44:45], v[44:45], v[8:9]
v_mul_f32 v44, 0x3acccccd, v44
v_mul_f32 v45, 0x3acccccd, v45
v_fma_f32 v45, -v44, v44, v45
v_max_f32 v45, 0, v45
v_cvt_pk_bf16_f32 v45, v45, v45
v_and_b32 v45, 0xffff0000, v45
v_add_f32 v45, 0x3727c5ac, v45
v_cvt_pk_bf16_f32 v45, v45, v45
v_and_b32 v45, 0xffff0000, v45
v_sqrt_f32 v45, v45
v_cvt_pk_bf16_f32 v44, v44, v44
v_and_b32 v44, 0xffff0000, v44
v_cvt_pk_bf16_f32 v45, v45, v45
v_and_b32 v45, 0xffff0000, v45
v_rcp_f32 v46, v45
s_nop 0
v_mul_f32 v47, v44, v46
v_mov_b64 v[8:9], v[46:47]
s_nop 1
v_permlane16_swap_b32 v46, v8
v_permlane16_swap_b32 v47, v9
v_mov_b32 v12, v46
v_mov_b32 v13, v46
v_mov_b32 v14, v47
v_mov_b32 v15, v47
v_pk_fma_f32 v[104:105], v[104:105], v[12:13], v[14:15] neg_lo:[0,0,1] neg_hi:[0,0,1]
v_pk_fma_f32 v[106:107], v[106:107], v[12:13], v[14:15] neg_lo:[0,0,1] neg_hi:[0,0,1]
v_pk_fma_f32 v[108:109], v[108:109], v[12:13], v[14:15] neg_lo:[0,0,1] neg_hi:[0,0,1]
v_pk_fma_f32 v[110:111], v[110:111], v[12:13], v[14:15] neg_lo:[0,0,1] neg_hi:[0,0,1]
v_pk_fma_f32 v[112:113], v[112:113], v[12:13], v[14:15] neg_lo:[0,0,1] neg_hi:[0,0,1]
v_pk_fma_f32 v[114:115], v[114:115], v[12:13], v[14:15] neg_lo:[0,0,1] neg_hi:[0,0,1]
v_pk_fma_f32 v[116:117], v[116:117], v[12:13], v[14:15] neg_lo:[0,0,1] neg_hi:[0,0,1]
v_pk_fma_f32 v[118:119], v[118:119], v[12:13], v[14:15] neg_lo:[0,0,1] neg_hi:[0,0,1]
s_add_u32 s54, s52, -14155776
v_cvt_pk_bf16_f32 v56, v104, v105
v_cvt_pk_bf16_f32 v57, v106, v107
v_cvt_pk_bf16_f32 v58, v108, v109
v_cvt_pk_bf16_f32 v59, v110, v111
buffer_store_dwordx4 v[56:59], v2, s[4:7], s54 offen offset:0 sc1
v_cvt_pk_bf16_f32 v60, v112, v113
v_cvt_pk_bf16_f32 v61, v114, v115
v_cvt_pk_bf16_f32 v62, v116, v117
v_cvt_pk_bf16_f32 v63, v118, v119
buffer_store_dwordx4 v[60:63], v2, s[4:7], s54 offen offset:1024 sc1
v_mov_b32 v12, v8
v_mov_b32 v13, v8
v_mov_b32 v14, v9
v_mov_b32 v15, v9
v_pk_fma_f32 v[120:121], v[120:121], v[12:13], v[14:15] neg_lo:[0,0,1] neg_hi:[0,0,1]
v_pk_fma_f32 v[122:123], v[122:123], v[12:13], v[14:15] neg_lo:[0,0,1] neg_hi:[0,0,1]
v_pk_fma_f32 v[124:125], v[124:125], v[12:13], v[14:15] neg_lo:[0,0,1] neg_hi:[0,0,1]
v_pk_fma_f32 v[126:127], v[126:127], v[12:13], v[14:15] neg_lo:[0,0,1] neg_hi:[0,0,1]
v_pk_fma_f32 v[128:129], v[128:129], v[12:13], v[14:15] neg_lo:[0,0,1] neg_hi:[0,0,1]
v_pk_fma_f32 v[130:131], v[130:131], v[12:13], v[14:15] neg_lo:[0,0,1] neg_hi:[0,0,1]
v_pk_fma_f32 v[132:133], v[132:133], v[12:13], v[14:15] neg_lo:[0,0,1] neg_hi:[0,0,1]
v_pk_fma_f32 v[134:135], v[134:135], v[12:13], v[14:15] neg_lo:[0,0,1] neg_hi:[0,0,1]
s_add_u32 s54, s51, -14155776
v_cvt_pk_bf16_f32 v64, v120, v121
v_cvt_pk_bf16_f32 v65, v122, v123
v_cvt_pk_bf16_f32 v66, v124, v125
v_cvt_pk_bf16_f32 v67, v126, v127
buffer_store_dwordx4 v[64:67], v2, s[4:7], s54 offen offset:0 sc1
v_cvt_pk_bf16_f32 v68, v128, v129
v_cvt_pk_bf16_f32 v69, v130, v131
v_cvt_pk_bf16_f32 v70, v132, v133
v_cvt_pk_bf16_f32 v71, v134, v135
buffer_store_dwordx4 v[68:71], v2, s[4:7], s54 offen offset:1024 sc1
s_lshl_b32 s51, s55, 6
s_lshl_b32 s52, s56, 2
s_add_u32 s51, s51, s52
s_add_u32 s51, s51, 14336
s_waitcnt vmcnt(0) lgkmcnt(0)
s_barrier
s_cmp_lg_u32 s49, 0
s_cbranch_scc1 PUB_36
v_mov_b32 v4, 0
v_mov_b32 v5, 1
buffer_store_dword v5, v4, s[4:7], s51 offen sc1
PUB_36:
s_branch G2_DONE
G2L1_35:
buffer_store_dwordx4 v[84:87], v6, s[44:47], s70 offen offset:0
buffer_store_dwordx4 v[88:91], v6, s[44:47], s70 offen offset:64
buffer_store_dwordx4 v[92:95], v6, s[44:47], s53 offen offset:0
buffer_store_dwordx4 v[96:99], v6, s[44:47], s53 offen offset:64
G2_DONE:
s_cmp_lg_u32 s50, 0
s_cbranch_scc1 DONE
s_mov_b32 s50, 1
s_barrier
s_branch GW_LAYER
ROLE_AW:
s_load_dwordx2 s[16:17], s[0:1], 40
s_mov_b32 s18, 5242880
s_mov_b32 s19, 0x20000
v_and_b32 v1, 63, v0
v_lshrrev_b32 v3, 6, v0
v_lshlrev_b32 v2, 4, v1
v_readfirstlane_b32 s49, v3
v_lshrrev_b32 v3, 4, v1
s_mov_b32 s66, -1
s_mov_b32 s67, 0
s_sub_u32 s59, s48, 192
s_and_b32 s58, s59, 1
s_and_b32 s59, s59, 30
s_waitcnt vmcnt(0) lgkmcnt(0)
s_barrier
s_lshl_b32 s36, s39, 4
v_mov_b32 v11, s36
v_cmp_eq_u32 vcc, 0, v0
s_nop 0
s_and_saveexec_b64 s[34:35], vcc
s_cbranch_execz ARR_37
v_mov_b32 v10, 1
buffer_atomic_add v10, v11, s[8:11], s37 offen offset:128 sc1
ARR_37:
s_mov_b64 exec, s[34:35]
s_waitcnt lgkmcnt(0)
v_lshrrev_b32 v4, 2, v1
v_mul_u32_u24 v4, 1280, v4
v_and_b32 v5, 3, v1
v_lshl_add_u32 v4, v5, 4, v4
s_mul_i32 s51, s49, 320
v_add_u32 v4, s51, v4
v_add_u32 v5, 40960, v4
v_add_u32 v10, 81920, v4
v_add_u32 v11, 122880, v4
s_mul_i32 s52, s59, 163840
s_mul_i32 s54, s49, 40960
s_add_u32 s52, s52, s54
s_add_u32 m0, s54, 0
s_add_u32 s53, s52, 0
buffer_load_dwordx4 v2, s[16:19], s53 offen offset:0 lds
buffer_load_dwordx4 v2, s[16:19], s53 offen offset:1024 lds
buffer_load_dwordx4 v2, s[16:19], s53 offen offset:2048 lds
buffer_load_dwordx4 v2, s[16:19], s53 offen offset:3072 lds
s_add_u32 m0, s54, 4096
s_add_u32 s53, s52, 4096
buffer_load_dwordx4 v2, s[16:19], s53 offen offset:0 lds
buffer_load_dwordx4 v2, s[16:19], s53 offen offset:1024 lds
buffer_load_dwordx4 v2, s[16:19], s53 offen offset:2048 lds
buffer_load_dwordx4 v2, s[16:19], s53 offen offset:3072 lds
s_add_u32 m0, s54, 8192
s_add_u32 s53, s52, 8192
buffer_load_dwordx4 v2, s[16:19], s53 offen offset:0 lds
buffer_load_dwordx4 v2, s[16:19], s53 offen offset:1024 lds
buffer_load_dwordx4 v2, s[16:19], s53 offen offset:2048 lds
buffer_load_dwordx4 v2, s[16:19], s53 offen offset:3072 lds
s_add_u32 m0, s54, 12288
s_add_u32 s53, s52, 12288
buffer_load_dwordx4 v2, s[16:19], s53 offen offset:0 lds
buffer_load_dwordx4 v2, s[16:19], s53 offen offset:1024 lds
buffer_load_dwordx4 v2, s[16:19], s53 offen offset:2048 lds
buffer_load_dwordx4 v2, s[16:19], s53 offen offset:3072 lds
s_add_u32 m0, s54, 16384
s_add_u32 s53, s52, 16384
buffer_load_dwordx4 v2, s[16:19], s53 offen offset:0 lds
buffer_load_dwordx4 v2, s[16:19], s53 offen offset:1024 lds
buffer_load_dwordx4 v2, s[16:19], s53 offen offset:2048 lds
buffer_load_dwordx4 v2, s[16:19], s53 offen offset:3072 lds
s_add_u32 m0, s54, 20480
s_add_u32 s53, s52, 20480
buffer_load_dwordx4 v2, s[16:19], s53 offen offset:0 lds
buffer_load_dwordx4 v2, s[16:19], s53 offen offset:1024 lds
buffer_load_dwordx4 v2, s[16:19], s53 offen offset:2048 lds
buffer_load_dwordx4 v2, s[16:19], s53 offen offset:3072 lds
s_add_u32 m0, s54, 24576
s_add_u32 s53, s52, 24576
buffer_load_dwordx4 v2, s[16:19], s53 offen offset:0 lds
buffer_load_dwordx4 v2, s[16:19], s53 offen offset:1024 lds
buffer_load_dwordx4 v2, s[16:19], s53 offen offset:2048 lds
buffer_load_dwordx4 v2, s[16:19], s53 offen offset:3072 lds
s_add_u32 m0, s54, 28672
s_add_u32 s53, s52, 28672
buffer_load_dwordx4 v2, s[16:19], s53 offen offset:0 lds
buffer_load_dwordx4 v2, s[16:19], s53 offen offset:1024 lds
buffer_load_dwordx4 v2, s[16:19], s53 offen offset:2048 lds
buffer_load_dwordx4 v2, s[16:19], s53 offen offset:3072 lds
s_add_u32 m0, s54, 32768
s_add_u32 s53, s52, 32768
buffer_load_dwordx4 v2, s[16:19], s53 offen offset:0 lds
buffer_load_dwordx4 v2, s[16:19], s53 offen offset:1024 lds
buffer_load_dwordx4 v2, s[16:19], s53 offen offset:2048 lds
buffer_load_dwordx4 v2, s[16:19], s53 offen offset:3072 lds
s_add_u32 m0, s54, 36864
s_add_u32 s53, s52, 36864
buffer_load_dwordx4 v2, s[16:19], s53 offen offset:0 lds
buffer_load_dwordx4 v2, s[16:19], s53 offen offset:1024 lds
buffer_load_dwordx4 v2, s[16:19], s53 offen offset:2048 lds
buffer_load_dwordx4 v2, s[16:19], s53 offen offset:3072 lds
s_waitcnt vmcnt(0) lgkmcnt(0)
s_barrier
ds_read_b64_tr_b16 v[192:193], v4 offset:0
ds_read_b64_tr_b16 v[194:195], v4 offset:20480
ds_read_b64_tr_b16 v[208:209], v4 offset:8
ds_read_b64_tr_b16 v[210:211], v4 offset:20488
ds_read_b64_tr_b16 v[224:225], v4 offset:64
ds_read_b64_tr_b16 v[226:227], v4 offset:20544
ds_read_b64_tr_b16 v[240:241], v4 offset:72
ds_read_b64_tr_b16 v[242:243], v4 offset:20552
ds_read_b64_tr_b16 a[0:1], v4 offset:128
ds_read_b64_tr_b16 a[2:3], v4 offset:20608
s_waitcnt lgkmcnt(0)
ds_read_b64_tr_b16 a[16:17], v4 offset:136
ds_read_b64_tr_b16 a[18:19], v4 offset:20616
ds_read_b64_tr_b16 a[32:33], v4 offset:192
ds_read_b64_tr_b16 a[34:35], v4 offset:20672
ds_read_b64_tr_b16 a[48:49], v4 offset:200
ds_read_b64_tr_b16 a[50:51], v4 offset:20680
ds_read_b64_tr_b16 a[64:65], v4 offset:256
ds_read_b64_tr_b16 a[66:67], v4 offset:20736
ds_read_b64_tr_b16 a[80:81], v4 offset:264
ds_read_b64_tr_b16 a[82:83], v4 offset:20744
s_waitcnt lgkmcnt(0)
ds_read_b64_tr_b16 v[196:197], v5 offset:0
ds_read_b64_tr_b16 v[198:199], v5 offset:20480
ds_read_b64_tr_b16 v[212:213], v5 offset:8
ds_read_b64_tr_b16 v[214:215], v5 offset:20488
ds_read_b64_tr_b16 v[228:229], v5 offset:64
ds_read_b64_tr_b16 v[230:231], v5 offset:20544
ds_read_b64_tr_b16 v[244:245], v5 offset:72
ds_read_b64_tr_b16 v[246:247], v5 offset:20552
ds_read_b64_tr_b16 a[4:5], v5 offset:128
ds_read_b64_tr_b16 a[6:7], v5 offset:20608
s_waitcnt lgkmcnt(0)
ds_read_b64_tr_b16 a[20:21], v5 offset:136
ds_read_b64_tr_b16 a[22:23], v5 offset:20616
ds_read_b64_tr_b16 a[36:37], v5 offset:192
ds_read_b64_tr_b16 a[38:39], v5 offset:20672
ds_read_b64_tr_b16 a[52:53], v5 offset:200
ds_read_b64_tr_b16 a[54:55], v5 offset:20680
ds_read_b64_tr_b16 a[68:69], v5 offset:256
ds_read_b64_tr_b16 a[70:71], v5 offset:20736
ds_read_b64_tr_b16 a[84:85], v5 offset:264
ds_read_b64_tr_b16 a[86:87], v5 offset:20744
s_waitcnt lgkmcnt(0)
ds_read_b64_tr_b16 v[200:201], v10 offset:0
ds_read_b64_tr_b16 v[202:203], v10 offset:20480
ds_read_b64_tr_b16 v[216:217], v10 offset:8
ds_read_b64_tr_b16 v[218:219], v10 offset:20488
ds_read_b64_tr_b16 v[232:233], v10 offset:64
ds_read_b64_tr_b16 v[234:235], v10 offset:20544
ds_read_b64_tr_b16 v[248:249], v10 offset:72
ds_read_b64_tr_b16 v[250:251], v10 offset:20552
ds_read_b64_tr_b16 a[8:9], v10 offset:128
ds_read_b64_tr_b16 a[10:11], v10 offset:20608
s_waitcnt lgkmcnt(0)
ds_read_b64_tr_b16 a[24:25], v10 offset:136
ds_read_b64_tr_b16 a[26:27], v10 offset:20616
ds_read_b64_tr_b16 a[40:41], v10 offset:192
ds_read_b64_tr_b16 a[42:43], v10 offset:20672
ds_read_b64_tr_b16 a[56:57], v10 offset:200
ds_read_b64_tr_b16 a[58:59], v10 offset:20680
ds_read_b64_tr_b16 a[72:73], v10 offset:256
ds_read_b64_tr_b16 a[74:75], v10 offset:20736
ds_read_b64_tr_b16 a[88:89], v10 offset:264
ds_read_b64_tr_b16 a[90:91], v10 offset:20744
s_waitcnt lgkmcnt(0)
ds_read_b64_tr_b16 v[204:205], v11 offset:0
ds_read_b64_tr_b16 v[206:207], v11 offset:20480
ds_read_b64_tr_b16 v[220:221], v11 offset:8
ds_read_b64_tr_b16 v[222:223], v11 offset:20488
ds_read_b64_tr_b16 v[236:237], v11 offset:64
ds_read_b64_tr_b16 v[238:239], v11 offset:20544
ds_read_b64_tr_b16 v[252:253], v11 offset:72
ds_read_b64_tr_b16 v[254:255], v11 offset:20552
ds_read_b64_tr_b16 a[12:13], v11 offset:128
ds_read_b64_tr_b16 a[14:15], v11 offset:20608
s_waitcnt lgkmcnt(0)
ds_read_b64_tr_b16 a[28:29], v11 offset:136
ds_read_b64_tr_b16 a[30:31], v11 offset:20616
ds_read_b64_tr_b16 a[44:45], v11 offset:192
ds_read_b64_tr_b16 a[46:47], v11 offset:20672
ds_read_b64_tr_b16 a[60:61], v11 offset:200
ds_read_b64_tr_b16 a[62:63], v11 offset:20680
ds_read_b64_tr_b16 a[76:77], v11 offset:256
ds_read_b64_tr_b16 a[78:79], v11 offset:20736
ds_read_b64_tr_b16 a[92:93], v11 offset:264
ds_read_b64_tr_b16 a[94:95], v11 offset:20744
s_waitcnt lgkmcnt(0)
s_waitcnt vmcnt(0) lgkmcnt(0)
s_barrier
s_add_u32 m0, s54, 0
s_add_u32 s53, s52, 163840
buffer_load_dwordx4 v2, s[16:19], s53 offen offset:0 lds
buffer_load_dwordx4 v2, s[16:19], s53 offen offset:1024 lds
buffer_load_dwordx4 v2, s[16:19], s53 offen offset:2048 lds
buffer_load_dwordx4 v2, s[16:19], s53 offen offset:3072 lds
s_add_u32 m0, s54, 4096
s_add_u32 s53, s52, 167936
buffer_load_dwordx4 v2, s[16:19], s53 offen offset:0 lds
buffer_load_dwordx4 v2, s[16:19], s53 offen offset:1024 lds
buffer_load_dwordx4 v2, s[16:19], s53 offen offset:2048 lds
buffer_load_dwordx4 v2, s[16:19], s53 offen offset:3072 lds
s_add_u32 m0, s54, 8192
s_add_u32 s53, s52, 172032
buffer_load_dwordx4 v2, s[16:19], s53 offen offset:0 lds
buffer_load_dwordx4 v2, s[16:19], s53 offen offset:1024 lds
buffer_load_dwordx4 v2, s[16:19], s53 offen offset:2048 lds
buffer_load_dwordx4 v2, s[16:19], s53 offen offset:3072 lds
s_add_u32 m0, s54, 12288
s_add_u32 s53, s52, 176128
buffer_load_dwordx4 v2, s[16:19], s53 offen offset:0 lds
buffer_load_dwordx4 v2, s[16:19], s53 offen offset:1024 lds
buffer_load_dwordx4 v2, s[16:19], s53 offen offset:2048 lds
buffer_load_dwordx4 v2, s[16:19], s53 offen offset:3072 lds
s_add_u32 m0, s54, 16384
s_add_u32 s53, s52, 180224
buffer_load_dwordx4 v2, s[16:19], s53 offen offset:0 lds
buffer_load_dwordx4 v2, s[16:19], s53 offen offset:1024 lds
buffer_load_dwordx4 v2, s[16:19], s53 offen offset:2048 lds
buffer_load_dwordx4 v2, s[16:19], s53 offen offset:3072 lds
s_add_u32 m0, s54, 20480
s_add_u32 s53, s52, 184320
buffer_load_dwordx4 v2, s[16:19], s53 offen offset:0 lds
buffer_load_dwordx4 v2, s[16:19], s53 offen offset:1024 lds
buffer_load_dwordx4 v2, s[16:19], s53 offen offset:2048 lds
buffer_load_dwordx4 v2, s[16:19], s53 offen offset:3072 lds
s_add_u32 m0, s54, 24576
s_add_u32 s53, s52, 188416
buffer_load_dwordx4 v2, s[16:19], s53 offen offset:0 lds
buffer_load_dwordx4 v2, s[16:19], s53 offen offset:1024 lds
buffer_load_dwordx4 v2, s[16:19], s53 offen offset:2048 lds
buffer_load_dwordx4 v2, s[16:19], s53 offen offset:3072 lds
s_add_u32 m0, s54, 28672
s_add_u32 s53, s52, 192512
buffer_load_dwordx4 v2, s[16:19], s53 offen offset:0 lds
buffer_load_dwordx4 v2, s[16:19], s53 offen offset:1024 lds
buffer_load_dwordx4 v2, s[16:19], s53 offen offset:2048 lds
buffer_load_dwordx4 v2, s[16:19], s53 offen offset:3072 lds
s_add_u32 m0, s54, 32768
s_add_u32 s53, s52, 196608
buffer_load_dwordx4 v2, s[16:19], s53 offen offset:0 lds
buffer_load_dwordx4 v2, s[16:19], s53 offen offset:1024 lds
buffer_load_dwordx4 v2, s[16:19], s53 offen offset:2048 lds
buffer_load_dwordx4 v2, s[16:19], s53 offen offset:3072 lds
s_add_u32 m0, s54, 36864
s_add_u32 s53, s52, 200704
buffer_load_dwordx4 v2, s[16:19], s53 offen offset:0 lds
buffer_load_dwordx4 v2, s[16:19], s53 offen offset:1024 lds
buffer_load_dwordx4 v2, s[16:19], s53 offen offset:2048 lds
buffer_load_dwordx4 v2, s[16:19], s53 offen offset:3072 lds
s_waitcnt vmcnt(0) lgkmcnt(0)
s_barrier
ds_read_b64_tr_b16 a[96:97], v4 offset:0
ds_read_b64_tr_b16 a[98:99], v4 offset:20480
ds_read_b64_tr_b16 a[112:113], v4 offset:8
ds_read_b64_tr_b16 a[114:115], v4 offset:20488
ds_read_b64_tr_b16 a[128:129], v4 offset:64
ds_read_b64_tr_b16 a[130:131], v4 offset:20544
ds_read_b64_tr_b16 a[144:145], v4 offset:72
ds_read_b64_tr_b16 a[146:147], v4 offset:20552
ds_read_b64_tr_b16 a[160:161], v4 offset:128
ds_read_b64_tr_b16 a[162:163], v4 offset:20608
s_waitcnt lgkmcnt(0)
ds_read_b64_tr_b16 a[176:177], v4 offset:136
ds_read_b64_tr_b16 a[178:179], v4 offset:20616
ds_read_b64_tr_b16 a[192:193], v4 offset:192
ds_read_b64_tr_b16 a[194:195], v4 offset:20672
ds_read_b64_tr_b16 a[208:209], v4 offset:200
ds_read_b64_tr_b16 a[210:211], v4 offset:20680
ds_read_b64_tr_b16 a[224:225], v4 offset:256
ds_read_b64_tr_b16 a[226:227], v4 offset:20736
ds_read_b64_tr_b16 a[240:241], v4 offset:264
ds_read_b64_tr_b16 a[242:243], v4 offset:20744
s_waitcnt lgkmcnt(0)
ds_read_b64_tr_b16 a[100:101], v5 offset:0
ds_read_b64_tr_b16 a[102:103], v5 offset:20480
ds_read_b64_tr_b16 a[116:117], v5 offset:8
ds_read_b64_tr_b16 a[118:119], v5 offset:20488
ds_read_b64_tr_b16 a[132:133], v5 offset:64
ds_read_b64_tr_b16 a[134:135], v5 offset:20544
ds_read_b64_tr_b16 a[148:149], v5 offset:72
ds_read_b64_tr_b16 a[150:151], v5 offset:20552
ds_read_b64_tr_b16 a[164:165], v5 offset:128
ds_read_b64_tr_b16 a[166:167], v5 offset:20608
s_waitcnt lgkmcnt(0)
ds_read_b64_tr_b16 a[180:181], v5 offset:136
ds_read_b64_tr_b16 a[182:183], v5 offset:20616
ds_read_b64_tr_b16 a[196:197], v5 offset:192
ds_read_b64_tr_b16 a[198:199], v5 offset:20672
ds_read_b64_tr_b16 a[212:213], v5 offset:200
ds_read_b64_tr_b16 a[214:215], v5 offset:20680
ds_read_b64_tr_b16 a[228:229], v5 offset:256
ds_read_b64_tr_b16 a[230:231], v5 offset:20736
ds_read_b64_tr_b16 a[244:245], v5 offset:264
ds_read_b64_tr_b16 a[246:247], v5 offset:20744
s_waitcnt lgkmcnt(0)
ds_read_b64_tr_b16 a[104:105], v10 offset:0
ds_read_b64_tr_b16 a[106:107], v10 offset:20480
ds_read_b64_tr_b16 a[120:121], v10 offset:8
ds_read_b64_tr_b16 a[122:123], v10 offset:20488
ds_read_b64_tr_b16 a[136:137], v10 offset:64
ds_read_b64_tr_b16 a[138:139], v10 offset:20544
ds_read_b64_tr_b16 a[152:153], v10 offset:72
ds_read_b64_tr_b16 a[154:155], v10 offset:20552
ds_read_b64_tr_b16 a[168:169], v10 offset:128
ds_read_b64_tr_b16 a[170:171], v10 offset:20608
s_waitcnt lgkmcnt(0)
ds_read_b64_tr_b16 a[184:185], v10 offset:136
ds_read_b64_tr_b16 a[186:187], v10 offset:20616
ds_read_b64_tr_b16 a[200:201], v10 offset:192
ds_read_b64_tr_b16 a[202:203], v10 offset:20672
ds_read_b64_tr_b16 a[216:217], v10 offset:200
ds_read_b64_tr_b16 a[218:219], v10 offset:20680
ds_read_b64_tr_b16 a[232:233], v10 offset:256
ds_read_b64_tr_b16 a[234:235], v10 offset:20736
ds_read_b64_tr_b16 a[248:249], v10 offset:264
ds_read_b64_tr_b16 a[250:251], v10 offset:20744
s_waitcnt lgkmcnt(0)
ds_read_b64_tr_b16 a[108:109], v11 offset:0
ds_read_b64_tr_b16 a[110:111], v11 offset:20480
ds_read_b64_tr_b16 a[124:125], v11 offset:8
ds_read_b64_tr_b16 a[126:127], v11 offset:20488
ds_read_b64_tr_b16 a[140:141], v11 offset:64
ds_read_b64_tr_b16 a[142:143], v11 offset:20544
ds_read_b64_tr_b16 a[156:157], v11 offset:72
ds_read_b64_tr_b16 a[158:159], v11 offset:20552
ds_read_b64_tr_b16 a[172:173], v11 offset:128
ds_read_b64_tr_b16 a[174:175], v11 offset:20608
s_waitcnt lgkmcnt(0)
ds_read_b64_tr_b16 a[188:189], v11 offset:136
ds_read_b64_tr_b16 a[190:191], v11 offset:20616
ds_read_b64_tr_b16 a[204:205], v11 offset:192
ds_read_b64_tr_b16 a[206:207], v11 offset:20672
ds_read_b64_tr_b16 a[220:221], v11 offset:200
ds_read_b64_tr_b16 a[222:223], v11 offset:20680
ds_read_b64_tr_b16 a[236:237], v11 offset:256
ds_read_b64_tr_b16 a[238:239], v11 offset:20736
ds_read_b64_tr_b16 a[252:253], v11 offset:264
ds_read_b64_tr_b16 a[254:255], v11 offset:20744
s_waitcnt lgkmcnt(0)
s_waitcnt vmcnt(0) lgkmcnt(0)
s_barrier
s_and_b32 s51, s49, 1
s_lshr_b32 s55, s49, 1
s_lshl_b32 s52, s51, 4
v_and_b32 v108, 15, v1
v_add_u32 v108, s52, v108
v_lshlrev_b32 v109, 2, v3
v_mov_b32 v110, 0xf149f2ca
v_add_u32 v111, 0, v109
v_cmp_gt_u32 vcc, v111, v108
s_nop 1
v_cndmask_b32 v12, 0, v110, vcc
v_add_u32 v111, 1, v109
v_cmp_gt_u32 vcc, v111, v108
s_nop 1
v_cndmask_b32 v13, 0, v110, vcc
v_add_u32 v111, 2, v109
v_cmp_gt_u32 vcc, v111, v108
s_nop 1
v_cndmask_b32 v14, 0, v110, vcc
v_add_u32 v111, 3, v109
v_cmp_gt_u32 vcc, v111, v108
s_nop 1
v_cndmask_b32 v15, 0, v110, vcc
v_add_u32 v111, 16, v109
v_cmp_gt_u32 vcc, v111, v108
s_nop 1
v_cndmask_b32 v16, 0, v110, vcc
v_add_u32 v111, 17, v109
v_cmp_gt_u32 vcc, v111, v108
s_nop 1
v_cndmask_b32 v17, 0, v110, vcc
v_add_u32 v111, 18, v109
v_cmp_gt_u32 vcc, v111, v108
s_nop 1
v_cndmask_b32 v18, 0, v110, vcc
v_add_u32 v111, 19, v109
v_cmp_gt_u32 vcc, v111, v108
s_nop 1
v_cndmask_b32 v19, 0, v110, vcc
v_cndmask_b32 v20, v110, 0, s[66:67]
v_mov_b32 v24, 0x3f803f80
v_cndmask_b32 v21, v110, 0, s[66:67]
v_mov_b32 v25, 0x3f803f80
v_cndmask_b32 v22, v110, 0, s[66:67]
v_mov_b32 v26, 0x3f803f80
v_cndmask_b32 v23, v110, 0, s[66:67]
v_mov_b32 v27, 0x3f803f80
v_mov_b32 v28, 0x3e0293ee
v_mov_b32 v29, v28
s_lshl_b32 s52, s55, 13
v_add_u32 v10, s52, v2
s_lshl_b32 s52, s49, 12
v_add_u32 v6, s52, v2
s_lshl_b32 s52, s55, 12
v_lshrrev_b32 v7, 2, v1
v_lshlrev_b32 v7, 4, v7
v_and_b32 v108, 1, v1
v_lshl_add_u32 v7, v108, 3, v7
v_add_u32 v7, s52, v7
v_and_b32 v8, 15, v1
v_lshlrev_b32 v8, 4, v8
v_and_b32 v108, 1, v3
v_lshl_add_u32 v8, v108, 3, v8
v_add_u32 v8, s52, v8
v_bfe_u32 v9, v1, 2, 2
v_mul_u32_u24 v9, 5120, v9
v_lshl_add_u32 v9, v3, 6, v9
v_and_b32 v108, 3, v1
v_lshl_add_u32 v9, v108, 4, v9
s_mul_i32 s53, s49, 1280
v_add_u32 v9, s53, v9
s_lshl_b32 s60, s59, 7
s_add_u32 s60, s60, 0
s_add_u32 s68, s60, 24
s_mov_b32 s61, 67108864
s_cmp_eq_u32 s49, 1
s_cselect_b32 s61, 100663296, s61
s_cmp_eq_u32 s49, 2
s_cselect_b32 s61, 33554432, s61
s_cmp_eq_u32 s49, 3
s_cselect_b32 s61, 8388608, s61
s_cselect_b32 s51, 12, 13
s_lshl_b32 s52, s58, 5
s_add_u32 s52, s52, s59
s_lshl_b32 s52, s52, s51
s_add_u32 s61, s61, s52
s_lshl_b32 s62, 64, s51
s_lshl_b32 s70, s49, 14
s_lshl_b32 s52, s58, 4
s_lshr_b32 s53, s59, 1
s_add_u32 s52, s52, s53
s_mul_i32 s64, s52, 40960
s_add_u32 s64, s64, 171966464
s_add_u32 s58, s58, 1
v_mov_b32 v110, v10
v_mov_b32 v111, v11
v_and_b32 v11, 7, v0
v_lshlrev_b32 v11, 4, v11
s_mov_b32 s69, 0
WST_38:
buffer_load_dword v10, v11, s[8:11], s37 offen offset:128 sc1
buffer_load_dword v11, off, s[8:11], 0 offset:132 sc1
s_add_u32 s69, s69, 1
s_cmp_gt_u32 s69, 131072
s_cbranch_scc1 ABORT
s_waitcnt vmcnt(0)
v_cmp_gt_u32 vcc, 32, v10
s_cbranch_vccz WSTOK_39
v_readfirstlane_b32 s36, v11
v_and_b32 v11, 7, v0
v_lshlrev_b32 v11, 4, v11
s_sub_u32 s35, s37, 1
s_cselect_b32 s36, s36, 0
s_cmp_lg_u32 s36, 0
s_cbranch_scc1 FALLBACK
s_sleep 2
s_branch WST_38
WSTOK_39:
v_mov_b32 v10, v110
s_mov_b32 s71, 0
s_mov_b32 s72, 0
s_mov_b32 s57, 0
AW_SEG:
v_add_u32 v188, s57, v10
v_add_u32 v189, s57, v6
s_cmp_eq_u32 s49, 3
s_cbranch_scc1 AW_W3
s_cmp_lg_u32 s72, 0
s_cbranch_scc1 AW_FD
s_cmp_ge_u32 s71, s58
s_cbranch_scc1 AWPOK_41
v_and_b32 v108, 7, v1
v_min_u32 v108, 5, v108
v_lshlrev_b32 v108, 2, v108
v_and_b32 v109, 8, v1
v_lshl_add_u32 v108, v109, 4, v108
s_mov_b32 s69, 0
AWP_40:
buffer_load_dword v109, v108, s[4:7], s60 offen sc1
s_add_u32 s69, s69, 1
s_cmp_gt_u32 s69, 131072
s_cbranch_scc1 ABORT
s_waitcnt vmcnt(0)
v_min_u32_dpp v109, v109, v109 quad_perm:[1,0,3,2] row_mask:0xf bank_mask:0xf
s_nop 1
v_min_u32_dpp v109, v109, v109 quad_perm:[2,3,0,1] row_mask:0xf bank_mask:0xf
s_nop 1
v_min_u32_dpp v109, v109, v109 row_half_mirror row_mask:0xf bank_mask:0xf
s_nop 1
v_min_u32_dpp v109, v109, v109 row_mirror row_mask:0xf bank_mask:0xf
s_nop 0
v_readfirstlane_b32 s71, v109
s_nop 1
s_cmp_ge_u32 s71, s58
s_cbranch_scc1 AWPOK_41
s_sleep 1
s_branch AWP_40
AWPOK_41:
s_add_u32 s52, s70, s57
s_add_u32 m0, s52, 0
s_add_u32 s51, s61, 0
buffer_load_dwordx4 v2, s[4:7], s51 offen offset:0 sc1 lds
buffer_load_dwordx4 v2, s[4:7], s51 offen offset:1024 sc1 lds
buffer_load_dwordx4 v2, s[4:7], s51 offen offset:2048 sc1 lds
buffer_load_dwordx4 v2, s[4:7], s51 offen offset:3072 sc1 lds
s_add_u32 m0, s52, 4096
s_add_u32 s51, s61, 4096
buffer_load_dwordx4 v2, s[4:7], s51 offen offset:0 sc1 lds
buffer_load_dwordx4 v2, s[4:7], s51 offen offset:1024 sc1 lds
buffer_load_dwordx4 v2, s[4:7], s51 offen offset:2048 sc1 lds
buffer_load_dwordx4 v2, s[4:7], s51 offen offset:3072 sc1 lds
s_add_u32 m0, s52, 8192
s_add_u32 s51, s61, 8192
buffer_load_dwordx4 v2, s[4:7], s51 offen offset:0 sc1 lds
buffer_load_dwordx4 v2, s[4:7], s51 offen offset:1024 sc1 lds
buffer_load_dwordx4 v2, s[4:7], s51 offen offset:2048 sc1 lds
buffer_load_dwordx4 v2, s[4:7], s51 offen offset:3072 sc1 lds
s_add_u32 m0, s52, 12288
s_add_u32 s51, s61, 12288
buffer_load_dwordx4 v2, s[4:7], s51 offen offset:0 sc1 lds
buffer_load_dwordx4 v2, s[4:7], s51 offen offset:1024 sc1 lds
buffer_load_dwordx4 v2, s[4:7], s51 offen offset:2048 sc1 lds
buffer_load_dwordx4 v2, s[4:7], s51 offen offset:3072 sc1 lds
s_add_u32 s61, s61, s62
s_branch AW_FD
AW_W3:
s_cmp_ge_u32 s71, s58
s_cbranch_scc1 AWPOK_43
v_and_b32 v108, 7, v1
v_min_u32 v108, 0, v108
v_lshlrev_b32 v108, 2, v108
v_and_b32 v109, 8, v1
v_lshl_add_u32 v108, v109, 4, v108
s_mov_b32 s69, 0
AWP_42:
buffer_load_dword v109, v108, s[4:7], s68 offen sc1
s_add_u32 s69, s69, 1
s_cmp_gt_u32 s69, 131072
s_cbranch_scc1 ABORT
s_waitcnt vmcnt(0)
v_min_u32_dpp v109, v109, v109 quad_perm:[1,0,3,2] row_mask:0xf bank_mask:0xf
s_nop 1
v_min_u32_dpp v109, v109, v109 quad_perm:[2,3,0,1] row_mask:0xf bank_mask:0xf
s_nop 1
v_min_u32_dpp v109, v109, v109 row_half_mirror row_mask:0xf bank_mask:0xf
s_nop 1
v_min_u32_dpp v109, v109, v109 row_mirror row_mask:0xf bank_mask:0xf
s_nop 0
v_readfirstlane_b32 s71, v109
s_nop 1
s_cmp_ge_u32 s71, s58
s_cbranch_scc1 AWPOK_43
s_sleep 1
s_branch AWP_42
AWPOK_43:
s_add_u32 s52, s70, 0
s_add_u32 m0, s52, 0
s_add_u32 s51, s61, 0
buffer_load_dwordx4 v2, s[4:7], s51 offen offset:0 sc1 lds
buffer_load_dwordx4 v2, s[4:7], s51 offen offset:1024 sc1 lds
buffer_load_dwordx4 v2, s[4:7], s51 offen offset:2048 sc1 lds
buffer_load_dwordx4 v2, s[4:7], s51 offen offset:3072 sc1 lds
s_add_u32 m0, s52, 4096
s_add_u32 s51, s61, 4096
buffer_load_dwordx4 v2, s[4:7], s51 offen offset:0 sc1 lds
buffer_load_dwordx4 v2, s[4:7], s51 offen offset:1024 sc1 lds
buffer_load_dwordx4 v2, s[4:7], s51 offen offset:2048 sc1 lds
buffer_load_dwordx4 v2, s[4:7], s51 offen offset:3072 sc1 lds
s_add_u32 s61, s61, s62
AW_FD:
s_waitcnt vmcnt(0) lgkmcnt(0)
s_barrier
s_xor_b32 s57, s57, 81920
s_mov_b32 s72, 0
ds_read_b128 v[64:67], v189 offset:32768
ds_read_b128 v[68:71], v189 offset:33792
ds_read_b128 v[72:75], v189 offset:34816
ds_read_b128 v[76:79], v189 offset:35840
ds_read_b128 v[32:35], v188 offset:0
ds_read_b128 v[48:51], v188 offset:4096
ds_read_b128 v[36:39], v188 offset:1024
ds_read_b128 v[52:55], v188 offset:5120
ds_read_b128 v[40:43], v188 offset:2048
ds_read_b128 v[56:59], v188 offset:6144
ds_read_b128 v[44:47], v188 offset:3072
ds_read_b128 v[60:63], v188 offset:7168
s_add_u32 s53, s58, 2
s_cmp_eq_u32 s49, 3
s_cbranch_scc1 AW_NOPF
s_cmp_lt_u32 s71, s53
s_cbranch_scc1 AW_NOPF
s_add_u32 s52, s70, s57
s_add_u32 m0, s52, 0
s_add_u32 s51, s61, 0
buffer_load_dwordx4 v2, s[4:7], s51 offen offset:0 sc1 lds
buffer_load_dwordx4 v2, s[4:7], s51 offen offset:1024 sc1 lds
buffer_load_dwordx4 v2, s[4:7], s51 offen offset:2048 sc1 lds
buffer_load_dwordx4 v2, s[4:7], s51 offen offset:3072 sc1 lds
s_add_u32 m0, s52, 4096
s_add_u32 s51, s61, 4096
buffer_load_dwordx4 v2, s[4:7], s51 offen offset:0 sc1 lds
buffer_load_dwordx4 v2, s[4:7], s51 offen offset:1024 sc1 lds
buffer_load_dwordx4 v2, s[4:7], s51 offen offset:2048 sc1 lds
buffer_load_dwordx4 v2, s[4:7], s51 offen offset:3072 sc1 lds
s_add_u32 m0, s52, 8192
s_add_u32 s51, s61, 8192
buffer_load_dwordx4 v2, s[4:7], s51 offen offset:0 sc1 lds
buffer_load_dwordx4 v2, s[4:7], s51 offen offset:1024 sc1 lds
buffer_load_dwordx4 v2, s[4:7], s51 offen offset:2048 sc1 lds
buffer_load_dwordx4 v2, s[4:7], s51 offen offset:3072 sc1 lds
s_add_u32 m0, s52, 12288
s_add_u32 s51, s61, 12288
buffer_load_dwordx4 v2, s[4:7], s51 offen offset:0 sc1 lds
buffer_load_dwordx4 v2, s[4:7], s51 offen offset:1024 sc1 lds
buffer_load_dwordx4 v2, s[4:7], s51 offen offset:2048 sc1 lds
buffer_load_dwordx4 v2, s[4:7], s51 offen offset:3072 sc1 lds
s_add_u32 s61, s61, s62
s_mov_b32 s72, 1
AW_NOPF:
s_waitcnt lgkmcnt(6)
v_mfma_f32_16x16x32_bf16 v[96:99], v[32:35], v[64:67], v[12:15]
ds_read_b64_tr_b16 v[80:81], v7 offset:49152
v_mfma_f32_16x16x32_bf16 v[100:103], v[48:51], v[64:67], v[16:19]
ds_read_b64_tr_b16 v[82:83], v7 offset:49408
s_waitcnt lgkmcnt(6)
v_mfma_f32_16x16x32_bf16 v[96:99], v[36:39], v[68:71], v[96:99]
ds_read_b64_tr_b16 v[84:85], v7 offset:49664
v_mfma_f32_16x16x32_bf16 v[100:103], v[52:55], v[68:71], v[100:103]
ds_read_b64_tr_b16 v[86:87], v7 offset:49920
s_waitcnt lgkmcnt(6)
v_mfma_f32_16x16x32_bf16 v[96:99], v[40:43], v[72:75], v[96:99]
ds_read_b64_tr_b16 v[88:89], v7 offset:50176
v_mfma_f32_16x16x32_bf16 v[100:103], v[56:59], v[72:75], v[100:103]
ds_read_b64_tr_b16 v[90:91], v7 offset:50432
s_waitcnt lgkmcnt(6)
v_mfma_f32_16x16x32_bf16 v[96:99], v[44:47], v[76:79], v[96:99]
ds_read_b64_tr_b16 v[92:93], v7 offset:50688
v_mfma_f32_16x16x32_bf16 v[100:103], v[60:63], v[76:79], v[100:103]
ds_read_b64_tr_b16 v[94:95], v7 offset:50944
s_waitcnt lgkmcnt(6)
v_mfma_f32_16x16x32_bf16 v[104:107], v[80:83], v[64:67], v[20:23]
ds_read_b128 v[32:35], v188 offset:16384
ds_read_b128 v[36:39], v188 offset:17408
s_waitcnt lgkmcnt(6)
v_mfma_f32_16x16x32_bf16 v[104:107], v[84:87], v[68:71], v[104:107]
ds_read_b128 v[40:43], v188 offset:18432
ds_read_b128 v[44:47], v188 offset:19456
s_waitcnt lgkmcnt(6)
v_mfma_f32_16x16x32_bf16 v[104:107], v[88:91], v[72:75], v[104:107]
ds_read_b128 v[48:51], v188 offset:20480
ds_read_b128 v[52:55], v188 offset:21504
s_waitcnt lgkmcnt(6)
v_mfma_f32_16x16x32_bf16 v[104:107], v[92:95], v[76:79], v[104:107]
ds_read_b128 v[56:59], v188 offset:22528
ds_read_b128 v[60:63], v188 offset:23552
ds_read_b64 v[64:65], v8 offset:51200
ds_read_b64 v[66:67], v8 offset:51456
ds_read_b64 v[68:69], v8 offset:51712
ds_read_b64 v[70:71], v8 offset:51968
ds_read_b64 v[72:73], v8 offset:52224
ds_read_b64 v[74:75], v8 offset:52480
ds_read_b64 v[76:77], v8 offset:52736
ds_read_b64 v[78:79], v8 offset:52992
v_max3_f32 v108, v96, v97, v98
v_max3_f32 v108, v108, v99, v100
v_max3_f32 v108, v108, v101, v102
v_max3_f32 v108, v108, v103, v104
v_max3_f32 v108, v108, v105, v106
v_max_f32 v108, v108, v107
v_mov_b32 v109, v108
s_nop 1
v_permlane32_swap_b32 v108, v109
v_max_f32 v108, v108, v109
v_mov_b32 v109, v108
s_nop 1
v_permlane16_swap_b32 v108, v109
v_max_f32 v108, v108, v109
v_mul_f32 v108, v28, v108
v_mov_b32 v109, v108
v_pk_fma_f32 v[96:97], v[96:97], v[28:29], v[108:109] neg_lo:[0,0,1] neg_hi:[0,0,1]
v_pk_fma_f32 v[98:99], v[98:99], v[28:29], v[108:109] neg_lo:[0,0,1] neg_hi:[0,0,1]
v_pk_fma_f32 v[100:101], v[100:101], v[28:29], v[108:109] neg_lo:[0,0,1] neg_hi:[0,0,1]
v_pk_fma_f32 v[102:103], v[102:103], v[28:29], v[108:109] neg_lo:[0,0,1] neg_hi:[0,0,1]
v_pk_fma_f32 v[104:105], v[104:105], v[28:29], v[108:109] neg_lo:[0,0,1] neg_hi:[0,0,1]
v_pk_fma_f32 v[106:107], v[106:107], v[28:29], v[108:109] neg_lo:[0,0,1] neg_hi:[0,0,1]
v_exp_f32 v96, v96
v_exp_f32 v97, v97
v_exp_f32 v98, v98
v_exp_f32 v99, v99
v_exp_f32 v100, v100
v_exp_f32 v101, v101
v_exp_f32 v102, v102
v_exp_f32 v103, v103
v_exp_f32 v104, v104
v_exp_f32 v105, v105
v_exp_f32 v106, v106
v_exp_f32 v107, v107
v_cvt_pk_bf16_f32 v112, v96, v97
v_cvt_pk_bf16_f32 v113, v98, v99
v_cvt_pk_bf16_f32 v114, v100, v101
v_cvt_pk_bf16_f32 v115, v102, v103
v_cvt_pk_bf16_f32 v116, v104, v105
v_cvt_pk_bf16_f32 v117, v106, v107
s_waitcnt lgkmcnt(0)
v_mfma_f32_16x16x32_bf16 v[120:123], v[24:27], v[112:115], 0
v_mfma_f32_16x16x32_bf16 v[124:127], v[32:35], v[112:115], 0
v_mfma_f32_16x16x32_bf16 v[128:131], v[36:39], v[112:115], 0
v_mfma_f32_16x16x32_bf16 v[132:135], v[40:43], v[112:115], 0
v_mfma_f32_16x16x32_bf16 v[136:139], v[44:47], v[112:115], 0
v_mfma_f32_16x16x32_bf16 v[140:143], v[48:51], v[112:115], 0
v_mfma_f32_16x16x32_bf16 v[144:147], v[52:55], v[112:115], 0
v_mfma_f32_16x16x32_bf16 v[148:151], v[56:59], v[112:115], 0
v_mfma_f32_16x16x32_bf16 v[152:155], v[60:63], v[112:115], 0
v_mfma_f32_16x16x16_bf16 v[120:123], v[24:25], v[116:117], v[120:123]
v_mfma_f32_16x16x16_bf16 v[124:127], v[64:65], v[116:117], v[124:127]
v_mfma_f32_16x16x16_bf16 v[128:131], v[66:67], v[116:117], v[128:131]
v_mfma_f32_16x16x16_bf16 v[132:135], v[68:69], v[116:117], v[132:135]
v_mfma_f32_16x16x16_bf16 v[136:139], v[70:71], v[116:117], v[136:139]
v_mfma_f32_16x16x16_bf16 v[140:143], v[72:73], v[116:117], v[140:143]
v_mfma_f32_16x16x16_bf16 v[144:147], v[74:75], v[116:117], v[144:147]
v_mfma_f32_16x16x16_bf16 v[148:151], v[76:77], v[116:117], v[148:151]
v_mfma_f32_16x16x16_bf16 v[152:155], v[78:79], v[116:117], v[152:155]
v_rcp_f32 v108, v120
s_nop 0
v_mov_b32 v109, v108
v_pk_mul_f32 v[124:125], v[124:125], v[108:109]
v_cvt_pk_bf16_f32 v80, v124, v125
v_pk_mul_f32 v[126:127], v[126:127], v[108:109]
v_cvt_pk_bf16_f32 v81, v126, v127
v_pk_mul_f32 v[128:129], v[128:129], v[108:109]
v_cvt_pk_bf16_f32 v82, v128, v129
v_pk_mul_f32 v[130:131], v[130:131], v[108:109]
v_cvt_pk_bf16_f32 v83, v130, v131
ds_write_b128 v6, v[80:83] offset:57344
v_pk_mul_f32 v[132:133], v[132:133], v[108:109]
v_cvt_pk_bf16_f32 v84, v132, v133
v_pk_mul_f32 v[134:135], v[134:135], v[108:109]
v_cvt_pk_bf16_f32 v85, v134, v135
v_pk_mul_f32 v[136:137], v[136:137], v[108:109]
v_cvt_pk_bf16_f32 v86, v136, v137
v_pk_mul_f32 v[138:139], v[138:139], v[108:109]
v_cvt_pk_bf16_f32 v87, v138, v139
ds_write_b128 v6, v[84:87] offset:58368
v_pk_mul_f32 v[140:141], v[140:141], v[108:109]
v_cvt_pk_bf16_f32 v88, v140, v141
v_pk_mul_f32 v[142:143], v[142:143], v[108:109]
v_cvt_pk_bf16_f32 v89, v142, v143
v_pk_mul_f32 v[144:145], v[144:145], v[108:109]
v_cvt_pk_bf16_f32 v90, v144, v145
v_pk_mul_f32 v[146:147], v[146:147], v[108:109]
v_cvt_pk_bf16_f32 v91, v146, v147
ds_write_b128 v6, v[88:91] offset:59392
v_pk_mul_f32 v[148:149], v[148:149], v[108:109]
v_cvt_pk_bf16_f32 v92, v148, v149
v_pk_mul_f32 v[150:151], v[150:151], v[108:109]
v_cvt_pk_bf16_f32 v93, v150, v151
v_pk_mul_f32 v[152:153], v[152:153], v[108:109]
v_cvt_pk_bf16_f32 v94, v152, v153
v_pk_mul_f32 v[154:155], v[154:155], v[108:109]
v_cvt_pk_bf16_f32 v95, v154, v155
ds_write_b128 v6, v[92:95] offset:60416
s_waitcnt lgkmcnt(0)
s_barrier
v_add_u32 v108, 57344, v2
ds_read_b128 v[32:35], v108 offset:0
ds_read_b128 v[36:39], v108 offset:1024
ds_read_b128 v[40:43], v108 offset:2048
ds_read_b128 v[44:47], v108 offset:3072
ds_read_b128 v[64:67], v108 offset:8192
ds_read_b128 v[68:71], v108 offset:9216
ds_read_b128 v[72:75], v108 offset:10240
ds_read_b128 v[76:79], v108 offset:11264
ds_read_b128 v[48:51], v108 offset:4096
ds_read_b128 v[52:55], v108 offset:5120
ds_read_b128 v[56:59], v108 offset:6144
ds_read_b128 v[60:63], v108 offset:7168
s_add_u32 s52, s64, 20480
s_waitcnt lgkmcnt(11)
v_mfma_f32_16x16x32_bf16 v[156:159], v[192:195], v[32:35], 0
v_mfma_f32_16x16x32_bf16 v[160:163], v[208:211], v[32:35], 0
s_waitcnt lgkmcnt(10)
v_mfma_f32_16x16x32_bf16 v[156:159], v[196:199], v[36:39], v[156:159]
v_mfma_f32_16x16x32_bf16 v[160:163], v[212:215], v[36:39], v[160:163]
s_waitcnt lgkmcnt(9)
v_mfma_f32_16x16x32_bf16 v[156:159], v[200:203], v[40:43], v[156:159]
v_mfma_f32_16x16x32_bf16 v[160:163], v[216:219], v[40:43], v[160:163]
s_waitcnt lgkmcnt(8)
v_mfma_f32_16x16x32_bf16 v[156:159], v[204:207], v[44:47], v[156:159]
v_mfma_f32_16x16x32_bf16 v[160:163], v[220:223], v[44:47], v[160:163]
s_waitcnt lgkmcnt(7)
v_mfma_f32_16x16x32_bf16 v[156:159], a[96:99], v[64:67], v[156:159]
v_mfma_f32_16x16x32_bf16 v[160:163], a[112:115], v[64:67], v[160:163]
ds_read_b128 v[80:83], v108 offset:12288
s_waitcnt lgkmcnt(7)
v_mfma_f32_16x16x32_bf16 v[156:159], a[100:103], v[68:71], v[156:159]
v_mfma_f32_16x16x32_bf16 v[160:163], a[116:119], v[68:71], v[160:163]
ds_read_b128 v[84:87], v108 offset:13312
s_waitcnt lgkmcnt(7)
v_mfma_f32_16x16x32_bf16 v[156:159], a[104:107], v[72:75], v[156:159]
v_mfma_f32_16x16x32_bf16 v[160:163], a[120:123], v[72:75], v[160:163]
ds_read_b128 v[88:91], v108 offset:14336
s_waitcnt lgkmcnt(7)
v_mfma_f32_16x16x32_bf16 v[156:159], a[108:111], v[76:79], v[156:159]
v_mfma_f32_16x16x32_bf16 v[160:163], a[124:127], v[76:79], v[160:163]
ds_read_b128 v[92:95], v108 offset:15360
v_mfma_f32_16x16x32_bf16 v[164:167], v[224:227], v[32:35], 0
v_mfma_f32_16x16x32_bf16 v[168:171], v[240:243], v[32:35], 0
v_mfma_f32_16x16x32_bf16 v[164:167], v[228:231], v[36:39], v[164:167]
v_mfma_f32_16x16x32_bf16 v[168:171], v[244:247], v[36:39], v[168:171]
v_mfma_f32_16x16x32_bf16 v[164:167], v[232:235], v[40:43], v[164:167]
v_cvt_pk_bf16_f32 v124, v156, v157
v_mfma_f32_16x16x32_bf16 v[168:171], v[248:251], v[40:43], v[168:171]
v_cvt_pk_bf16_f32 v125, v158, v159
v_mfma_f32_16x16x32_bf16 v[164:167], v[236:239], v[44:47], v[164:167]
v_cvt_pk_bf16_f32 v126, v160, v161
v_mfma_f32_16x16x32_bf16 v[168:171], v[252:255], v[44:47], v[168:171]
v_cvt_pk_bf16_f32 v127, v162, v163
v_mfma_f32_16x16x32_bf16 v[164:167], a[128:131], v[64:67], v[164:167]
buffer_store_dwordx4 v[124:127], v9, s[4:7], s64 offen offset:0 sc1
v_mfma_f32_16x16x32_bf16 v[168:171], a[144:147], v[64:67], v[168:171]
v_mfma_f32_16x16x32_bf16 v[164:167], a[132:135], v[68:71], v[164:167]
v_mfma_f32_16x16x32_bf16 v[168:171], a[148:151], v[68:71], v[168:171]
v_mfma_f32_16x16x32_bf16 v[164:167], a[136:139], v[72:75], v[164:167]
v_mfma_f32_16x16x32_bf16 v[168:171], a[152:155], v[72:75], v[168:171]
v_mfma_f32_16x16x32_bf16 v[164:167], a[140:143], v[76:79], v[164:167]
v_mfma_f32_16x16x32_bf16 v[168:171], a[156:159], v[76:79], v[168:171]
v_mfma_f32_16x16x32_bf16 v[172:175], a[0:3], v[32:35], 0
v_mfma_f32_16x16x32_bf16 v[176:179], a[16:19], v[32:35], 0
v_mfma_f32_16x16x32_bf16 v[172:175], a[4:7], v[36:39], v[172:175]
v_mfma_f32_16x16x32_bf16 v[176:179], a[20:23], v[36:39], v[176:179]
v_mfma_f32_16x16x32_bf16 v[172:175], a[8:11], v[40:43], v[172:175]
v_cvt_pk_bf16_f32 v128, v164, v165
v_mfma_f32_16x16x32_bf16 v[176:179], a[24:27], v[40:43], v[176:179]
v_cvt_pk_bf16_f32 v129, v166, v167
v_mfma_f32_16x16x32_bf16 v[172:175], a[12:15], v[44:47], v[172:175]
v_cvt_pk_bf16_f32 v130, v168, v169
v_mfma_f32_16x16x32_bf16 v[176:179], a[28:31], v[44:47], v[176:179]
v_cvt_pk_bf16_f32 v131, v170, v171
v_mfma_f32_16x16x32_bf16 v[172:175], a[160:163], v[64:67], v[172:175]
buffer_store_dwordx4 v[128:131], v9, s[4:7], s64 offen offset:256 sc1
v_mfma_f32_16x16x32_bf16 v[176:179], a[176:179], v[64:67], v[176:179]
v_mfma_f32_16x16x32_bf16 v[172:175], a[164:167], v[68:71], v[172:175]
v_mfma_f32_16x16x32_bf16 v[176:179], a[180:183], v[68:71], v[176:179]
v_mfma_f32_16x16x32_bf16 v[172:175], a[168:171], v[72:75], v[172:175]
v_mfma_f32_16x16x32_bf16 v[176:179], a[184:187], v[72:75], v[176:179]
v_mfma_f32_16x16x32_bf16 v[172:175], a[172:175], v[76:79], v[172:175]
v_mfma_f32_16x16x32_bf16 v[176:179], a[188:191], v[76:79], v[176:179]
v_mfma_f32_16x16x32_bf16 v[180:183], a[32:35], v[32:35], 0
v_mfma_f32_16x16x32_bf16 v[184:187], a[48:51], v[32:35], 0
v_mfma_f32_16x16x32_bf16 v[180:183], a[36:39], v[36:39], v[180:183]
v_mfma_f32_16x16x32_bf16 v[184:187], a[52:55], v[36:39], v[184:187]
v_mfma_f32_16x16x32_bf16 v[180:183], a[40:43], v[40:43], v[180:183]
v_cvt_pk_bf16_f32 v132, v172, v173
v_mfma_f32_16x16x32_bf16 v[184:187], a[56:59], v[40:43], v[184:187]
v_cvt_pk_bf16_f32 v133, v174, v175
v_mfma_f32_16x16x32_bf16 v[180:183], a[44:47], v[44:47], v[180:183]
v_cvt_pk_bf16_f32 v134, v176, v177
v_mfma_f32_16x16x32_bf16 v[184:187], a[60:63], v[44:47], v[184:187]
v_cvt_pk_bf16_f32 v135, v178, v179
v_mfma_f32_16x16x32_bf16 v[180:183], a[192:195], v[64:67], v[180:183]
buffer_store_dwordx4 v[132:135], v9, s[4:7], s64 offen offset:512 sc1
v_mfma_f32_16x16x32_bf16 v[184:187], a[208:211], v[64:67], v[184:187]
v_mfma_f32_16x16x32_bf16 v[180:183], a[196:199], v[68:71], v[180:183]
v_mfma_f32_16x16x32_bf16 v[184:187], a[212:215], v[68:71], v[184:187]
v_mfma_f32_16x16x32_bf16 v[180:183], a[200:203], v[72:75], v[180:183]
v_mfma_f32_16x16x32_bf16 v[184:187], a[216:219], v[72:75], v[184:187]
v_mfma_f32_16x16x32_bf16 v[180:183], a[204:207], v[76:79], v[180:183]
v_mfma_f32_16x16x32_bf16 v[184:187], a[220:223], v[76:79], v[184:187]
v_mfma_f32_16x16x32_bf16 v[156:159], a[64:67], v[32:35], 0
v_mfma_f32_16x16x32_bf16 v[160:163], a[80:83], v[32:35], 0
v_mfma_f32_16x16x32_bf16 v[156:159], a[68:71], v[36:39], v[156:159]
v_mfma_f32_16x16x32_bf16 v[160:163], a[84:87], v[36:39], v[160:163]
v_mfma_f32_16x16x32_bf16 v[156:159], a[72:75], v[40:43], v[156:159]
v_cvt_pk_bf16_f32 v136, v180, v181
v_mfma_f32_16x16x32_bf16 v[160:163], a[88:91], v[40:43], v[160:163]
v_cvt_pk_bf16_f32 v137, v182, v183
v_mfma_f32_16x16x32_bf16 v[156:159], a[76:79], v[44:47], v[156:159]
v_cvt_pk_bf16_f32 v138, v184, v185
v_mfma_f32_16x16x32_bf16 v[160:163], a[92:95], v[44:47], v[160:163]
v_cvt_pk_bf16_f32 v139, v186, v187
v_mfma_f32_16x16x32_bf16 v[156:159], a[224:227], v[64:67], v[156:159]
buffer_store_dwordx4 v[136:139], v9, s[4:7], s64 offen offset:768 sc1
v_mfma_f32_16x16x32_bf16 v[160:163], a[240:243], v[64:67], v[160:163]
v_mfma_f32_16x16x32_bf16 v[156:159], a[228:231], v[68:71], v[156:159]
v_mfma_f32_16x16x32_bf16 v[160:163], a[244:247], v[68:71], v[160:163]
v_mfma_f32_16x16x32_bf16 v[156:159], a[232:235], v[72:75], v[156:159]
v_mfma_f32_16x16x32_bf16 v[160:163], a[248:251], v[72:75], v[160:163]
v_mfma_f32_16x16x32_bf16 v[156:159], a[236:239], v[76:79], v[156:159]
v_mfma_f32_16x16x32_bf16 v[160:163], a[252:255], v[76:79], v[160:163]
s_waitcnt lgkmcnt(7)
v_mfma_f32_16x16x32_bf16 v[164:167], v[192:195], v[48:51], 0
v_mfma_f32_16x16x32_bf16 v[168:171], v[208:211], v[48:51], 0
s_waitcnt lgkmcnt(6)
v_mfma_f32_16x16x32_bf16 v[164:167], v[196:199], v[52:55], v[164:167]
v_mfma_f32_16x16x32_bf16 v[168:171], v[212:215], v[52:55], v[168:171]
s_waitcnt lgkmcnt(5)
v_mfma_f32_16x16x32_bf16 v[164:167], v[200:203], v[56:59], v[164:167]
v_cvt_pk_bf16_f32 v140, v156, v157
v_mfma_f32_16x16x32_bf16 v[168:171], v[216:219], v[56:59], v[168:171]
v_cvt_pk_bf16_f32 v141, v158, v159
s_waitcnt lgkmcnt(4)
v_mfma_f32_16x16x32_bf16 v[164:167], v[204:207], v[60:63], v[164:167]
v_cvt_pk_bf16_f32 v142, v160, v161
v_mfma_f32_16x16x32_bf16 v[168:171], v[220:223], v[60:63], v[168:171]
v_cvt_pk_bf16_f32 v143, v162, v163
s_waitcnt lgkmcnt(3)
v_mfma_f32_16x16x32_bf16 v[164:167], a[96:99], v[80:83], v[164:167]
buffer_store_dwordx4 v[140:143], v9, s[4:7], s64 offen offset:1024 sc1
v_mfma_f32_16x16x32_bf16 v[168:171], a[112:115], v[80:83], v[168:171]
s_waitcnt lgkmcnt(2)
v_mfma_f32_16x16x32_bf16 v[164:167], a[100:103], v[84:87], v[164:167]
v_mfma_f32_16x16x32_bf16 v[168:171], a[116:119], v[84:87], v[168:171]
s_waitcnt lgkmcnt(1)
v_mfma_f32_16x16x32_bf16 v[164:167], a[104:107], v[88:91], v[164:167]
v_mfma_f32_16x16x32_bf16 v[168:171], a[120:123], v[88:91], v[168:171]
s_waitcnt lgkmcnt(0)
v_mfma_f32_16x16x32_bf16 v[164:167], a[108:111], v[92:95], v[164:167]
v_mfma_f32_16x16x32_bf16 v[168:171], a[124:127], v[92:95], v[168:171]
v_mfma_f32_16x16x32_bf16 v[172:175], v[224:227], v[48:51], 0
v_mfma_f32_16x16x32_bf16 v[176:179], v[240:243], v[48:51], 0
v_mfma_f32_16x16x32_bf16 v[172:175], v[228:231], v[52:55], v[172:175]
v_mfma_f32_16x16x32_bf16 v[176:179], v[244:247], v[52:55], v[176:179]
v_mfma_f32_16x16x32_bf16 v[172:175], v[232:235], v[56:59], v[172:175]
v_cvt_pk_bf16_f32 v144, v164, v165
v_mfma_f32_16x16x32_bf16 v[176:179], v[248:251], v[56:59], v[176:179]
v_cvt_pk_bf16_f32 v145, v166, v167
v_mfma_f32_16x16x32_bf16 v[172:175], v[236:239], v[60:63], v[172:175]
v_cvt_pk_bf16_f32 v146, v168, v169
v_mfma_f32_16x16x32_bf16 v[176:179], v[252:255], v[60:63], v[176:179]
v_cvt_pk_bf16_f32 v147, v170, v171
v_mfma_f32_16x16x32_bf16 v[172:175], a[128:131], v[80:83], v[172:175]
buffer_store_dwordx4 v[144:147], v9, s[4:7], s52 offen offset:0 sc1
v_mfma_f32_16x16x32_bf16 v[176:179], a[144:147], v[80:83], v[176:179]
v_mfma_f32_16x16x32_bf16 v[172:175], a[132:135], v[84:87], v[172:175]
v_mfma_f32_16x16x32_bf16 v[176:179], a[148:151], v[84:87], v[176:179]
v_mfma_f32_16x16x32_bf16 v[172:175], a[136:139], v[88:91], v[172:175]
v_mfma_f32_16x16x32_bf16 v[176:179], a[152:155], v[88:91], v[176:179]
v_mfma_f32_16x16x32_bf16 v[172:175], a[140:143], v[92:95], v[172:175]
v_mfma_f32_16x16x32_bf16 v[176:179], a[156:159], v[92:95], v[176:179]
v_mfma_f32_16x16x32_bf16 v[180:183], a[0:3], v[48:51], 0
v_mfma_f32_16x16x32_bf16 v[184:187], a[16:19], v[48:51], 0
v_mfma_f32_16x16x32_bf16 v[180:183], a[4:7], v[52:55], v[180:183]
v_mfma_f32_16x16x32_bf16 v[184:187], a[20:23], v[52:55], v[184:187]
v_mfma_f32_16x16x32_bf16 v[180:183], a[8:11], v[56:59], v[180:183]
v_cvt_pk_bf16_f32 v148, v172, v173
v_mfma_f32_16x16x32_bf16 v[184:187], a[24:27], v[56:59], v[184:187]
v_cvt_pk_bf16_f32 v149, v174, v175
v_mfma_f32_16x16x32_bf16 v[180:183], a[12:15], v[60:63], v[180:183]
v_cvt_pk_bf16_f32 v150, v176, v177
v_mfma_f32_16x16x32_bf16 v[184:187], a[28:31], v[60:63], v[184:187]
v_cvt_pk_bf16_f32 v151, v178, v179
v_mfma_f32_16x16x32_bf16 v[180:183], a[160:163], v[80:83], v[180:183]
buffer_store_dwordx4 v[148:151], v9, s[4:7], s52 offen offset:256 sc1
v_mfma_f32_16x16x32_bf16 v[184:187], a[176:179], v[80:83], v[184:187]
v_mfma_f32_16x16x32_bf16 v[180:183], a[164:167], v[84:87], v[180:183]
v_mfma_f32_16x16x32_bf16 v[184:187], a[180:183], v[84:87], v[184:187]
v_mfma_f32_16x16x32_bf16 v[180:183], a[168:171], v[88:91], v[180:183]
v_mfma_f32_16x16x32_bf16 v[184:187], a[184:187], v[88:91], v[184:187]
v_mfma_f32_16x16x32_bf16 v[180:183], a[172:175], v[92:95], v[180:183]
v_mfma_f32_16x16x32_bf16 v[184:187], a[188:191], v[92:95], v[184:187]
v_mfma_f32_16x16x32_bf16 v[156:159], a[32:35], v[48:51], 0
v_mfma_f32_16x16x32_bf16 v[160:163], a[48:51], v[48:51], 0
v_mfma_f32_16x16x32_bf16 v[156:159], a[36:39], v[52:55], v[156:159]
v_mfma_f32_16x16x32_bf16 v[160:163], a[52:55], v[52:55], v[160:163]
v_mfma_f32_16x16x32_bf16 v[156:159], a[40:43], v[56:59], v[156:159]
v_cvt_pk_bf16_f32 v152, v180, v181
v_mfma_f32_16x16x32_bf16 v[160:163], a[56:59], v[56:59], v[160:163]
v_cvt_pk_bf16_f32 v153, v182, v183
v_mfma_f32_16x16x32_bf16 v[156:159], a[44:47], v[60:63], v[156:159]
v_cvt_pk_bf16_f32 v154, v184, v185
v_mfma_f32_16x16x32_bf16 v[160:163], a[60:63], v[60:63], v[160:163]
v_cvt_pk_bf16_f32 v155, v186, v187
v_mfma_f32_16x16x32_bf16 v[156:159], a[192:195], v[80:83], v[156:159]
buffer_store_dwordx4 v[152:155], v9, s[4:7], s52 offen offset:512 sc1
v_mfma_f32_16x16x32_bf16 v[160:163], a[208:211], v[80:83], v[160:163]
v_mfma_f32_16x16x32_bf16 v[156:159], a[196:199], v[84:87], v[156:159]
v_mfma_f32_16x16x32_bf16 v[160:163], a[212:215], v[84:87], v[160:163]
v_mfma_f32_16x16x32_bf16 v[156:159], a[200:203], v[88:91], v[156:159]
v_mfma_f32_16x16x32_bf16 v[160:163], a[216:219], v[88:91], v[160:163]
v_mfma_f32_16x16x32_bf16 v[156:159], a[204:207], v[92:95], v[156:159]
v_mfma_f32_16x16x32_bf16 v[160:163], a[220:223], v[92:95], v[160:163]
v_mfma_f32_16x16x32_bf16 v[164:167], a[64:67], v[48:51], 0
v_mfma_f32_16x16x32_bf16 v[168:171], a[80:83], v[48:51], 0
v_mfma_f32_16x16x32_bf16 v[164:167], a[68:71], v[52:55], v[164:167]
v_mfma_f32_16x16x32_bf16 v[168:171], a[84:87], v[52:55], v[168:171]
v_mfma_f32_16x16x32_bf16 v[164:167], a[72:75], v[56:59], v[164:167]
v_cvt_pk_bf16_f32 v96, v156, v157
v_mfma_f32_16x16x32_bf16 v[168:171], a[88:91], v[56:59], v[168:171]
v_cvt_pk_bf16_f32 v97, v158, v159
v_mfma_f32_16x16x32_bf16 v[164:167], a[76:79], v[60:63], v[164:167]
v_cvt_pk_bf16_f32 v98, v160, v161
v_mfma_f32_16x16x32_bf16 v[168:171], a[92:95], v[60:63], v[168:171]
v_cvt_pk_bf16_f32 v99, v162, v163
v_mfma_f32_16x16x32_bf16 v[164:167], a[224:227], v[80:83], v[164:167]
buffer_store_dwordx4 v[96:99], v9, s[4:7], s52 offen offset:768 sc1
v_mfma_f32_16x16x32_bf16 v[168:171], a[240:243], v[80:83], v[168:171]
v_mfma_f32_16x16x32_bf16 v[164:167], a[228:231], v[84:87], v[164:167]
v_mfma_f32_16x16x32_bf16 v[168:171], a[244:247], v[84:87], v[168:171]
v_mfma_f32_16x16x32_bf16 v[164:167], a[232:235], v[88:91], v[164:167]
v_mfma_f32_16x16x32_bf16 v[168:171], a[248:251], v[88:91], v[168:171]
v_mfma_f32_16x16x32_bf16 v[164:167], a[236:239], v[92:95], v[164:167]
v_mfma_f32_16x16x32_bf16 v[168:171], a[252:255], v[92:95], v[168:171]
s_nop 3
v_cvt_pk_bf16_f32 v100, v164, v165
v_cvt_pk_bf16_f32 v101, v166, v167
s_nop 1
v_cvt_pk_bf16_f32 v102, v168, v169
v_cvt_pk_bf16_f32 v103, v170, v171
buffer_store_dwordx4 v[100:103], v9, s[4:7], s52 offen offset:1024 sc1
s_waitcnt vmcnt(0) lgkmcnt(0)
s_barrier
s_cmp_lg_u32 s49, 0
s_cbranch_scc1 AW_NF
s_sub_u32 s51, s58, 1
s_lshl_b32 s51, s51, 7
s_add_u32 s51, s51, 16384
v_mov_b32 v110, 0
v_mov_b32 v111, 1
s_mov_b64 exec, 1
buffer_atomic_add v111, v110, s[4:7], s51 offen sc1
s_mov_b64 exec, -1
AW_NF:
s_add_u32 s64, s64, 1310720
s_add_u32 s58, s58, 2
s_cmp_le_u32 s58, 128
s_cbranch_scc1 AW_SEG
s_branch DONE
ROLE_CHAIN:
s_mov_b32 s40, s38
s_load_dwordx2 s[28:29], s[0:1], 8
s_mov_b32 s30, 10240
s_mov_b32 s31, 0x20000
v_lshrrev_b32 v82, 6, v0
v_and_b32 v80, 63, v0
v_readfirstlane_b32 s41, v82
v_lshrrev_b32 v81, 4, v80
v_lshlrev_b32 v1, 4, v80
s_mov_b32 s60, 0xff00ff00
s_mov_b32 s61, 0xff00ff00
s_mov_b32 s62, -1
s_mov_b32 s63, 0
s_mov_b32 s64, 0x3e0293ee
s_mov_b32 s70, 0x3e0293ee
s_mov_b32 s71, 0x3e0293ee
v_mov_b32 v82, 0x4444
v_mov_b32 v83, 0xeeee
v_cndmask_b32 v2, v82, v83, s[60:61]
s_mul_i32 s49, s41, 34816
s_add_u32 s49, s49, 23552
v_add_u32 v3, s49, v1
s_mul_i32 s49, s41, 81920
s_lshl_b32 s50, s40, 7
s_add_u32 s49, s49, s50
v_lshrrev_b32 v82, 3, v80
v_lshlrev_b32 v82, 12, v82
v_and_b32 v83, 7, v80
v_lshl_add_u32 v82, v83, 4, v82
v_add_u32 v4, s49, v82
s_lshl_b32 s74, s40, 1
s_add_u32 s74, s74, s41
s_mov_b32 s59, 1
s_cmp_lt_u32 s41, 2
s_cbranch_scc1 CH_U_OK
s_add_u32 s74, s40, 64
s_cmp_eq_u32 s41, 2
s_cselect_b32 s49, 1, 0
s_cmp_lt_u32 s40, 16
s_cselect_b32 s50, 1, 0
s_and_b32 s59, s49, s50
s_mul_i32 s74, s74, s59
CH_U_OK:
v_bfe_u32 v82, v80, 3, 1
v_lshl_add_u32 v83, v82, 2, v81
v_lshlrev_b32 v83, 7, v83
v_and_b32 v84, 7, v80
v_lshl_add_u32 v83, v84, 4, v83
s_lshl_b32 s49, s74, 12
v_add_u32 v5, s49, v83
s_lshr_b32 s49, s74, 2
s_lshl_b32 s49, s49, 9
s_and_b32 s50, s74, 1
s_lshl_b32 s50, s50, 8
s_add_u32 s49, s49, s50
s_bfe_u32 s50, s74, 0x10001
s_lshl_b32 s50, s50, 6
s_add_u32 s49, s49, s50
v_lshl_add_u32 v82, v81, 1, v82
v_lshlrev_b32 v82, 4, v82
v_lshrrev_b32 v83, 2, v84
v_lshl_add_u32 v82, v83, 7, v82
v_and_b32 v83, 3, v84
v_lshl_add_u32 v82, v83, 2, v82
v_add_u32 v82, s49, v82
v_mov_b32 v83, 0x40000000
v_cndmask_b32 v6, v83, v82, s[62:63]
v_lshrrev_b32 v82, 2, v80
v_lshlrev_b32 v82, 4, v82
v_and_b32 v83, 1, v80
v_lshl_add_u32 v7, v83, 3, v82
v_lshrrev_b32 v82, 5, v80
v_lshlrev_b32 v82, 8, v82
v_and_b32 v83, 15, v80
v_lshl_add_u32 v82, v83, 4, v82
v_and_b32 v83, 1, v81
v_lshl_add_u32 v82, v83, 3, v82
s_lshl_b32 s49, s41, 9
v_add_u32 v8, s49, v82
v_and_b32 v83, 7, v80
v_lshlrev_b32 v82, 7, v81
v_lshl_add_u32 v82, v83, 4, v82
s_mul_i32 s49, s41, 2560
v_add_u32 v9, s49, v82
s_add_u32 s50, s41, 1
s_and_b32 s50, s50, 3
s_mul_i32 s51, s50, 2560
s_sub_u32 s51, s51, s49
s_lshl_b32 s66, s50, 9
s_add_u32 s66, s66, 0
s_sub_u32 s66, s66, s49
s_add_u32 s50, s41, 2
s_and_b32 s50, s50, 3
s_mul_i32 s52, s50, 2560
s_sub_u32 s52, s52, s49
s_lshl_b32 s67, s50, 9
s_add_u32 s67, s67, 0
s_sub_u32 s67, s67, s49
s_add_u32 s50, s41, 3
s_and_b32 s50, s50, 3
s_mul_i32 s53, s50, 2560
s_sub_u32 s53, s53, s49
s_lshl_b32 s68, s50, 9
s_add_u32 s68, s68, 0
s_sub_u32 s68, s68, s49
s_lshl_b32 s50, s41, 11
s_sub_u32 s65, 0, s50
s_add_u32 s72, s50, 10240
s_lshl_b32 s49, s40, 2
s_add_u32 s49, s49, s41
s_mul_i32 s49, s49, 20480
s_add_u32 s54, s49, 2097152
s_lshl_b32 s73, s40, 7
s_add_u32 s73, s73, 0
s_waitcnt lgkmcnt(0)
v_mov_b32 v52, -1
v_mov_b32 v53, -1
v_mov_b32 v54, -1
v_mov_b32 v55, -1
s_cmp_eq_u32 s59, 0
s_cbranch_scc1 CH_NOPOISON
s_mov_b32 s49, 524288
buffer_store_dwordx4 v[52:55], v5, s[4:7], s49 offen offset:0 sc1
buffer_store_dwordx4 v[52:55], v5, s[4:7], s49 offen offset:1024 sc1
buffer_store_dwordx4 v[52:55], v5, s[4:7], s49 offen offset:2048 sc1
buffer_store_dwordx4 v[52:55], v5, s[4:7], s49 offen offset:3072 sc1
s_mov_b32 s49, 65536
buffer_store_dword v52, v6, s[4:7], s49 offen sc1
s_mov_b32 s49, 75776
buffer_store_dword v52, v6, s[4:7], s49 offen sc1
CH_NOPOISON:
s_mul_i32 s49, s40, 10240
s_add_u32 s49, s49, 131072
v_bfe_u32 v82, v0, 2, 3
v_mul_u32_u24 v82, 1280, v82
v_bfe_u32 v83, v0, 5, 2
v_and_b32 v84, 3, v0
v_lshl_add_u32 v83, v83, 2, v84
v_lshl_add_u32 v82, v83, 1, v82
v_cmp_gt_u32 vcc, 128, v0
v_lshlrev_b32 v84, 2, v0
v_mov_b32 v86, 0
v_mov_b32 v83, 32
v_cndmask_b32 v86, v83, v86, vcc
v_add_u32 v86, v86, v82
v_mov_b32 v87, 64
v_mov_b32 v83, 96
v_cndmask_b32 v87, v83, v87, vcc
v_add_u32 v87, v87, v82
buffer_load_ushort v56, v86, s[28:31], 0 offen
buffer_load_ushort v57, v87, s[28:31], 0 offen
v_mov_b32 v86, 128
v_mov_b32 v83, 160
v_cndmask_b32 v86, v83, v86, vcc
v_add_u32 v86, v86, v82
v_mov_b32 v87, 192
v_mov_b32 v83, 224
v_cndmask_b32 v87, v83, v87, vcc
v_add_u32 v87, v87, v82
buffer_load_ushort v58, v86, s[28:31], 0 offen
buffer_load_ushort v59, v87, s[28:31], 0 offen
v_mov_b32 v86, 256
v_mov_b32 v83, 320
v_cndmask_b32 v86, v83, v86, vcc
v_add_u32 v86, v86, v82
v_mov_b32 v87, 288
v_mov_b32 v83, 384
v_cndmask_b32 v87, v83, v87, vcc
v_add_u32 v87, v87, v82
buffer_load_ushort v60, v86, s[28:31], 0 offen
buffer_load_ushort v61, v87, s[28:31], 0 offen
v_mov_b32 v86, 352
v_mov_b32 v83, 448
v_cndmask_b32 v86, v83, v86, vcc
v_add_u32 v86, v86, v82
v_mov_b32 v87, 416
v_mov_b32 v83, 512
v_cndmask_b32 v87, v83, v87, vcc
v_add_u32 v87, v87, v82
buffer_load_ushort v62, v86, s[28:31], 0 offen
buffer_load_ushort v63, v87, s[28:31], 0 offen
v_mov_b32 v86, 480
v_mov_b32 v83, 576
v_cndmask_b32 v86, v83, v86, vcc
v_add_u32 v86, v86, v82
v_mov_b32 v87, 544
v_mov_b32 v83, 608
v_cndmask_b32 v87, v83, v87, vcc
v_add_u32 v87, v87, v82
buffer_load_ushort v64, v86, s[28:31], 0 offen
buffer_load_ushort v65, v87, s[28:31], 0 offen
v_mov_b32 v86, 640
v_mov_b32 v83, 672
v_cndmask_b32 v86, v83, v86, vcc
v_add_u32 v86, v86, v82
v_mov_b32 v87, 704
v_mov_b32 v83, 736
v_cndmask_b32 v87, v83, v87, vcc
v_add_u32 v87, v87, v82
buffer_load_ushort v66, v86, s[28:31], 0 offen
buffer_load_ushort v67, v87, s[28:31], 0 offen
v_mov_b32 v86, 768
v_mov_b32 v83, 800
v_cndmask_b32 v86, v83, v86, vcc
v_add_u32 v86, v86, v82
v_mov_b32 v87, 832
v_mov_b32 v83, 864
v_cndmask_b32 v87, v83, v87, vcc
v_add_u32 v87, v87, v82
buffer_load_ushort v68, v86, s[28:31], 0 offen
buffer_load_ushort v69, v87, s[28:31], 0 offen
v_mov_b32 v86, 896
v_mov_b32 v83, 960
v_cndmask_b32 v86, v83, v86, vcc
v_add_u32 v86, v86, v82
v_mov_b32 v87, 928
v_mov_b32 v83, 1024
v_cndmask_b32 v87, v83, v87, vcc
v_add_u32 v87, v87, v82
buffer_load_ushort v70, v86, s[28:31], 0 offen
buffer_load_ushort v71, v87, s[28:31], 0 offen
v_mov_b32 v86, 992
v_mov_b32 v83, 1088
v_cndmask_b32 v86, v83, v86, vcc
v_add_u32 v86, v86, v82
v_mov_b32 v87, 1056
v_mov_b32 v83, 1152
v_cndmask_b32 v87, v83, v87, vcc
v_add_u32 v87, v87, v82
buffer_load_ushort v72, v86, s[28:31], 0 offen
buffer_load_ushort v73, v87, s[28:31], 0 offen
v_mov_b32 v86, 1120
v_mov_b32 v83, 1216
v_cndmask_b32 v86, v83, v86, vcc
v_add_u32 v86, v86, v82
v_mov_b32 v87, 1184
v_mov_b32 v83, 1248
v_cndmask_b32 v87, v83, v87, vcc
v_add_u32 v87, v87, v82
buffer_load_ushort v74, v86, s[28:31], 0 offen
buffer_load_ushort v75, v87, s[28:31], 0 offen
s_waitcnt vmcnt(0)
v_lshl_or_b32 v56, v57, 16, v56
s_add_u32 s50, s49, 0
buffer_store_dword v56, v84, s[4:7], s50 offen
v_lshl_or_b32 v58, v59, 16, v58
s_add_u32 s50, s49, 1024
buffer_store_dword v58, v84, s[4:7], s50 offen
v_lshl_or_b32 v60, v61, 16, v60
s_add_u32 s50, s49, 2048
buffer_store_dword v60, v84, s[4:7], s50 offen
v_lshl_or_b32 v62, v63, 16, v62
s_add_u32 s50, s49, 3072
buffer_store_dword v62, v84, s[4:7], s50 offen
v_lshl_or_b32 v64, v65, 16, v64
s_add_u32 s50, s49, 4096
buffer_store_dword v64, v84, s[4:7], s50 offen
v_lshl_or_b32 v66, v67, 16, v66
s_add_u32 s50, s49, 5120
buffer_store_dword v66, v84, s[4:7], s50 offen
v_lshl_or_b32 v68, v69, 16, v68
s_add_u32 s50, s49, 6144
buffer_store_dword v68, v84, s[4:7], s50 offen
v_lshl_or_b32 v70, v71, 16, v70
s_add_u32 s50, s49, 7168
buffer_store_dword v70, v84, s[4:7], s50 offen
v_lshl_or_b32 v72, v73, 16, v72
s_add_u32 s50, s49, 8192
buffer_store_dword v72, v84, s[4:7], s50 offen
v_lshl_or_b32 v74, v75, 16, v74
s_add_u32 s50, s49, 9216
buffer_store_dword v74, v84, s[4:7], s50 offen
s_nop 1
v_and_b32 v82, 15, v80
v_and_b32 v83, 1, v82
v_lshrrev_b32 v84, 1, v82
v_lshl_add_u32 v83, v83, 2, v84
v_mov_b32 v84, 99
v_cndmask_b32 v83, v83, v84, s[60:61]
v_mov_b32 v82, 0x3f80
v_mov_b32 v84, 0x3f800000
v_mov_b32 v56, 0
v_cmp_eq_u32 vcc, 0, v83
s_nop 1
v_cndmask_b32 v56, v56, v82, vcc
v_cmp_eq_u32 vcc, 1, v83
s_nop 1
v_cndmask_b32 v56, v56, v84, vcc
v_mov_b32 v57, 0
v_cmp_eq_u32 vcc, 2, v83
s_nop 1
v_cndmask_b32 v57, v57, v82, vcc
v_cmp_eq_u32 vcc, 3, v83
s_nop 1
v_cndmask_b32 v57, v57, v84, vcc
v_mov_b32 v58, 0
v_cmp_eq_u32 vcc, 4, v83
s_nop 1
v_cndmask_b32 v58, v58, v82, vcc
v_cmp_eq_u32 vcc, 5, v83
s_nop 1
v_cndmask_b32 v58, v58, v84, vcc
v_mov_b32 v59, 0
v_cmp_eq_u32 vcc, 6, v83
s_nop 1
v_cndmask_b32 v59, v59, v82, vcc
v_cmp_eq_u32 vcc, 7, v83
s_nop 1
v_cndmask_b32 v59, v59, v84, vcc
v_add_u32 v82, 18432, v1
ds_write_b128 v82, v[56:59]
s_waitcnt vmcnt(0) lgkmcnt(0)
s_waitcnt vmcnt(0) lgkmcnt(0)
s_barrier
s_lshl_b32 s36, s39, 4
v_mov_b32 v11, s36
v_cmp_eq_u32 vcc, 0, v0
s_nop 0
s_and_saveexec_b64 s[34:35], vcc
s_cbranch_execz ARR_44
v_mov_b32 v10, 1
buffer_atomic_add v10, v11, s[8:11], s37 offen offset:128 sc1
ARR_44:
s_mov_b64 exec, s[34:35]
s_load_dwordx2 s[12:13], s[0:1], 16
s_mov_b32 s14, 5242880
s_mov_b32 s15, 0x20000
s_load_dwordx2 s[16:17], s[0:1], 24
s_mov_b32 s18, 5242880
s_mov_b32 s19, 0x20000
s_load_dwordx2 s[20:21], s[0:1], 32
s_mov_b32 s22, 5242880
s_mov_b32 s23, 0x20000
s_load_dwordx2 s[24:25], s[0:1], 40
s_mov_b32 s26, 5242880
s_mov_b32 s27, 0x20000
v_and_b32 v60, 63, v0
v_lshrrev_b32 v61, 4, v60
v_lshrrev_b32 v62, 1, v61
v_lshlrev_b32 v64, 13, v62
v_and_b32 v63, 15, v60
v_lshl_add_u32 v64, v63, 4, v64
v_and_b32 v62, 1, v61
v_lshl_add_u32 v65, v62, 17, v64
v_lshl_add_u32 v64, v62, 18, v64
v_lshrrev_b32 v62, 3, v60
v_mul_u32_u24 v66, 1280, v62
v_and_b32 v63, 7, v60
v_lshl_add_u32 v66, v63, 4, v66
v_lshrrev_b32 v62, 2, v60
v_mul_u32_u24 v67, 1280, v62
v_and_b32 v63, 3, v60
v_lshl_add_u32 v67, v63, 4, v67
v_bfe_u32 v62, v60, 3, 1
v_lshlrev_b32 v62, 5, v62
v_lshl_add_u32 v62, v63, 3, v62
v_bfe_u32 v63, v60, 2, 1
v_lshl_add_u32 v68, v61, 2, v63
v_lshl_add_u32 v68, v68, 8, v62
s_lshl_b32 s80, s41, 6
s_add_u32 s80, s80, 24576
v_add_u32 v68, s80, v68
s_add_u32 s80, s41, 3
s_and_b32 s80, s80, 3
s_lshl_b32 s80, s80, 13
v_add_u32 v71, s80, v68
s_add_u32 s80, s41, 2
s_and_b32 s80, s80, 3
s_lshl_b32 s80, s80, 13
v_add_u32 v70, s80, v68
s_add_u32 s80, s41, 1
s_and_b32 s80, s80, 3
s_lshl_b32 s80, s80, 13
v_add_u32 v69, s80, v68
s_add_u32 s80, s41, 0
s_and_b32 s80, s80, 3
s_lshl_b32 s80, s80, 13
v_add_u32 v68, s80, v68
v_and_b32 v72, 1, v61
v_lshlrev_b32 v72, 4, v72
v_lshrrev_b32 v73, 1, v61
v_lshl_add_u32 v72, v73, 2, v72
v_add_u32 v72, v72, v63
s_lshl_b32 s84, s41, 13
s_add_u32 s84, s84, 24576
v_add_u32 v62, s84, v62
v_lshl_add_u32 v73, v72, 6, v62
v_lshl_add_u32 v72, v72, 7, v62
s_mul_i32 s82, s41, 1310720
s_lshl_b32 s80, s40, 8
s_add_u32 s82, s82, s80
s_mul_i32 s83, s40, 163840
s_mul_i32 s80, s41, 320
s_add_u32 s83, s83, s80
s_lshl_b32 s85, s40, 2
s_add_u32 s85, s85, s41
s_mul_i32 s85, s85, 34816
s_add_u32 s85, s85, 25165824
v_bfe_u32 v62, v60, 2, 2
v_sub_u32 v62, s41, v62
v_and_b32 v62, 3, v62
v_cmp_eq_u32 s[86:87], 0, v62
v_cmp_eq_u32 s[88:89], 1, v62
v_cmp_eq_u32 s[90:91], 2, v62
v_cmp_eq_u32 s[92:93], 3, v62
v_mov_b32 v74, 0x40000000
s_waitcnt lgkmcnt(0)
s_add_u32 m0, s84, 0
s_add_u32 s80, s82, 0
buffer_load_dwordx4 v64, s[12:15], s80 offen lds
s_add_u32 m0, s84, 1024
s_add_u32 s80, s82, 16384
buffer_load_dwordx4 v64, s[12:15], s80 offen lds
s_add_u32 m0, s84, 2048
s_add_u32 s80, s82, 32768
buffer_load_dwordx4 v64, s[12:15], s80 offen lds
s_add_u32 m0, s84, 3072
s_add_u32 s80, s82, 49152
buffer_load_dwordx4 v64, s[12:15], s80 offen lds
s_add_u32 m0, s84, 4096
s_add_u32 s80, s82, 65536
buffer_load_dwordx4 v64, s[12:15], s80 offen lds
s_add_u32 m0, s84, 5120
s_add_u32 s80, s82, 81920
buffer_load_dwordx4 v64, s[12:15], s80 offen lds
s_add_u32 m0, s84, 6144
s_add_u32 s80, s82, 98304
buffer_load_dwordx4 v64, s[12:15], s80 offen lds
s_add_u32 m0, s84, 7168
s_add_u32 s80, s82, 114688
buffer_load_dwordx4 v64, s[12:15], s80 offen lds
s_mov_b64 vcc, s[90:91]
s_or_b64 vcc, vcc, s[92:93]
v_cndmask_b32 v75, v74, v64, vcc
s_add_u32 m0, s84, 32768
s_add_u32 s80, s82, 0
buffer_load_dwordx4 v75, s[16:19], s80 offen lds
s_add_u32 m0, s84, 33792
s_add_u32 s80, s82, 16384
buffer_load_dwordx4 v75, s[16:19], s80 offen lds
s_add_u32 m0, s84, 34816
s_add_u32 s80, s82, 32768
buffer_load_dwordx4 v75, s[16:19], s80 offen lds
s_add_u32 m0, s84, 35840
s_add_u32 s80, s82, 49152
buffer_load_dwordx4 v75, s[16:19], s80 offen lds
s_add_u32 m0, s84, 36864
s_add_u32 s80, s82, 65536
buffer_load_dwordx4 v75, s[16:19], s80 offen lds
s_add_u32 m0, s84, 37888
s_add_u32 s80, s82, 81920
buffer_load_dwordx4 v75, s[16:19], s80 offen lds
s_add_u32 m0, s84, 38912
s_add_u32 s80, s82, 98304
buffer_load_dwordx4 v75, s[16:19], s80 offen lds
s_add_u32 m0, s84, 39936
s_add_u32 s80, s82, 114688
buffer_load_dwordx4 v75, s[16:19], s80 offen lds
s_mov_b64 vcc, s[88:89]
s_or_b64 vcc, vcc, s[92:93]
v_cndmask_b32 v75, v74, v64, vcc
s_add_u32 m0, s84, 65536
s_add_u32 s80, s82, 0
buffer_load_dwordx4 v75, s[20:23], s80 offen lds
s_add_u32 m0, s84, 66560
s_add_u32 s80, s82, 16384
buffer_load_dwordx4 v75, s[20:23], s80 offen lds
s_add_u32 m0, s84, 67584
s_add_u32 s80, s82, 32768
buffer_load_dwordx4 v75, s[20:23], s80 offen lds
s_add_u32 m0, s84, 68608
s_add_u32 s80, s82, 49152
buffer_load_dwordx4 v75, s[20:23], s80 offen lds
s_add_u32 m0, s84, 69632
s_add_u32 s80, s82, 65536
buffer_load_dwordx4 v75, s[20:23], s80 offen lds
s_add_u32 m0, s84, 70656
s_add_u32 s80, s82, 81920
buffer_load_dwordx4 v75, s[20:23], s80 offen lds
s_add_u32 m0, s84, 71680
s_add_u32 s80, s82, 98304
buffer_load_dwordx4 v75, s[20:23], s80 offen lds
s_add_u32 m0, s84, 72704
s_add_u32 s80, s82, 114688
buffer_load_dwordx4 v75, s[20:23], s80 offen lds
s_waitcnt vmcnt(16)
s_barrier
s_add_u32 m0, s84, 98304
s_add_u32 s80, s82, 131072
buffer_load_dwordx4 v64, s[12:15], s80 offen lds
s_add_u32 m0, s84, 99328
s_add_u32 s80, s82, 147456
buffer_load_dwordx4 v64, s[12:15], s80 offen lds
s_add_u32 m0, s84, 100352
s_add_u32 s80, s82, 163840
buffer_load_dwordx4 v64, s[12:15], s80 offen lds
s_add_u32 m0, s84, 101376
s_add_u32 s80, s82, 180224
buffer_load_dwordx4 v64, s[12:15], s80 offen lds
s_add_u32 m0, s84, 102400
s_add_u32 s80, s82, 196608
buffer_load_dwordx4 v64, s[12:15], s80 offen lds
s_add_u32 m0, s84, 103424
s_add_u32 s80, s82, 212992
buffer_load_dwordx4 v64, s[12:15], s80 offen lds
s_add_u32 m0, s84, 104448
s_add_u32 s80, s82, 229376
buffer_load_dwordx4 v64, s[12:15], s80 offen lds
s_add_u32 m0, s84, 105472
s_add_u32 s80, s82, 245760
buffer_load_dwordx4 v64, s[12:15], s80 offen lds
ds_read_b64_tr_b16 v[88:89], v68 offset:0
ds_read_b64_tr_b16 v[90:91], v68 offset:512
ds_read_b64_tr_b16 v[92:93], v68 offset:4096
ds_read_b64_tr_b16 v[94:95], v68 offset:4608
ds_read_b64_tr_b16 v[128:129], v69 offset:0
ds_read_b64_tr_b16 v[130:131], v69 offset:512
ds_read_b64_tr_b16 v[132:133], v69 offset:4096
ds_read_b64_tr_b16 v[134:135], v69 offset:4608
ds_read_b64_tr_b16 v[168:169], v70 offset:0
ds_read_b64_tr_b16 v[170:171], v70 offset:512
ds_read_b64_tr_b16 v[172:173], v70 offset:4096
ds_read_b64_tr_b16 v[174:175], v70 offset:4608
ds_read_b64_tr_b16 v[208:209], v71 offset:0
ds_read_b64_tr_b16 v[210:211], v71 offset:512
ds_read_b64_tr_b16 v[212:213], v71 offset:4096
ds_read_b64_tr_b16 v[214:215], v71 offset:4608
s_waitcnt lgkmcnt(0)
s_waitcnt vmcnt(16)
s_barrier
s_mov_b64 vcc, s[92:93]
v_cndmask_b32 v75, v74, v64, vcc
s_add_u32 m0, s84, 0
s_add_u32 s80, s82, 131072
buffer_load_dwordx4 v75, s[16:19], s80 offen lds
s_add_u32 m0, s84, 1024
s_add_u32 s80, s82, 147456
buffer_load_dwordx4 v75, s[16:19], s80 offen lds
s_add_u32 m0, s84, 2048
s_add_u32 s80, s82, 163840
buffer_load_dwordx4 v75, s[16:19], s80 offen lds
s_add_u32 m0, s84, 3072
s_add_u32 s80, s82, 180224
buffer_load_dwordx4 v75, s[16:19], s80 offen lds
s_add_u32 m0, s84, 4096
s_add_u32 s80, s82, 196608
buffer_load_dwordx4 v75, s[16:19], s80 offen lds
s_add_u32 m0, s84, 5120
s_add_u32 s80, s82, 212992
buffer_load_dwordx4 v75, s[16:19], s80 offen lds
s_add_u32 m0, s84, 6144
s_add_u32 s80, s82, 229376
buffer_load_dwordx4 v75, s[16:19], s80 offen lds
s_add_u32 m0, s84, 7168
s_add_u32 s80, s82, 245760
buffer_load_dwordx4 v75, s[16:19], s80 offen lds
ds_read_b64_tr_b16 a[8:9], v70 offset:32768
ds_read_b64_tr_b16 a[10:11], v70 offset:33280
ds_read_b64_tr_b16 a[12:13], v70 offset:36864
ds_read_b64_tr_b16 a[14:15], v70 offset:37376
ds_read_b64_tr_b16 a[32:33], v71 offset:32768
ds_read_b64_tr_b16 a[34:35], v71 offset:33280
ds_read_b64_tr_b16 a[36:37], v71 offset:36864
ds_read_b64_tr_b16 a[38:39], v71 offset:37376
s_waitcnt lgkmcnt(0)
s_waitcnt vmcnt(16)
s_barrier
s_mov_b64 vcc, s[86:87]
s_or_b64 vcc, vcc, s[88:89]
s_or_b64 vcc, vcc, s[90:91]
v_cndmask_b32 v75, v74, v64, vcc
s_add_u32 m0, s84, 32768
s_add_u32 s80, s82, 131072
buffer_load_dwordx4 v75, s[20:23], s80 offen lds
s_add_u32 m0, s84, 33792
s_add_u32 s80, s82, 147456
buffer_load_dwordx4 v75, s[20:23], s80 offen lds
s_add_u32 m0, s84, 34816
s_add_u32 s80, s82, 163840
buffer_load_dwordx4 v75, s[20:23], s80 offen lds
s_add_u32 m0, s84, 35840
s_add_u32 s80, s82, 180224
buffer_load_dwordx4 v75, s[20:23], s80 offen lds
s_add_u32 m0, s84, 36864
s_add_u32 s80, s82, 196608
buffer_load_dwordx4 v75, s[20:23], s80 offen lds
s_add_u32 m0, s84, 37888
s_add_u32 s80, s82, 212992
buffer_load_dwordx4 v75, s[20:23], s80 offen lds
s_add_u32 m0, s84, 38912
s_add_u32 s80, s82, 229376
buffer_load_dwordx4 v75, s[20:23], s80 offen lds
s_add_u32 m0, s84, 39936
s_add_u32 s80, s82, 245760
buffer_load_dwordx4 v75, s[20:23], s80 offen lds
v_add_u32 v63, 65536, v69
ds_read_b64_tr_b16 a[96:97], v63 offset:0
ds_read_b64_tr_b16 a[98:99], v63 offset:512
ds_read_b64_tr_b16 a[100:101], v63 offset:4096
ds_read_b64_tr_b16 a[102:103], v63 offset:4608
v_add_u32 v63, 65536, v71
ds_read_b64_tr_b16 a[152:153], v63 offset:0
ds_read_b64_tr_b16 a[154:155], v63 offset:512
ds_read_b64_tr_b16 a[156:157], v63 offset:4096
ds_read_b64_tr_b16 a[158:159], v63 offset:4608
s_waitcnt lgkmcnt(0)
s_waitcnt vmcnt(16)
s_barrier
s_add_u32 m0, s84, 65536
s_add_u32 s80, s82, 524288
buffer_load_dwordx4 v64, s[12:15], s80 offen lds
s_add_u32 m0, s84, 66560
s_add_u32 s80, s82, 540672
buffer_load_dwordx4 v64, s[12:15], s80 offen lds
s_add_u32 m0, s84, 67584
s_add_u32 s80, s82, 557056
buffer_load_dwordx4 v64, s[12:15], s80 offen lds
s_add_u32 m0, s84, 68608
s_add_u32 s80, s82, 573440
buffer_load_dwordx4 v64, s[12:15], s80 offen lds
s_add_u32 m0, s84, 69632
s_add_u32 s80, s82, 589824
buffer_load_dwordx4 v64, s[12:15], s80 offen lds
s_add_u32 m0, s84, 70656
s_add_u32 s80, s82, 606208
buffer_load_dwordx4 v64, s[12:15], s80 offen lds
s_add_u32 m0, s84, 71680
s_add_u32 s80, s82, 622592
buffer_load_dwordx4 v64, s[12:15], s80 offen lds
s_add_u32 m0, s84, 72704
s_add_u32 s80, s82, 638976
buffer_load_dwordx4 v64, s[12:15], s80 offen lds
v_add_u32 v63, 65536, v68
ds_read_b64_tr_b16 v[96:97], v63 offset:32768
ds_read_b64_tr_b16 v[98:99], v63 offset:33280
ds_read_b64_tr_b16 v[100:101], v63 offset:36864
ds_read_b64_tr_b16 v[102:103], v63 offset:37376
v_add_u32 v63, 65536, v69
ds_read_b64_tr_b16 v[136:137], v63 offset:32768
ds_read_b64_tr_b16 v[138:139], v63 offset:33280
ds_read_b64_tr_b16 v[140:141], v63 offset:36864
ds_read_b64_tr_b16 v[142:143], v63 offset:37376
v_add_u32 v63, 65536, v70
ds_read_b64_tr_b16 v[176:177], v63 offset:32768
ds_read_b64_tr_b16 v[178:179], v63 offset:33280
ds_read_b64_tr_b16 v[180:181], v63 offset:36864
ds_read_b64_tr_b16 v[182:183], v63 offset:37376
v_add_u32 v63, 65536, v71
ds_read_b64_tr_b16 v[216:217], v63 offset:32768
ds_read_b64_tr_b16 v[218:219], v63 offset:33280
ds_read_b64_tr_b16 v[220:221], v63 offset:36864
ds_read_b64_tr_b16 v[222:223], v63 offset:37376
s_waitcnt lgkmcnt(0)
s_waitcnt vmcnt(16)
s_barrier
s_mov_b64 vcc, s[88:89]
s_or_b64 vcc, vcc, s[92:93]
v_cndmask_b32 v75, v74, v64, vcc
s_add_u32 m0, s84, 98304
s_add_u32 s80, s82, 524288
buffer_load_dwordx4 v75, s[16:19], s80 offen lds
s_add_u32 m0, s84, 99328
s_add_u32 s80, s82, 540672
buffer_load_dwordx4 v75, s[16:19], s80 offen lds
s_add_u32 m0, s84, 100352
s_add_u32 s80, s82, 557056
buffer_load_dwordx4 v75, s[16:19], s80 offen lds
s_add_u32 m0, s84, 101376
s_add_u32 s80, s82, 573440
buffer_load_dwordx4 v75, s[16:19], s80 offen lds
s_add_u32 m0, s84, 102400
s_add_u32 s80, s82, 589824
buffer_load_dwordx4 v75, s[16:19], s80 offen lds
s_add_u32 m0, s84, 103424
s_add_u32 s80, s82, 606208
buffer_load_dwordx4 v75, s[16:19], s80 offen lds
s_add_u32 m0, s84, 104448
s_add_u32 s80, s82, 622592
buffer_load_dwordx4 v75, s[16:19], s80 offen lds
s_add_u32 m0, s84, 105472
s_add_u32 s80, s82, 638976
buffer_load_dwordx4 v75, s[16:19], s80 offen lds
ds_read_b64_tr_b16 a[40:41], v71 offset:0
ds_read_b64_tr_b16 a[42:43], v71 offset:512
ds_read_b64_tr_b16 a[44:45], v71 offset:4096
ds_read_b64_tr_b16 a[46:47], v71 offset:4608
s_waitcnt lgkmcnt(0)
s_waitcnt vmcnt(16)
s_barrier
s_mov_b64 vcc, s[86:87]
s_or_b64 vcc, vcc, s[90:91]
s_or_b64 vcc, vcc, s[92:93]
v_cndmask_b32 v75, v74, v64, vcc
s_add_u32 m0, s84, 0
s_add_u32 s80, s82, 524288
buffer_load_dwordx4 v75, s[20:23], s80 offen lds
s_add_u32 m0, s84, 1024
s_add_u32 s80, s82, 540672
buffer_load_dwordx4 v75, s[20:23], s80 offen lds
s_add_u32 m0, s84, 2048
s_add_u32 s80, s82, 557056
buffer_load_dwordx4 v75, s[20:23], s80 offen lds
s_add_u32 m0, s84, 3072
s_add_u32 s80, s82, 573440
buffer_load_dwordx4 v75, s[20:23], s80 offen lds
s_add_u32 m0, s84, 4096
s_add_u32 s80, s82, 589824
buffer_load_dwordx4 v75, s[20:23], s80 offen lds
s_add_u32 m0, s84, 5120
s_add_u32 s80, s82, 606208
buffer_load_dwordx4 v75, s[20:23], s80 offen lds
s_add_u32 m0, s84, 6144
s_add_u32 s80, s82, 622592
buffer_load_dwordx4 v75, s[20:23], s80 offen lds
s_add_u32 m0, s84, 7168
s_add_u32 s80, s82, 638976
buffer_load_dwordx4 v75, s[20:23], s80 offen lds
ds_read_b64_tr_b16 a[72:73], v68 offset:32768
ds_read_b64_tr_b16 a[74:75], v68 offset:33280
ds_read_b64_tr_b16 a[76:77], v68 offset:36864
ds_read_b64_tr_b16 a[78:79], v68 offset:37376
ds_read_b64_tr_b16 a[104:105], v69 offset:32768
ds_read_b64_tr_b16 a[106:107], v69 offset:33280
ds_read_b64_tr_b16 a[108:109], v69 offset:36864
ds_read_b64_tr_b16 a[110:111], v69 offset:37376
ds_read_b64_tr_b16 a[128:129], v70 offset:32768
ds_read_b64_tr_b16 a[130:131], v70 offset:33280
ds_read_b64_tr_b16 a[132:133], v70 offset:36864
ds_read_b64_tr_b16 a[134:135], v70 offset:37376
s_waitcnt lgkmcnt(0)
s_waitcnt vmcnt(16)
s_barrier
s_add_u32 m0, s84, 32768
s_add_u32 s80, s82, 655360
buffer_load_dwordx4 v64, s[12:15], s80 offen lds
s_add_u32 m0, s84, 33792
s_add_u32 s80, s82, 671744
buffer_load_dwordx4 v64, s[12:15], s80 offen lds
s_add_u32 m0, s84, 34816
s_add_u32 s80, s82, 688128
buffer_load_dwordx4 v64, s[12:15], s80 offen lds
s_add_u32 m0, s84, 35840
s_add_u32 s80, s82, 704512
buffer_load_dwordx4 v64, s[12:15], s80 offen lds
s_add_u32 m0, s84, 36864
s_add_u32 s80, s82, 720896
buffer_load_dwordx4 v64, s[12:15], s80 offen lds
s_add_u32 m0, s84, 37888
s_add_u32 s80, s82, 737280
buffer_load_dwordx4 v64, s[12:15], s80 offen lds
s_add_u32 m0, s84, 38912
s_add_u32 s80, s82, 753664
buffer_load_dwordx4 v64, s[12:15], s80 offen lds
s_add_u32 m0, s84, 39936
s_add_u32 s80, s82, 770048
buffer_load_dwordx4 v64, s[12:15], s80 offen lds
v_add_u32 v63, 65536, v68
ds_read_b64_tr_b16 v[104:105], v63 offset:0
ds_read_b64_tr_b16 v[106:107], v63 offset:512
ds_read_b64_tr_b16 v[108:109], v63 offset:4096
ds_read_b64_tr_b16 v[110:111], v63 offset:4608
v_add_u32 v63, 65536, v69
ds_read_b64_tr_b16 v[144:145], v63 offset:0
ds_read_b64_tr_b16 v[146:147], v63 offset:512
ds_read_b64_tr_b16 v[148:149], v63 offset:4096
ds_read_b64_tr_b16 v[150:151], v63 offset:4608
v_add_u32 v63, 65536, v70
ds_read_b64_tr_b16 v[184:185], v63 offset:0
ds_read_b64_tr_b16 v[186:187], v63 offset:512
ds_read_b64_tr_b16 v[188:189], v63 offset:4096
ds_read_b64_tr_b16 v[190:191], v63 offset:4608
v_add_u32 v63, 65536, v71
ds_read_b64_tr_b16 v[224:225], v63 offset:0
ds_read_b64_tr_b16 v[226:227], v63 offset:512
ds_read_b64_tr_b16 v[228:229], v63 offset:4096
ds_read_b64_tr_b16 v[230:231], v63 offset:4608
s_waitcnt lgkmcnt(0)
s_waitcnt vmcnt(16)
s_barrier
s_mov_b64 vcc, s[90:91]
s_or_b64 vcc, vcc, s[92:93]
v_cndmask_b32 v75, v74, v64, vcc
s_add_u32 m0, s84, 65536
s_add_u32 s80, s82, 655360
buffer_load_dwordx4 v75, s[16:19], s80 offen lds
s_add_u32 m0, s84, 66560
s_add_u32 s80, s82, 671744
buffer_load_dwordx4 v75, s[16:19], s80 offen lds
s_add_u32 m0, s84, 67584
s_add_u32 s80, s82, 688128
buffer_load_dwordx4 v75, s[16:19], s80 offen lds
s_add_u32 m0, s84, 68608
s_add_u32 s80, s82, 704512
buffer_load_dwordx4 v75, s[16:19], s80 offen lds
s_add_u32 m0, s84, 69632
s_add_u32 s80, s82, 720896
buffer_load_dwordx4 v75, s[16:19], s80 offen lds
s_add_u32 m0, s84, 70656
s_add_u32 s80, s82, 737280
buffer_load_dwordx4 v75, s[16:19], s80 offen lds
s_add_u32 m0, s84, 71680
s_add_u32 s80, s82, 753664
buffer_load_dwordx4 v75, s[16:19], s80 offen lds
s_add_u32 m0, s84, 72704
s_add_u32 s80, s82, 770048
buffer_load_dwordx4 v75, s[16:19], s80 offen lds
v_add_u32 v63, 65536, v69
ds_read_b64_tr_b16 a[0:1], v63 offset:32768
ds_read_b64_tr_b16 a[2:3], v63 offset:33280
ds_read_b64_tr_b16 a[4:5], v63 offset:36864
ds_read_b64_tr_b16 a[6:7], v63 offset:37376
v_add_u32 v63, 65536, v71
ds_read_b64_tr_b16 a[48:49], v63 offset:32768
ds_read_b64_tr_b16 a[50:51], v63 offset:33280
ds_read_b64_tr_b16 a[52:53], v63 offset:36864
ds_read_b64_tr_b16 a[54:55], v63 offset:37376
s_waitcnt lgkmcnt(0)
s_waitcnt vmcnt(16)
s_barrier
s_mov_b64 vcc, s[86:87]
s_or_b64 vcc, vcc, s[88:89]
s_or_b64 vcc, vcc, s[92:93]
v_cndmask_b32 v75, v74, v64, vcc
s_add_u32 m0, s84, 98304
s_add_u32 s80, s82, 655360
buffer_load_dwordx4 v75, s[20:23], s80 offen lds
s_add_u32 m0, s84, 99328
s_add_u32 s80, s82, 671744
buffer_load_dwordx4 v75, s[20:23], s80 offen lds
s_add_u32 m0, s84, 100352
s_add_u32 s80, s82, 688128
buffer_load_dwordx4 v75, s[20:23], s80 offen lds
s_add_u32 m0, s84, 101376
s_add_u32 s80, s82, 704512
buffer_load_dwordx4 v75, s[20:23], s80 offen lds
s_add_u32 m0, s84, 102400
s_add_u32 s80, s82, 720896
buffer_load_dwordx4 v75, s[20:23], s80 offen lds
s_add_u32 m0, s84, 103424
s_add_u32 s80, s82, 737280
buffer_load_dwordx4 v75, s[20:23], s80 offen lds
s_add_u32 m0, s84, 104448
s_add_u32 s80, s82, 753664
buffer_load_dwordx4 v75, s[20:23], s80 offen lds
s_add_u32 m0, s84, 105472
s_add_u32 s80, s82, 770048
buffer_load_dwordx4 v75, s[20:23], s80 offen lds
ds_read_b64_tr_b16 a[80:81], v68 offset:0
ds_read_b64_tr_b16 a[82:83], v68 offset:512
ds_read_b64_tr_b16 a[84:85], v68 offset:4096
ds_read_b64_tr_b16 a[86:87], v68 offset:4608
ds_read_b64_tr_b16 a[136:137], v70 offset:0
ds_read_b64_tr_b16 a[138:139], v70 offset:512
ds_read_b64_tr_b16 a[140:141], v70 offset:4096
ds_read_b64_tr_b16 a[142:143], v70 offset:4608
ds_read_b64_tr_b16 a[160:161], v71 offset:0
ds_read_b64_tr_b16 a[162:163], v71 offset:512
ds_read_b64_tr_b16 a[164:165], v71 offset:4096
ds_read_b64_tr_b16 a[166:167], v71 offset:4608
s_waitcnt lgkmcnt(0)
s_waitcnt vmcnt(16)
s_barrier
s_add_u32 m0, s84, 0
s_add_u32 s80, s82, 1048576
buffer_load_dwordx4 v65, s[12:15], s80 offen lds
s_add_u32 m0, s84, 1024
s_add_u32 s80, s82, 1064960
buffer_load_dwordx4 v65, s[12:15], s80 offen lds
s_add_u32 m0, s84, 2048
s_add_u32 s80, s82, 1081344
buffer_load_dwordx4 v65, s[12:15], s80 offen lds
s_add_u32 m0, s84, 3072
s_add_u32 s80, s82, 1097728
buffer_load_dwordx4 v65, s[12:15], s80 offen lds
s_add_u32 m0, s84, 4096
s_add_u32 s80, s82, 1114112
buffer_load_dwordx4 v65, s[12:15], s80 offen lds
s_add_u32 m0, s84, 5120
s_add_u32 s80, s82, 1130496
buffer_load_dwordx4 v65, s[12:15], s80 offen lds
s_add_u32 m0, s84, 6144
s_add_u32 s80, s82, 1146880
buffer_load_dwordx4 v65, s[12:15], s80 offen lds
s_add_u32 m0, s84, 7168
s_add_u32 s80, s82, 1163264
buffer_load_dwordx4 v65, s[12:15], s80 offen lds
ds_read_b64_tr_b16 v[112:113], v68 offset:32768
ds_read_b64_tr_b16 v[114:115], v68 offset:33280
ds_read_b64_tr_b16 v[116:117], v68 offset:36864
ds_read_b64_tr_b16 v[118:119], v68 offset:37376
ds_read_b64_tr_b16 v[152:153], v69 offset:32768
ds_read_b64_tr_b16 v[154:155], v69 offset:33280
ds_read_b64_tr_b16 v[156:157], v69 offset:36864
ds_read_b64_tr_b16 v[158:159], v69 offset:37376
ds_read_b64_tr_b16 v[192:193], v70 offset:32768
ds_read_b64_tr_b16 v[194:195], v70 offset:33280
ds_read_b64_tr_b16 v[196:197], v70 offset:36864
ds_read_b64_tr_b16 v[198:199], v70 offset:37376
ds_read_b64_tr_b16 v[232:233], v71 offset:32768
ds_read_b64_tr_b16 v[234:235], v71 offset:33280
ds_read_b64_tr_b16 v[236:237], v71 offset:36864
ds_read_b64_tr_b16 v[238:239], v71 offset:37376
s_waitcnt lgkmcnt(0)
s_waitcnt vmcnt(16)
s_barrier
s_mov_b64 vcc, s[86:87]
s_or_b64 vcc, vcc, s[90:91]
s_or_b64 vcc, vcc, s[92:93]
v_cndmask_b32 v75, v74, v65, vcc
s_add_u32 m0, s84, 32768
s_add_u32 s80, s82, 1048576
buffer_load_dwordx4 v75, s[16:19], s80 offen lds
s_add_u32 m0, s84, 33792
s_add_u32 s80, s82, 1064960
buffer_load_dwordx4 v75, s[16:19], s80 offen lds
s_add_u32 m0, s84, 34816
s_add_u32 s80, s82, 1081344
buffer_load_dwordx4 v75, s[16:19], s80 offen lds
s_add_u32 m0, s84, 35840
s_add_u32 s80, s82, 1097728
buffer_load_dwordx4 v75, s[16:19], s80 offen lds
s_add_u32 m0, s84, 36864
s_add_u32 s80, s82, 1114112
buffer_load_dwordx4 v75, s[16:19], s80 offen lds
s_add_u32 m0, s84, 37888
s_add_u32 s80, s82, 1130496
buffer_load_dwordx4 v75, s[16:19], s80 offen lds
s_add_u32 m0, s84, 38912
s_add_u32 s80, s82, 1146880
buffer_load_dwordx4 v75, s[16:19], s80 offen lds
s_add_u32 m0, s84, 39936
s_add_u32 s80, s82, 1163264
buffer_load_dwordx4 v75, s[16:19], s80 offen lds
v_add_u32 v63, 65536, v70
ds_read_b64_tr_b16 a[16:17], v63 offset:0
ds_read_b64_tr_b16 a[18:19], v63 offset:512
ds_read_b64_tr_b16 a[20:21], v63 offset:4096
ds_read_b64_tr_b16 a[22:23], v63 offset:4608
v_add_u32 v63, 65536, v71
ds_read_b64_tr_b16 a[56:57], v63 offset:0
ds_read_b64_tr_b16 a[58:59], v63 offset:512
ds_read_b64_tr_b16 a[60:61], v63 offset:4096
ds_read_b64_tr_b16 a[62:63], v63 offset:4608
s_waitcnt lgkmcnt(0)
s_waitcnt vmcnt(16)
s_barrier
s_mov_b64 vcc, s[88:89]
s_or_b64 vcc, vcc, s[90:91]
s_or_b64 vcc, vcc, s[92:93]
v_cndmask_b32 v75, v74, v65, vcc
s_add_u32 m0, s84, 65536
s_add_u32 s80, s82, 1048576
buffer_load_dwordx4 v75, s[20:23], s80 offen lds
s_add_u32 m0, s84, 66560
s_add_u32 s80, s82, 1064960
buffer_load_dwordx4 v75, s[20:23], s80 offen lds
s_add_u32 m0, s84, 67584
s_add_u32 s80, s82, 1081344
buffer_load_dwordx4 v75, s[20:23], s80 offen lds
s_add_u32 m0, s84, 68608
s_add_u32 s80, s82, 1097728
buffer_load_dwordx4 v75, s[20:23], s80 offen lds
s_add_u32 m0, s84, 69632
s_add_u32 s80, s82, 1114112
buffer_load_dwordx4 v75, s[20:23], s80 offen lds
s_add_u32 m0, s84, 70656
s_add_u32 s80, s82, 1130496
buffer_load_dwordx4 v75, s[20:23], s80 offen lds
s_add_u32 m0, s84, 71680
s_add_u32 s80, s82, 1146880
buffer_load_dwordx4 v75, s[20:23], s80 offen lds
s_add_u32 m0, s84, 72704
s_add_u32 s80, s82, 1163264
buffer_load_dwordx4 v75, s[20:23], s80 offen lds
v_add_u32 v63, 65536, v68
ds_read_b64_tr_b16 a[88:89], v63 offset:32768
ds_read_b64_tr_b16 a[90:91], v63 offset:33280
ds_read_b64_tr_b16 a[92:93], v63 offset:36864
ds_read_b64_tr_b16 a[94:95], v63 offset:37376
v_add_u32 v63, 65536, v69
ds_read_b64_tr_b16 a[112:113], v63 offset:32768
ds_read_b64_tr_b16 a[114:115], v63 offset:33280
ds_read_b64_tr_b16 a[116:117], v63 offset:36864
ds_read_b64_tr_b16 a[118:119], v63 offset:37376
v_add_u32 v63, 65536, v71
ds_read_b64_tr_b16 a[168:169], v63 offset:32768
ds_read_b64_tr_b16 a[170:171], v63 offset:33280
ds_read_b64_tr_b16 a[172:173], v63 offset:36864
ds_read_b64_tr_b16 a[174:175], v63 offset:37376
s_waitcnt lgkmcnt(0)
s_waitcnt vmcnt(16)
s_barrier
s_add_u32 s81, s41, 0
s_and_b32 s81, s81, 3
s_mul_i32 s81, s81, 40960
s_add_u32 s81, s81, s83
s_add_u32 m0, s84, 98304
s_add_u32 s80, s81, 0
buffer_load_dwordx4 v66, s[24:27], s80 offen lds
s_add_u32 m0, s84, 99328
s_add_u32 s80, s81, 10240
buffer_load_dwordx4 v66, s[24:27], s80 offen lds
s_add_u32 m0, s84, 100352
s_add_u32 s80, s81, 20480
buffer_load_dwordx4 v66, s[24:27], s80 offen lds
s_add_u32 m0, s84, 101376
s_add_u32 s80, s81, 30720
buffer_load_dwordx4 v66, s[24:27], s80 offen lds
s_add_u32 m0, s84, 102400
s_add_u32 s80, s81, 128
buffer_load_dwordx4 v66, s[24:27], s80 offen lds
s_add_u32 m0, s84, 103424
s_add_u32 s80, s81, 10368
buffer_load_dwordx4 v66, s[24:27], s80 offen lds
s_add_u32 m0, s84, 104448
s_add_u32 s80, s81, 20608
buffer_load_dwordx4 v66, s[24:27], s80 offen lds
s_add_u32 m0, s84, 105472
s_add_u32 s80, s81, 30848
buffer_load_dwordx4 v66, s[24:27], s80 offen lds
ds_read_b64_tr_b16 v[120:121], v68 offset:0
ds_read_b64_tr_b16 v[122:123], v68 offset:512
ds_read_b64_tr_b16 v[124:125], v68 offset:4096
ds_read_b64_tr_b16 v[126:127], v68 offset:4608
ds_read_b64_tr_b16 v[160:161], v69 offset:0
ds_read_b64_tr_b16 v[162:163], v69 offset:512
ds_read_b64_tr_b16 v[164:165], v69 offset:4096
ds_read_b64_tr_b16 v[166:167], v69 offset:4608
ds_read_b64_tr_b16 v[200:201], v70 offset:0
ds_read_b64_tr_b16 v[202:203], v70 offset:512
ds_read_b64_tr_b16 v[204:205], v70 offset:4096
ds_read_b64_tr_b16 v[206:207], v70 offset:4608
ds_read_b64_tr_b16 v[240:241], v71 offset:0
ds_read_b64_tr_b16 v[242:243], v71 offset:512
ds_read_b64_tr_b16 v[244:245], v71 offset:4096
ds_read_b64_tr_b16 v[246:247], v71 offset:4608
s_waitcnt lgkmcnt(0)
s_waitcnt vmcnt(16)
s_barrier
s_add_u32 s81, s41, 2
s_and_b32 s81, s81, 3
s_mul_i32 s81, s81, 40960
s_add_u32 s81, s81, s83
s_add_u32 m0, s84, 0
s_add_u32 s80, s81, 0
buffer_load_dwordx4 v66, s[24:27], s80 offen lds
s_add_u32 m0, s84, 1024
s_add_u32 s80, s81, 10240
buffer_load_dwordx4 v66, s[24:27], s80 offen lds
s_add_u32 m0, s84, 2048
s_add_u32 s80, s81, 20480
buffer_load_dwordx4 v66, s[24:27], s80 offen lds
s_add_u32 m0, s84, 3072
s_add_u32 s80, s81, 30720
buffer_load_dwordx4 v66, s[24:27], s80 offen lds
ds_read_b64_tr_b16 v[248:249], v68 offset:32768
ds_read_b64_tr_b16 v[250:251], v68 offset:33280
ds_read_b64_tr_b16 v[252:253], v68 offset:36864
ds_read_b64_tr_b16 v[254:255], v68 offset:37376
ds_read_b64_tr_b16 a[24:25], v70 offset:32768
ds_read_b64_tr_b16 a[26:27], v70 offset:33280
ds_read_b64_tr_b16 a[28:29], v70 offset:36864
ds_read_b64_tr_b16 a[30:31], v70 offset:37376
ds_read_b64_tr_b16 a[64:65], v71 offset:32768
ds_read_b64_tr_b16 a[66:67], v71 offset:33280
ds_read_b64_tr_b16 a[68:69], v71 offset:36864
ds_read_b64_tr_b16 a[70:71], v71 offset:37376
s_waitcnt lgkmcnt(0)
s_waitcnt vmcnt(12)
s_barrier
s_add_u32 s81, s41, 3
s_and_b32 s81, s81, 3
s_mul_i32 s81, s81, 40960
s_add_u32 s81, s81, s83
s_add_u32 m0, s84, 36864
s_add_u32 s80, s81, 128
buffer_load_dwordx4 v66, s[24:27], s80 offen lds
s_add_u32 m0, s84, 37888
s_add_u32 s80, s81, 10368
buffer_load_dwordx4 v66, s[24:27], s80 offen lds
s_add_u32 m0, s84, 38912
s_add_u32 s80, s81, 20608
buffer_load_dwordx4 v66, s[24:27], s80 offen lds
s_add_u32 m0, s84, 39936
s_add_u32 s80, s81, 30848
buffer_load_dwordx4 v66, s[24:27], s80 offen lds
v_add_u32 v63, 65536, v69
ds_read_b64_tr_b16 a[120:121], v63 offset:0
ds_read_b64_tr_b16 a[122:123], v63 offset:512
ds_read_b64_tr_b16 a[124:125], v63 offset:4096
ds_read_b64_tr_b16 a[126:127], v63 offset:4608
v_add_u32 v63, 65536, v70
ds_read_b64_tr_b16 a[144:145], v63 offset:0
ds_read_b64_tr_b16 a[146:147], v63 offset:512
ds_read_b64_tr_b16 a[148:149], v63 offset:4096
ds_read_b64_tr_b16 a[150:151], v63 offset:4608
v_add_u32 v63, 65536, v71
ds_read_b64_tr_b16 a[176:177], v63 offset:0
ds_read_b64_tr_b16 a[178:179], v63 offset:512
ds_read_b64_tr_b16 a[180:181], v63 offset:4096
ds_read_b64_tr_b16 a[182:183], v63 offset:4608
s_waitcnt lgkmcnt(0)
s_waitcnt vmcnt(8)
s_barrier
s_add_u32 s81, s41, 0
s_and_b32 s81, s81, 3
s_mul_i32 s81, s81, 40960
s_add_u32 s81, s81, s83
s_add_u32 s81, s41, 1
s_and_b32 s81, s81, 3
s_mul_i32 s81, s81, 40960
s_add_u32 s81, s81, s83
s_add_u32 m0, s84, 67584
s_add_u32 s80, s81, 256
buffer_load_dwordx4 v67, s[24:27], s80 offen lds
s_add_u32 m0, s84, 68608
s_add_u32 s80, s81, 20736
buffer_load_dwordx4 v67, s[24:27], s80 offen lds
s_add_u32 s81, s41, 2
s_and_b32 s81, s81, 3
s_mul_i32 s81, s81, 40960
s_add_u32 s81, s81, s83
s_add_u32 s81, s41, 3
s_and_b32 s81, s81, 3
s_mul_i32 s81, s81, 40960
s_add_u32 s81, s81, s83
s_add_u32 m0, s84, 71680
s_add_u32 s80, s81, 256
buffer_load_dwordx4 v67, s[24:27], s80 offen lds
s_add_u32 m0, s84, 72704
s_add_u32 s80, s81, 20736
buffer_load_dwordx4 v67, s[24:27], s80 offen lds
v_add_u32 v63, 65536, v72
ds_read_b64_tr_b16 a[192:193], v63 offset:32832
ds_read_b64_tr_b16 a[194:195], v63 offset:33088
ds_read_b64_tr_b16 a[196:197], v63 offset:33856
ds_read_b64_tr_b16 a[198:199], v63 offset:34112
v_add_u32 v63, 65536, v72
ds_read_b64_tr_b16 a[208:209], v63 offset:36864
ds_read_b64_tr_b16 a[210:211], v63 offset:37120
ds_read_b64_tr_b16 a[212:213], v63 offset:37888
ds_read_b64_tr_b16 a[214:215], v63 offset:38144
v_add_u32 v63, 65536, v72
ds_read_b64_tr_b16 a[224:225], v63 offset:36928
ds_read_b64_tr_b16 a[226:227], v63 offset:37184
ds_read_b64_tr_b16 a[228:229], v63 offset:37952
ds_read_b64_tr_b16 a[230:231], v63 offset:38208
s_waitcnt lgkmcnt(0)
s_waitcnt vmcnt(8)
s_barrier
ds_read_b64_tr_b16 a[184:185], v72 offset:0
ds_read_b64_tr_b16 a[186:187], v72 offset:256
ds_read_b64_tr_b16 a[188:189], v72 offset:1024
ds_read_b64_tr_b16 a[190:191], v72 offset:1280
ds_read_b64_tr_b16 a[200:201], v72 offset:64
ds_read_b64_tr_b16 a[202:203], v72 offset:320
ds_read_b64_tr_b16 a[204:205], v72 offset:1088
ds_read_b64_tr_b16 a[206:207], v72 offset:1344
s_waitcnt lgkmcnt(0)
s_waitcnt vmcnt(4)
s_barrier
ds_read_b64_tr_b16 a[216:217], v72 offset:36864
ds_read_b64_tr_b16 a[218:219], v72 offset:37120
ds_read_b64_tr_b16 a[220:221], v72 offset:37888
ds_read_b64_tr_b16 a[222:223], v72 offset:38144
ds_read_b64_tr_b16 a[232:233], v72 offset:36928
ds_read_b64_tr_b16 a[234:235], v72 offset:37184
ds_read_b64_tr_b16 a[236:237], v72 offset:37952
ds_read_b64_tr_b16 a[238:239], v72 offset:38208
s_waitcnt lgkmcnt(0)
s_waitcnt vmcnt(0)
s_barrier
v_add_u32 v63, 65536, v73
ds_read_b64_tr_b16 a[240:241], v63 offset:2048
ds_read_b64_tr_b16 a[242:243], v63 offset:2176
ds_read_b64_tr_b16 a[244:245], v63 offset:2560
ds_read_b64_tr_b16 a[246:247], v63 offset:2688
v_add_u32 v63, 65536, v73
ds_read_b64_tr_b16 a[248:249], v63 offset:6144
ds_read_b64_tr_b16 a[250:251], v63 offset:6272
ds_read_b64_tr_b16 a[252:253], v63 offset:6656
ds_read_b64_tr_b16 a[254:255], v63 offset:6784
s_waitcnt lgkmcnt(0)
s_waitcnt vmcnt(0) lgkmcnt(0)
v_and_b32 v11, 7, v0
v_lshlrev_b32 v11, 4, v11
s_mov_b32 s69, 0
WST_45:
buffer_load_dword v10, v11, s[8:11], s37 offen offset:128 sc1
buffer_load_dword v11, off, s[8:11], 0 offset:132 sc1
s_add_u32 s69, s69, 1
s_cmp_gt_u32 s69, 131072
s_cbranch_scc1 ABORT
s_waitcnt vmcnt(0)
v_cmp_gt_u32 vcc, 32, v10
s_cbranch_vccz WSTOK_46
v_readfirstlane_b32 s36, v11
v_and_b32 v11, 7, v0
v_lshlrev_b32 v11, 4, v11
s_sub_u32 s35, s37, 1
s_cselect_b32 s36, s36, 0
s_cmp_lg_u32 s36, 0
s_cbranch_scc1 FALLBACK
s_sleep 2
s_branch WST_45
WSTOK_46:
s_barrier
s_mul_i32 s74, s41, 34816
s_add_u32 s74, s74, 23552
s_add_u32 m0, s74, 0
s_add_u32 s80, s85, 0
buffer_load_dwordx4 v1, s[4:7], s80 offen offset:0 sc1 lds
buffer_load_dwordx4 v1, s[4:7], s80 offen offset:1024 sc1 lds
buffer_load_dwordx4 v1, s[4:7], s80 offen offset:2048 sc1 lds
buffer_load_dwordx4 v1, s[4:7], s80 offen offset:3072 sc1 lds
s_add_u32 m0, s74, 4096
s_add_u32 s80, s85, 4096
buffer_load_dwordx4 v1, s[4:7], s80 offen offset:0 sc1 lds
buffer_load_dwordx4 v1, s[4:7], s80 offen offset:1024 sc1 lds
buffer_load_dwordx4 v1, s[4:7], s80 offen offset:2048 sc1 lds
buffer_load_dwordx4 v1, s[4:7], s80 offen offset:3072 sc1 lds
s_add_u32 m0, s74, 8192
s_add_u32 s80, s85, 8192
buffer_load_dwordx4 v1, s[4:7], s80 offen offset:0 sc1 lds
buffer_load_dwordx4 v1, s[4:7], s80 offen offset:1024 sc1 lds
buffer_load_dwordx4 v1, s[4:7], s80 offen offset:2048 sc1 lds
buffer_load_dwordx4 v1, s[4:7], s80 offen offset:3072 sc1 lds
s_add_u32 m0, s74, 12288
s_add_u32 s80, s85, 12288
buffer_load_dwordx4 v1, s[4:7], s80 offen offset:0 sc1 lds
buffer_load_dwordx4 v1, s[4:7], s80 offen offset:1024 sc1 lds
buffer_load_dwordx4 v1, s[4:7], s80 offen offset:2048 sc1 lds
buffer_load_dwordx4 v1, s[4:7], s80 offen offset:3072 sc1 lds
s_add_u32 m0, s74, 16384
s_add_u32 s80, s85, 16384
buffer_load_dwordx4 v1, s[4:7], s80 offen offset:0 sc1 lds
buffer_load_dwordx4 v1, s[4:7], s80 offen offset:1024 sc1 lds
buffer_load_dwordx4 v1, s[4:7], s80 offen offset:2048 sc1 lds
buffer_load_dwordx4 v1, s[4:7], s80 offen offset:3072 sc1 lds
s_add_u32 m0, s74, 20480
s_add_u32 s80, s85, 20480
buffer_load_dwordx4 v1, s[4:7], s80 offen offset:0 sc1 lds
buffer_load_dwordx4 v1, s[4:7], s80 offen offset:1024 sc1 lds
buffer_load_dwordx4 v1, s[4:7], s80 offen offset:2048 sc1 lds
buffer_load_dwordx4 v1, s[4:7], s80 offen offset:3072 sc1 lds
s_add_u32 m0, s74, 24576
s_add_u32 s80, s85, 24576
buffer_load_dwordx4 v1, s[4:7], s80 offen offset:0 sc1 lds
buffer_load_dwordx4 v1, s[4:7], s80 offen offset:1024 sc1 lds
buffer_load_dwordx4 v1, s[4:7], s80 offen offset:2048 sc1 lds
buffer_load_dwordx4 v1, s[4:7], s80 offen offset:3072 sc1 lds
s_add_u32 m0, s74, 28672
s_add_u32 s80, s85, 28672
buffer_load_dwordx4 v1, s[4:7], s80 offen offset:0 sc1 lds
buffer_load_dwordx4 v1, s[4:7], s80 offen offset:1024 sc1 lds
buffer_load_dwordx4 v1, s[4:7], s80 offen offset:2048 sc1 lds
buffer_load_dwordx4 v1, s[4:7], s80 offen offset:3072 sc1 lds
s_add_u32 m0, s74, 32768
s_add_u32 s80, s85, 32768
buffer_load_dwordx4 v1, s[4:7], s80 offen offset:0 sc1 lds
buffer_load_dwordx4 v1, s[4:7], s80 offen offset:1024 sc1 lds
s_waitcnt vmcnt(0) lgkmcnt(0)
s_barrier
s_cmp_lg_u32 s37, 0
s_cbranch_scc1 CHAIN_DEV
s_mov_b32 s42, 0
s_mov_b32 s44, 0
s_mov_b32 s58, 0
s_mov_b32 s48, 524288
s_mov_b32 s30, 557056
s_mov_b32 s31, 589824
s_lshl_b32 s55, s40, 13
s_lshl_b32 s49, s41, 11
s_add_u32 s55, s55, s49
s_add_u32 s55, s55, 66846720
s_lshl_b32 s56, s40, 12
s_add_u32 s56, s56, 8388608
s_add_u32 s80, s54, 0
s_add_u32 s81, s54, 4096
s_add_u32 s82, s54, 8192
s_add_u32 s83, s54, 12288
s_add_u32 s84, s54, 16384
CH_LAYER:
s_mov_b32 s43, 0
s_mul_i32 s45, s40, 10240
s_add_u32 s45, s45, 131072
s_lshl_b32 s49, s44, 6
s_add_u32 s49, s49, 1
buffer_load_dwordx4 v[12:15], v1, s[4:7], s80 offen offset:0
buffer_load_dwordx4 v[16:19], v1, s[4:7], s80 offen offset:1024
buffer_load_dwordx4 v[20:23], v1, s[4:7], s82 offen offset:0
buffer_load_dwordx4 v[24:27], v1, s[4:7], s82 offen offset:1024
s_cmp_lt_u32 s58, s49
s_cbranch_scc1 CH_KVPOLL_1048
CH_KVOK_1047:
s_mov_b32 m0, s72
s_add_u32 s55, s55, 262144
buffer_load_dwordx4 v1, s[4:7], s55 offen sc1 nt lds
buffer_load_dwordx4 v1, s[4:7], s55 offen offset:1024 sc1 nt lds
s_mul_i32 s49, s41, 2560
v_add_u32 v10, s49, v1
v_lshrrev_b32 v11, 1, v1
v_add_u32 v11, s49, v11
CH_STEP:
s_barrier
buffer_load_dwordx4 v[76:79], v9, s[4:7], s45 offen sc1
buffer_load_dwordx4 v[80:83], v9, s[4:7], s45 offen offset:512 sc1
buffer_load_dwordx4 v[52:55], v10, s[4:7], s45 offen offset:1024 sc1
buffer_load_dwordx2 v[56:57], v11, s[4:7], s45 offen offset:2048 sc1
s_and_b32 s33, s42, 1
s_mul_i32 s47, s33, 10240
s_sub_u32 s46, 75776, s47
s_add_u32 s47, s47, 65536
v_add_u32 v0, 512, v9
v_cndmask_b32 v0, v9, v0, s[60:61]
ds_read_b128 v[36:39], v3 offset:0
ds_read_b128 v[40:43], v3 offset:1024
ds_read_b128 v[44:47], v3 offset:2048
ds_read_b128 v[48:51], v3 offset:3072
s_mov_b32 s69, 0
CH_POLL2:
v_mov_b64 v[60:61], 0
v_mov_b64 v[62:63], 0
v_mov_b64 v[64:65], 0
v_mov_b64 v[66:67], 0
v_mov_b64 v[68:69], 0
v_mov_b64 v[70:71], 0
s_waitcnt vmcnt(2)
v_cndmask_b32 v28, v76, v80, s[60:61]
v_cndmask_b32 v29, v77, v81, s[60:61]
v_cndmask_b32 v30, v78, v82, s[60:61]
v_cndmask_b32 v31, v79, v83, s[60:61]
ds_write_b128 v0, v[28:31] offset:0
v_smfmac_f32_16x16x64_bf16 v[60:63], v[76:79], v[88:95], v2
v_max3_u32 v32, v28, v29, v30
s_waitcnt vmcnt(0)
ds_write_b128 v10, v[52:55] offset:1024
v_smfmac_f32_16x16x64_bf16 v[64:67], v[76:79], v[12:19], v2
ds_write_b64 v11, v[56:57] offset:2048
v_max3_u32 v33, v52, v53, v54
v_max3_u32 v32, v32, v31, v55
v_max3_u32 v33, v33, v56, v57
v_max_u32 v32, v32, v33
v_cmp_eq_u32 vcc, -1, v32
v_smfmac_f32_16x16x64_bf16 v[68:71], v[76:79], v[20:27], v2
s_cbranch_vccnz CH_POLL2R
buffer_load_dwordx4 v[28:31], v1, s[4:7], s83 offen offset:2048
buffer_load_dwordx4 v[32:35], v1, s[4:7], s83 offen offset:3072
v_smfmac_f32_16x16x64_bf16 v[60:63], v[80:83], v[96:103], v2
ds_read_b128 v[72:75], v9 offset:1024
ds_read_b128 v[84:87], v9 offset:1536
s_waitcnt lgkmcnt(7)
v_smfmac_f32_16x16x64_bf16 v[64:67], v[80:83], v[36:43], v2
buffer_load_dwordx4 v[12:15], v1, s[4:7], s80 offen offset:2048
buffer_load_dwordx4 v[16:19], v1, s[4:7], s80 offen offset:3072
v_smfmac_f32_16x16x64_bf16 v[68:71], v[80:83], a[72:79], v2
buffer_load_dwordx4 v[20:23], v1, s[4:7], s82 offen offset:2048
buffer_load_dwordx4 v[24:27], v1, s[4:7], s82 offen offset:3072
ds_read_b128 v[76:79], v9 offset:2048
v_add_u32 v10, s51, v9
ds_read_b128 v[36:39], v3 offset:4096
ds_read_b128 v[40:43], v3 offset:5120
s_waitcnt lgkmcnt(5)
s_barrier
ds_read_b128 v[80:83], v10 offset:0
s_waitcnt lgkmcnt(5)
v_smfmac_f32_16x16x64_bf16 v[60:63], v[72:75], v[104:111], v2
v_smfmac_f32_16x16x64_bf16 v[64:67], v[72:75], v[44:51], v2
ds_read_b128 v[44:47], v3 offset:6144
ds_read_b128 v[48:51], v3 offset:7168
v_smfmac_f32_16x16x64_bf16 v[68:71], v[72:75], a[80:87], v2
ds_read_b128 v[72:75], v10 offset:512
s_waitcnt lgkmcnt(7)
v_smfmac_f32_16x16x64_bf16 v[60:63], v[84:87], v[112:119], v2
s_waitcnt lgkmcnt(4)
v_smfmac_f32_16x16x64_bf16 v[64:67], v[84:87], v[36:43], v2
ds_read_b128 v[36:39], v3 offset:8192
ds_read_b128 v[40:43], v3 offset:9216
v_smfmac_f32_16x16x64_bf16 v[68:71], v[84:87], a[88:95], v2
ds_read_b128 v[84:87], v10 offset:1024
v_smfmac_f32_16x16x64_bf16 v[60:63], v[76:79], v[120:127], v2
v_smfmac_f32_16x16x64_bf16 v[64:67], v[76:79], v[248:255], v2
s_waitcnt vmcnt(4)
v_smfmac_f32_16x16x64_bf16 v[68:71], v[76:79], v[28:35], v2
buffer_load_dwordx4 v[28:31], v1, s[4:7], s84 offen offset:0
buffer_load_dwordx4 v[32:35], v1, s[4:7], s84 offen offset:1024
s_waitcnt lgkmcnt(6)
v_smfmac_f32_16x16x64_bf16 v[60:63], v[80:83], v[128:135], v2
ds_read_b128 v[76:79], v10 offset:1536
s_waitcnt lgkmcnt(5)
v_smfmac_f32_16x16x64_bf16 v[64:67], v[80:83], v[44:51], v2
ds_read_b128 v[44:47], v3 offset:10240
ds_read_b128 v[48:51], v3 offset:11264
v_smfmac_f32_16x16x64_bf16 v[68:71], v[80:83], a[96:103], v2
ds_read_b128 v[80:83], v10 offset:2048
v_add_u32 v11, s52, v9
s_waitcnt lgkmcnt(7)
v_smfmac_f32_16x16x64_bf16 v[60:63], v[72:75], v[136:143], v2
s_waitcnt lgkmcnt(5)
v_smfmac_f32_16x16x64_bf16 v[64:67], v[72:75], v[36:43], v2
ds_read_b128 v[36:39], v3 offset:12288
ds_read_b128 v[40:43], v3 offset:13312
v_smfmac_f32_16x16x64_bf16 v[68:71], v[72:75], a[104:111], v2
ds_read_b128 v[72:75], v11 offset:0
s_waitcnt lgkmcnt(7)
v_smfmac_f32_16x16x64_bf16 v[60:63], v[84:87], v[144:151], v2
v_smfmac_f32_16x16x64_bf16 v[64:67], v[84:87], a[0:7], v2
s_waitcnt vmcnt(4)
v_smfmac_f32_16x16x64_bf16 v[68:71], v[84:87], v[12:19], v2
buffer_load_dwordx4 v[12:15], v1, s[4:7], s81 offen offset:0
buffer_load_dwordx4 v[16:19], v1, s[4:7], s81 offen offset:1024
s_waitcnt lgkmcnt(6)
v_smfmac_f32_16x16x64_bf16 v[60:63], v[76:79], v[152:159], v2
ds_read_b128 v[84:87], v11 offset:512
s_waitcnt lgkmcnt(5)
v_smfmac_f32_16x16x64_bf16 v[64:67], v[76:79], v[44:51], v2
ds_read_b128 v[44:47], v3 offset:14336
ds_read_b128 v[48:51], v3 offset:15360
v_smfmac_f32_16x16x64_bf16 v[68:71], v[76:79], a[112:119], v2
ds_read_b128 v[76:79], v11 offset:1024
s_waitcnt lgkmcnt(7)
v_smfmac_f32_16x16x64_bf16 v[60:63], v[80:83], v[160:167], v2
s_waitcnt lgkmcnt(5)
v_smfmac_f32_16x16x64_bf16 v[64:67], v[80:83], v[36:43], v2
ds_read_b128 v[36:39], v3 offset:16384
ds_read_b128 v[40:43], v3 offset:17408
v_smfmac_f32_16x16x64_bf16 v[68:71], v[80:83], a[120:127], v2
ds_read_b128 v[80:83], v11 offset:1536
s_add_u32 s50, s55, 33554432
s_waitcnt lgkmcnt(7)
v_smfmac_f32_16x16x64_bf16 v[60:63], v[72:75], v[168:175], v2
buffer_load_dwordx4 v[52:55], v1, s[4:7], s50 offen offset:0 sc1 nt
buffer_load_dwordx4 v[56:59], v1, s[4:7], s50 offen offset:1024 sc1 nt
v_smfmac_f32_16x16x64_bf16 v[64:67], v[72:75], a[8:15], v2
s_waitcnt vmcnt(6)
v_smfmac_f32_16x16x64_bf16 v[68:71], v[72:75], v[20:27], v2
ds_read_b128 v[72:75], v11 offset:2048
v_add_u32 v10, s53, v9
s_waitcnt lgkmcnt(7)
v_smfmac_f32_16x16x64_bf16 v[60:63], v[84:87], v[176:183], v2
ds_read_b128 v[20:23], v1 offset:10240
ds_read_b128 v[24:27], v1 offset:14336
s_waitcnt lgkmcnt(7)
v_smfmac_f32_16x16x64_bf16 v[64:67], v[84:87], v[44:51], v2
ds_read_b128 v[44:47], v1 offset:11264
ds_read_b128 v[48:51], v1 offset:15360
v_smfmac_f32_16x16x64_bf16 v[68:71], v[84:87], a[128:135], v2
ds_read_b128 v[84:87], v10 offset:0
s_waitcnt lgkmcnt(9)
v_smfmac_f32_16x16x64_bf16 v[60:63], v[76:79], v[184:191], v2
s_waitcnt lgkmcnt(7)
v_smfmac_f32_16x16x64_bf16 v[64:67], v[76:79], v[36:43], v2
ds_read_b128 v[36:39], v1 offset:12288
ds_read_b128 v[40:43], v1 offset:16384
v_smfmac_f32_16x16x64_bf16 v[68:71], v[76:79], a[136:143], v2
ds_read_b128 v[76:79], v10 offset:512
s_waitcnt lgkmcnt(9)
v_smfmac_f32_16x16x64_bf16 v[60:63], v[80:83], v[192:199], v2
v_smfmac_f32_16x16x64_bf16 v[64:67], v[80:83], a[16:23], v2
s_waitcnt vmcnt(4)
v_smfmac_f32_16x16x64_bf16 v[68:71], v[80:83], v[28:35], v2
ds_read_b128 v[80:83], v10 offset:1024
s_lshl_b32 s49, s44, 6
s_waitcnt lgkmcnt(9)
v_smfmac_f32_16x16x64_bf16 v[60:63], v[72:75], v[200:207], v2
s_add_u32 s49, s49, s43
s_add_u32 s49, s49, 2
v_smfmac_f32_16x16x64_bf16 v[64:67], v[72:75], a[24:31], v2
s_cmp_eq_u32 s43, 63
s_cselect_b32 s49, 0, s49
v_smfmac_f32_16x16x64_bf16 v[68:71], v[72:75], a[144:151], v2
ds_read_b128 v[28:31], v1 offset:13312
ds_read_b128 v[32:35], v1 offset:17408
s_waitcnt lgkmcnt(6)
v_smfmac_f32_16x16x64_bf16 v[60:63], v[84:87], v[208:215], v2
ds_read_b128 v[72:75], v10 offset:1536
v_smfmac_f32_16x16x64_bf16 v[64:67], v[84:87], a[32:39], v2
v_smfmac_f32_16x16x64_bf16 v[68:71], v[84:87], a[152:159], v2
ds_read_b128 v[84:87], v10 offset:2048
s_waitcnt lgkmcnt(5)
v_smfmac_f32_16x16x64_bf16 v[60:63], v[76:79], v[216:223], v2
v_smfmac_f32_16x16x64_bf16 v[64:67], v[76:79], a[40:47], v2
s_waitcnt vmcnt(2)
v_smfmac_f32_16x16x64_bf16 v[68:71], v[76:79], v[12:19], v2
s_lshl_b32 s74, s44, 6
s_add_u32 s74, s74, s43
s_waitcnt lgkmcnt(4)
v_smfmac_f32_16x16x64_bf16 v[60:63], v[80:83], v[224:231], v2
v_mov_b32 v12, s74
buffer_store_dword v12, off, s[4:7], s73 offset:24 sc1
v_smfmac_f32_16x16x64_bf16 v[64:67], v[80:83], a[48:55], v2
s_waitcnt lgkmcnt(1)
v_smfmac_f32_16x16x64_bf16 v[60:63], v[72:75], v[232:239], v2
v_smfmac_f32_16x16x64_bf16 v[64:67], v[72:75], a[56:63], v2
s_waitcnt lgkmcnt(0)
v_smfmac_f32_16x16x64_bf16 v[60:63], v[84:87], v[240:247], v2
v_smfmac_f32_16x16x64_bf16 v[64:67], v[84:87], a[64:71], v2
v_smfmac_f32_16x16x64_bf16 v[68:71], v[80:83], a[160:167], v2
v_smfmac_f32_16x16x64_bf16 v[68:71], v[72:75], a[168:175], v2
v_cvt_pk_bf16_f32 v60, v60, v61
v_cvt_pk_bf16_f32 v61, v62, v63
ds_write_b64 v8, v[60:61] offset:19456
v_cvt_pk_bf16_f32 v64, v64, v65
v_cvt_pk_bf16_f32 v65, v66, v67
ds_write_b64 v8, v[64:65] offset:21504
v_smfmac_f32_16x16x64_bf16 v[68:71], v[84:87], a[176:183], v2
buffer_store_dwordx2 v[64:65], v8, s[4:7], s56 offen sc1
s_waitcnt lgkmcnt(0)
s_barrier
ds_read_b64_tr_b16 v[84:85], v7 offset:19456
ds_read_b64_tr_b16 v[86:87], v7 offset:19712
ds_read_b64_tr_b16 v[60:61], v7 offset:19968
ds_read_b64_tr_b16 v[62:63], v7 offset:20224
ds_read_b64_tr_b16 v[64:65], v7 offset:20480
ds_read_b64_tr_b16 v[66:67], v7 offset:20736
buffer_load_dwordx4 v[12:15], v1, s[4:7], s81 offen offset:2048
buffer_load_dwordx4 v[16:19], v1, s[4:7], s81 offen offset:3072
v_cvt_pk_bf16_f32 v68, v68, v69
v_cvt_pk_bf16_f32 v69, v70, v71
buffer_store_dwordx2 v[68:69], v8, s[4:7], s56 offen offset:2048 sc1
s_add_u32 s56, s56, 131072
s_cmp_eq_u32 s43, 63
s_cbranch_scc1 CH_LAYER_END
s_waitcnt lgkmcnt(4)
v_mfma_f32_16x16x32_bf16 v[72:75], v[20:23], v[84:87], 0
ds_read_b64_tr_b16 v[20:21], v7 offset:20992
ds_read_b64_tr_b16 v[22:23], v7 offset:21248
v_mfma_f32_16x16x32_bf16 v[76:79], v[24:27], v[84:87], 0
ds_read_b64_tr_b16 v[24:25], v7 offset:21504
ds_read_b64_tr_b16 v[26:27], v7 offset:21760
s_waitcnt lgkmcnt(6)
v_mfma_f32_16x16x32_bf16 v[72:75], v[44:47], v[60:63], v[72:75]
ds_read_b64_tr_b16 v[44:45], v7 offset:22016
ds_read_b64_tr_b16 v[46:47], v7 offset:22272
v_mfma_f32_16x16x32_bf16 v[76:79], v[48:51], v[60:63], v[76:79]
ds_read_b64_tr_b16 v[48:49], v7 offset:22528
ds_read_b64_tr_b16 v[50:51], v7 offset:22784
s_waitcnt lgkmcnt(8)
v_mfma_f32_16x16x32_bf16 v[72:75], v[36:39], v[64:67], v[72:75]
ds_read_b64_tr_b16 v[36:37], v7 offset:23040
ds_read_b64_tr_b16 v[38:39], v7 offset:23296
v_mfma_f32_16x16x32_bf16 v[76:79], v[40:43], v[64:67], v[76:79]
s_waitcnt lgkmcnt(8)
v_mfma_f32_16x16x32_bf16 v[72:75], v[28:31], v[20:23], v[72:75]
v_mfma_f32_16x16x32_bf16 v[76:79], v[32:35], v[20:23], v[76:79]
buffer_load_dwordx4 v[28:31], v1, s[4:7], s84 offen offset:2048
buffer_load_dwordx4 v[32:35], v1, s[4:7], s84 offen offset:3072
s_waitcnt lgkmcnt(6)
v_mfma_f32_16x16x32_bf16 v[80:83], v[24:27], v[84:87], 0
v_mov_b32 v40, 0x3f803f80
s_waitcnt lgkmcnt(4)
v_mfma_f32_16x16x32_bf16 v[80:83], v[44:47], v[60:63], v[80:83]
v_mov_b32 v41, 0x3f803f80
s_waitcnt lgkmcnt(2)
v_mfma_f32_16x16x32_bf16 v[80:83], v[48:51], v[64:67], v[80:83]
v_mov_b32 v42, 0x3f803f80
v_max3_f32 v10, v72, v73, v74
s_waitcnt lgkmcnt(0)
v_mfma_f32_16x16x32_bf16 v[80:83], v[36:39], v[20:23], v[80:83]
v_mov_b32 v43, 0x3f803f80
v_max3_f32 v10, v10, v75, v76
buffer_load_dwordx4 v[20:23], v1, s[4:7], s83 offen offset:0
buffer_load_dwordx4 v[24:27], v1, s[4:7], s83 offen offset:1024
v_max3_f32 v10, v10, v77, v78
v_max_f32 v10, v10, v79
v_add_u32 v0, s65, v9
v_mov_b64 v[84:85], 0
v_mov_b64 v[86:87], 0
v_mov_b64 v[70:71], 0
v_max3_f32 v10, v10, v80, v81
v_max3_f32 v10, v10, v82, v83
v_mov_b32 v11, v10
s_mov_b64 vcc, s[62:63]
s_nop 0
v_permlane32_swap_b32 v10, v11
v_max_f32 v10, v10, v11
v_mov_b32 v11, v10
s_nop 1
v_permlane16_swap_b32 v10, v11
v_max_f32 v10, v10, v11
v_mul_f32 v10, s64, v10
v_mov_b32 v11, v10
v_pk_fma_f32 v[72:73], v[72:73], s[70:71], v[10:11] neg_lo:[0,0,1] neg_hi:[0,0,1]
v_pk_fma_f32 v[74:75], v[74:75], s[70:71], v[10:11] neg_lo:[0,0,1] neg_hi:[0,0,1]
v_pk_fma_f32 v[76:77], v[76:77], s[70:71], v[10:11] neg_lo:[0,0,1] neg_hi:[0,0,1]
v_pk_fma_f32 v[78:79], v[78:79], s[70:71], v[10:11] neg_lo:[0,0,1] neg_hi:[0,0,1]
v_pk_fma_f32 v[80:81], v[80:81], s[70:71], v[10:11] neg_lo:[0,0,1] neg_hi:[0,0,1]
v_pk_fma_f32 v[82:83], v[82:83], s[70:71], v[10:11] neg_lo:[0,0,1] neg_hi:[0,0,1]
v_exp_f32 v72, v72
v_exp_f32 v73, v73
v_exp_f32 v74, v74
v_exp_f32 v75, v75
v_exp_f32 v76, v76
v_exp_f32 v77, v77
v_exp_f32 v78, v78
v_exp_f32 v79, v79
v_exp_f32 v80, v80
v_exp_f32 v81, v81
v_exp_f32 v82, v82
v_exp_f32 v83, v83
s_cmp_lt_u32 s58, s49
s_cbranch_scc1 CH_KVPOLL_1050
CH_KVOK_1049:
s_mov_b32 m0, s72
s_add_u32 s55, s55, 262144
buffer_load_dwordx4 v1, s[4:7], s55 offen sc1 nt lds
buffer_load_dwordx4 v1, s[4:7], s55 offen offset:1024 sc1 nt lds
v_cvt_pk_bf16_f32 v64, v72, v73
v_cvt_pk_bf16_f32 v65, v74, v75
v_cvt_pk_bf16_f32 v66, v76, v77
v_cvt_pk_bf16_f32 v67, v78, v79
v_cvt_pk_bf16_f32 v62, v80, v81
v_cvt_pk_bf16_f32 v63, v82, v83
v_mfma_f32_16x16x32_bf16 v[36:39], v[40:43], v[64:67], 0
v_cndmask_b32 v60, 0, v62, vcc
v_cndmask_b32 v61, 0, v63, vcc
s_waitcnt vmcnt(8)
v_mfma_f32_16x16x32_bf16 v[44:47], v[52:55], v[64:67], 0
v_xor_b32 v62, v62, v60
v_xor_b32 v63, v63, v61
v_mfma_f32_16x16x32_bf16 v[48:51], v[56:59], v[64:67], 0
v_mov_b64 v[72:73], 0
v_mfma_f32_16x16x16_bf16 v[36:39], v[40:41], v[60:61], v[36:39]
v_mov_b64 v[74:75], 0
v_mov_b64 v[76:77], 0
v_mfma_f32_16x16x16_bf16 v[44:47], v[68:69], v[60:61], v[44:47]
v_mov_b64 v[78:79], 0
v_mov_b64 v[80:81], 0
v_mfma_f32_16x16x16_bf16 v[48:51], v[68:69], v[62:63], v[48:51]
v_mov_b64 v[82:83], 0
v_mov_b64 v[68:69], 0
v_rcp_f32 v10, v36
s_nop 0
v_mov_b32 v11, v10
v_pk_mul_f32 v[44:45], v[44:45], v[10:11]
v_pk_mul_f32 v[46:47], v[46:47], v[10:11]
s_nop 0
v_pk_mul_f32 v[48:49], v[48:49], v[10:11]
v_pk_mul_f32 v[50:51], v[50:51], v[10:11]
v_cvt_pk_bf16_f32 v52, v44, v45
v_cvt_pk_bf16_f32 v53, v46, v47
v_cvt_pk_bf16_f32 v54, v48, v49
v_cvt_pk_bf16_f32 v55, v50, v51
ds_write_b128 v0, v[52:55]
v_add_u32 v10, s66, v9
v_smfmac_f32_16x16x64_bf16 v[76:79], v[52:55], a[208:215], v2
ds_read_b128 v[36:39], v3 offset:18432
ds_read_b128 v[40:43], v3 offset:19456
v_add_u32 v11, s67, v9
v_smfmac_f32_16x16x64_bf16 v[80:83], v[52:55], a[224:231], v2
ds_read_b128 v[44:47], v3 offset:20480
ds_read_b128 v[48:51], v3 offset:21504
v_add_u32 v0, s68, v9
s_waitcnt lgkmcnt(4)
s_barrier
ds_read_b128 v[56:59], v10
ds_read_b128 v[60:63], v11
ds_read_b128 v[64:67], v0
v_smfmac_f32_16x16x64_bf16 v[72:75], v[52:55], a[192:199], v2
s_waitcnt lgkmcnt(5)
v_smfmac_f32_16x16x64_bf16 v[84:87], v[52:55], v[36:43], v2
ds_read_b128 v[36:39], v3 offset:22528
ds_read_b128 v[40:43], v3 offset:23552
s_waitcnt lgkmcnt(5)
v_smfmac_f32_16x16x64_bf16 v[68:71], v[52:55], v[44:51], v2
ds_read_b128 v[44:47], v3 offset:24576
ds_read_b128 v[48:51], v3 offset:25600
s_waitcnt lgkmcnt(6)
v_smfmac_f32_16x16x64_bf16 v[84:87], v[56:59], a[240:247], v2
s_waitcnt lgkmcnt(2)
v_smfmac_f32_16x16x64_bf16 v[84:87], v[60:63], v[36:43], v2
ds_read_b128 v[36:39], v3 offset:26624
ds_read_b128 v[40:43], v3 offset:27648
v_smfmac_f32_16x16x64_bf16 v[84:87], v[64:67], a[248:255], v2
ds_read_b128 v[52:55], v1 offset:18432
s_waitcnt lgkmcnt(3)
v_smfmac_f32_16x16x64_bf16 v[68:71], v[56:59], v[44:51], v2
ds_read_b128 v[44:47], v3 offset:28672
ds_read_b128 v[48:51], v3 offset:29696
v_smfmac_f32_16x16x64_bf16 v[68:71], v[60:63], a[184:191], v2
v_cvt_pk_bf16_f32 v84, v84, v85
v_cvt_pk_bf16_f32 v85, v86, v87
s_waitcnt lgkmcnt(3)
v_smfmac_f32_16x16x64_bf16 v[68:71], v[64:67], v[36:43], v2
ds_read_b128 v[36:39], v3 offset:30720
ds_read_b128 v[40:43], v3 offset:31744
v_mov_b64 v[86:87], v[84:85]
s_nop 1
v_permlane32_swap_b32 v84, v86
s_waitcnt vmcnt(2)
v_smfmac_f32_16x16x64_bf16 v[72:75], v[56:59], v[12:19], v2
v_permlane32_swap_b32 v85, v87
v_and_or_b32 v84, v84, -2, s33
v_smfmac_f32_16x16x64_bf16 v[72:75], v[60:63], a[200:207], v2
s_mov_b64 exec, s[62:63]
buffer_store_dwordx4 v[84:87], v4, s[4:7], s31 offen
s_mov_b64 exec, -1
v_smfmac_f32_16x16x64_bf16 v[72:75], v[64:67], v[28:35], v2
v_cvt_pk_bf16_f32 v68, v68, v69
v_cvt_pk_bf16_f32 v69, v70, v71
s_waitcnt lgkmcnt(2)
v_smfmac_f32_16x16x64_bf16 v[76:79], v[56:59], v[44:51], v2
ds_read_b128 v[44:47], v3 offset:32768
ds_read_b128 v[48:51], v3 offset:33792
v_and_or_b32 v68, v68, -2, s33
s_nop 0
v_cvt_pk_bf16_f32 v70, v72, v73
v_smfmac_f32_16x16x64_bf16 v[76:79], v[60:63], v[20:27], v2
v_cvt_pk_bf16_f32 v71, v74, v75
buffer_store_dwordx4 v[68:71], v4, s[4:7], s48 offen
s_waitcnt lgkmcnt(2)
v_smfmac_f32_16x16x64_bf16 v[80:83], v[56:59], v[36:43], v2
v_smfmac_f32_16x16x64_bf16 v[76:79], v[64:67], a[216:223], v2
s_waitcnt lgkmcnt(0)
v_smfmac_f32_16x16x64_bf16 v[80:83], v[60:63], v[44:51], v2
v_smfmac_f32_16x16x64_bf16 v[80:83], v[64:67], a[232:239], v2
v_cvt_pk_bf16_f32 v76, v76, v77
v_cvt_pk_bf16_f32 v77, v78, v79
s_mov_b32 s69, 0
s_cmp_eq_u32 s59, 0
v_and_or_b32 v76, v76, -2, s33
s_nop 2
v_cvt_pk_bf16_f32 v78, v80, v81
v_cvt_pk_bf16_f32 v79, v82, v83
buffer_store_dwordx4 v[76:79], v4, s[4:7], s30 offen
s_cbranch_scc1 CH_NORED
v_mov_b32 v10, -1
s_waitcnt vmcnt(0)
buffer_load_dwordx4 v[36:39], v5, s[4:7], s48 offen offset:0 sc1
buffer_load_dwordx4 v[40:43], v5, s[4:7], s48 offen offset:1024 sc1
buffer_load_dwordx4 v[44:47], v5, s[4:7], s48 offen offset:2048 sc1
buffer_load_dwordx4 v[48:51], v5, s[4:7], s48 offen offset:3072 sc1
buffer_load_dwordx4 v[12:15], v1, s[4:7], s80 offen offset:0
buffer_load_dwordx4 v[16:19], v1, s[4:7], s80 offen offset:1024
buffer_load_dwordx4 v[20:23], v1, s[4:7], s82 offen offset:0
buffer_load_dwordx4 v[24:27], v1, s[4:7], s82 offen offset:1024
s_waitcnt vmcnt(7)
v_mfma_f32_16x16x32_bf16 v[56:59], v[52:55], v[36:39], 0
v_xor_b32 v11, s33, v36
s_waitcnt vmcnt(6)
v_mfma_f32_16x16x32_bf16 v[56:59], v[52:55], v[40:43], v[56:59]
v_bitop3_b32 v11, v11, v40, s33 bitop3:0xf6
s_waitcnt vmcnt(5)
v_mfma_f32_16x16x32_bf16 v[56:59], v[52:55], v[44:47], v[56:59]
v_bitop3_b32 v11, v11, v44, s33 bitop3:0xf6
s_waitcnt vmcnt(4)
v_mfma_f32_16x16x32_bf16 v[56:59], v[52:55], v[48:51], v[56:59]
v_bitop3_b32 v11, v11, v48, s33 bitop3:0xf6
v_and_b32 v11, 1, v11
v_cmp_ne_u32 vcc, 0, v11
s_cbranch_vccnz CH_POLL1
CH_P1OK:
s_nop 3
v_add_f32_dpp v56, v56, v56 row_ror:8 row_mask:0xf bank_mask:0xf
v_add_f32_dpp v57, v57, v57 row_ror:8 row_mask:0xf bank_mask:0xf
v_add_f32_dpp v58, v58, v58 row_ror:8 row_mask:0xf bank_mask:0xf
v_add_f32_dpp v59, v59, v59 row_ror:8 row_mask:0xf bank_mask:0xf
v_cvt_pk_bf16_f32 v56, v56, v57
v_cvt_pk_bf16_f32 v57, v58, v59
v_cndmask_b32 v56, v56, v57, s[60:61]
v_min_u32 v56, -2, v56
buffer_store_dword v56, v6, s[4:7], s46 offen
buffer_store_dword v10, v6, s[4:7], s47 offen
CH_RED_DONE:
s_mul_i32 s49, s41, 2560
v_add_u32 v10, s49, v1
v_lshrrev_b32 v11, 1, v1
v_add_u32 v11, s49, v11
s_mov_b32 s45, s46
s_add_u32 s42, s42, 1
s_add_u32 s43, s43, 1
s_branch CH_STEP
CH_NORED:
buffer_load_dwordx4 v[12:15], v1, s[4:7], s80 offen offset:0
buffer_load_dwordx4 v[16:19], v1, s[4:7], s80 offen offset:1024
buffer_load_dwordx4 v[20:23], v1, s[4:7], s82 offen offset:0
buffer_load_dwordx4 v[24:27], v1, s[4:7], s82 offen offset:1024
s_branch CH_RED_DONE
CH_KVPOLL_1048:
s_mov_b32 s69, 0
CH_KVPOLL_1048L:
v_and_b32 v11, 48, v1
v_lshrrev_b32 v11, 2, v11
buffer_load_dword v11, v11, s[4:7], s73 offen offset:8 sc1
s_add_u32 s69, s69, 1
s_cmp_gt_u32 s69, 131072
s_cbranch_scc1 ABORT
s_waitcnt vmcnt(0)
v_min_u32_dpp v11, v11, v11 quad_perm:[1,0,3,2] row_mask:0xf bank_mask:0xf
s_nop 1
v_min_u32_dpp v11, v11, v11 quad_perm:[2,3,0,1] row_mask:0xf bank_mask:0xf
s_nop 0
v_readfirstlane_b32 s58, v11
s_nop 1
s_cmp_lt_u32 s58, s49
s_cbranch_scc1 CH_KVPOLL_1048L
s_branch CH_KVOK_1047
CH_KVPOLL_1050:
s_mov_b32 s69, 0
CH_KVPOLL_1050L:
v_and_b32 v11, 48, v1
v_lshrrev_b32 v11, 2, v11
buffer_load_dword v11, v11, s[4:7], s73 offen offset:8 sc1
s_add_u32 s69, s69, 1
s_cmp_gt_u32 s69, 131072
s_cbranch_scc1 ABORT
s_waitcnt vmcnt(0)
v_min_u32_dpp v11, v11, v11 quad_perm:[1,0,3,2] row_mask:0xf bank_mask:0xf
s_nop 1
v_min_u32_dpp v11, v11, v11 quad_perm:[2,3,0,1] row_mask:0xf bank_mask:0xf
s_nop 0
v_readfirstlane_b32 s58, v11
s_nop 1
s_cmp_lt_u32 s58, s49
s_cbranch_scc1 CH_KVPOLL_1050L
s_branch CH_KVOK_1049
CH_POLL1:
buffer_load_dwordx4 v[36:39], v5, s[4:7], s48 offen offset:0 sc1
buffer_load_dwordx4 v[40:43], v5, s[4:7], s48 offen offset:1024 sc1
buffer_load_dwordx4 v[44:47], v5, s[4:7], s48 offen offset:2048 sc1
buffer_load_dwordx4 v[48:51], v5, s[4:7], s48 offen offset:3072 sc1
s_add_u32 s69, s69, 1
s_cmp_gt_u32 s69, 131072
s_cbranch_scc1 ABORT
s_waitcnt vmcnt(3)
v_mfma_f32_16x16x32_bf16 v[56:59], v[52:55], v[36:39], 0
v_xor_b32 v11, s33, v36
s_waitcnt vmcnt(2)
v_mfma_f32_16x16x32_bf16 v[56:59], v[52:55], v[40:43], v[56:59]
v_bitop3_b32 v11, v11, v40, s33 bitop3:0xf6
s_waitcnt vmcnt(1)
v_mfma_f32_16x16x32_bf16 v[56:59], v[52:55], v[44:47], v[56:59]
v_bitop3_b32 v11, v11, v44, s33 bitop3:0xf6
s_waitcnt vmcnt(0)
v_mfma_f32_16x16x32_bf16 v[56:59], v[52:55], v[48:51], v[56:59]
v_bitop3_b32 v11, v11, v48, s33 bitop3:0xf6
v_and_b32 v11, 1, v11
v_cmp_ne_u32 vcc, 0, v11
s_cbranch_vccnz CH_POLL1
s_nop 3
s_branch CH_P1OK
CH_POLL2R:
buffer_load_dwordx4 v[76:79], v9, s[4:7], s45 offen sc1
buffer_load_dwordx4 v[80:83], v9, s[4:7], s45 offen offset:512 sc1
buffer_load_dwordx4 v[52:55], v10, s[4:7], s45 offen offset:1024 sc1
buffer_load_dwordx2 v[56:57], v11, s[4:7], s45 offen offset:2048 sc1
s_add_u32 s69, s69, 1
s_cmp_gt_u32 s69, 131072
s_cbranch_scc1 ABORT
s_branch CH_POLL2
CH_LAYER_END:
s_add_u32 s44, s44, 1
s_lshl_b32 s49, s44, 6
v_mov_b32 v10, s49
v_mov_b32 v11, 24
s_waitcnt vmcnt(0) lgkmcnt(0)
s_barrier
buffer_store_dword v10, v11, s[4:7], s73 offen sc1
s_cmp_lt_u32 s44, 2
s_cbranch_scc1 CH_LAYER
s_waitcnt vmcnt(0)
s_branch DONE
CHAIN_DEV:
s_mov_b32 s42, 0
s_mov_b32 s44, 0
s_mov_b32 s58, 0
s_mov_b32 s48, 524288
s_mov_b32 s30, 557056
s_mov_b32 s31, 589824
s_lshl_b32 s55, s40, 13
s_lshl_b32 s49, s41, 11
s_add_u32 s55, s55, s49
s_add_u32 s55, s55, 66846720
s_lshl_b32 s56, s40, 12
s_add_u32 s56, s56, 8388608
s_add_u32 s80, s54, 0
s_add_u32 s81, s54, 4096
s_add_u32 s82, s54, 8192
s_add_u32 s83, s54, 12288
s_add_u32 s84, s54, 16384
CD_LAYER:
s_mov_b32 s43, 0
s_mul_i32 s45, s40, 10240
s_add_u32 s45, s45, 131072
s_lshl_b32 s49, s44, 6
s_add_u32 s49, s49, 1
buffer_load_dwordx4 v[12:15], v1, s[4:7], s80 offen offset:0
buffer_load_dwordx4 v[16:19], v1, s[4:7], s80 offen offset:1024
buffer_load_dwordx4 v[20:23], v1, s[4:7], s82 offen offset:0
buffer_load_dwordx4 v[24:27], v1, s[4:7], s82 offen offset:1024
s_cmp_lt_u32 s58, s49
s_cbranch_scc1 CD_KVPOLL_2052
CD_KVOK_2051:
s_mov_b32 m0, s72
s_add_u32 s55, s55, 262144
buffer_load_dwordx4 v1, s[4:7], s55 offen sc1 nt lds
buffer_load_dwordx4 v1, s[4:7], s55 offen offset:1024 sc1 nt lds
s_mul_i32 s49, s41, 2560
v_add_u32 v10, s49, v1
v_lshrrev_b32 v11, 1, v1
v_add_u32 v11, s49, v11
CD_STEP:
s_barrier
buffer_load_dwordx4 v[76:79], v9, s[4:7], s45 offen sc1
buffer_load_dwordx4 v[80:83], v9, s[4:7], s45 offen offset:512 sc1
buffer_load_dwordx4 v[52:55], v10, s[4:7], s45 offen offset:1024 sc1
buffer_load_dwordx2 v[56:57], v11, s[4:7], s45 offen offset:2048 sc1
s_and_b32 s33, s42, 1
s_mul_i32 s47, s33, 10240
s_sub_u32 s46, 75776, s47
s_add_u32 s47, s47, 65536
v_add_u32 v0, 512, v9
v_cndmask_b32 v0, v9, v0, s[60:61]
ds_read_b128 v[36:39], v3 offset:0
ds_read_b128 v[40:43], v3 offset:1024
ds_read_b128 v[44:47], v3 offset:2048
ds_read_b128 v[48:51], v3 offset:3072
s_mov_b32 s69, 0
CD_POLL2:
v_mov_b64 v[60:61], 0
v_mov_b64 v[62:63], 0
v_mov_b64 v[64:65], 0
v_mov_b64 v[66:67], 0
v_mov_b64 v[68:69], 0
v_mov_b64 v[70:71], 0
s_waitcnt vmcnt(2)
v_cndmask_b32 v28, v76, v80, s[60:61]
v_cndmask_b32 v29, v77, v81, s[60:61]
v_cndmask_b32 v30, v78, v82, s[60:61]
v_cndmask_b32 v31, v79, v83, s[60:61]
ds_write_b128 v0, v[28:31] offset:0
v_smfmac_f32_16x16x64_bf16 v[60:63], v[76:79], v[88:95], v2
v_max3_u32 v32, v28, v29, v30
s_waitcnt vmcnt(0)
ds_write_b128 v10, v[52:55] offset:1024
v_smfmac_f32_16x16x64_bf16 v[64:67], v[76:79], v[12:19], v2
ds_write_b64 v11, v[56:57] offset:2048
v_max3_u32 v33, v52, v53, v54
v_max3_u32 v32, v32, v31, v55
v_max3_u32 v33, v33, v56, v57
v_max_u32 v32, v32, v33
v_cmp_eq_u32 vcc, -1, v32
v_smfmac_f32_16x16x64_bf16 v[68:71], v[76:79], v[20:27], v2
s_cbranch_vccnz CD_POLL2R
buffer_load_dwordx4 v[28:31], v1, s[4:7], s83 offen offset:2048
buffer_load_dwordx4 v[32:35], v1, s[4:7], s83 offen offset:3072
v_smfmac_f32_16x16x64_bf16 v[60:63], v[80:83], v[96:103], v2
ds_read_b128 v[72:75], v9 offset:1024
ds_read_b128 v[84:87], v9 offset:1536
s_waitcnt lgkmcnt(7)
v_smfmac_f32_16x16x64_bf16 v[64:67], v[80:83], v[36:43], v2
buffer_load_dwordx4 v[12:15], v1, s[4:7], s80 offen offset:2048
buffer_load_dwordx4 v[16:19], v1, s[4:7], s80 offen offset:3072
v_smfmac_f32_16x16x64_bf16 v[68:71], v[80:83], a[72:79], v2
buffer_load_dwordx4 v[20:23], v1, s[4:7], s82 offen offset:2048
buffer_load_dwordx4 v[24:27], v1, s[4:7], s82 offen offset:3072
ds_read_b128 v[76:79], v9 offset:2048
v_add_u32 v10, s51, v9
ds_read_b128 v[36:39], v3 offset:4096
ds_read_b128 v[40:43], v3 offset:5120
s_waitcnt lgkmcnt(5)
s_barrier
ds_read_b128 v[80:83], v10 offset:0
s_waitcnt lgkmcnt(5)
v_smfmac_f32_16x16x64_bf16 v[60:63], v[72:75], v[104:111], v2
v_smfmac_f32_16x16x64_bf16 v[64:67], v[72:75], v[44:51], v2
ds_read_b128 v[44:47], v3 offset:6144
ds_read_b128 v[48:51], v3 offset:7168
v_smfmac_f32_16x16x64_bf16 v[68:71], v[72:75], a[80:87], v2
ds_read_b128 v[72:75], v10 offset:512
s_waitcnt lgkmcnt(7)
v_smfmac_f32_16x16x64_bf16 v[60:63], v[84:87], v[112:119], v2
s_waitcnt lgkmcnt(4)
v_smfmac_f32_16x16x64_bf16 v[64:67], v[84:87], v[36:43], v2
ds_read_b128 v[36:39], v3 offset:8192
ds_read_b128 v[40:43], v3 offset:9216
v_smfmac_f32_16x16x64_bf16 v[68:71], v[84:87], a[88:95], v2
ds_read_b128 v[84:87], v10 offset:1024
v_smfmac_f32_16x16x64_bf16 v[60:63], v[76:79], v[120:127], v2
v_smfmac_f32_16x16x64_bf16 v[64:67], v[76:79], v[248:255], v2
s_waitcnt vmcnt(4)
v_smfmac_f32_16x16x64_bf16 v[68:71], v[76:79], v[28:35], v2
buffer_load_dwordx4 v[28:31], v1, s[4:7], s84 offen offset:0
buffer_load_dwordx4 v[32:35], v1, s[4:7], s84 offen offset:1024
s_waitcnt lgkmcnt(6)
v_smfmac_f32_16x16x64_bf16 v[60:63], v[80:83], v[128:135], v2
ds_read_b128 v[76:79], v10 offset:1536
s_waitcnt lgkmcnt(5)
v_smfmac_f32_16x16x64_bf16 v[64:67], v[80:83], v[44:51], v2
ds_read_b128 v[44:47], v3 offset:10240
ds_read_b128 v[48:51], v3 offset:11264
v_smfmac_f32_16x16x64_bf16 v[68:71], v[80:83], a[96:103], v2
ds_read_b128 v[80:83], v10 offset:2048
v_add_u32 v11, s52, v9
s_waitcnt lgkmcnt(7)
v_smfmac_f32_16x16x64_bf16 v[60:63], v[72:75], v[136:143], v2
s_waitcnt lgkmcnt(5)
v_smfmac_f32_16x16x64_bf16 v[64:67], v[72:75], v[36:43], v2
ds_read_b128 v[36:39], v3 offset:12288
ds_read_b128 v[40:43], v3 offset:13312
v_smfmac_f32_16x16x64_bf16 v[68:71], v[72:75], a[104:111], v2
ds_read_b128 v[72:75], v11 offset:0
s_waitcnt lgkmcnt(7)
v_smfmac_f32_16x16x64_bf16 v[60:63], v[84:87], v[144:151], v2
v_smfmac_f32_16x16x64_bf16 v[64:67], v[84:87], a[0:7], v2
s_waitcnt vmcnt(4)
v_smfmac_f32_16x16x64_bf16 v[68:71], v[84:87], v[12:19], v2
buffer_load_dwordx4 v[12:15], v1, s[4:7], s81 offen offset:0
buffer_load_dwordx4 v[16:19], v1, s[4:7], s81 offen offset:1024
s_waitcnt lgkmcnt(6)
v_smfmac_f32_16x16x64_bf16 v[60:63], v[76:79], v[152:159], v2
ds_read_b128 v[84:87], v11 offset:512
s_waitcnt lgkmcnt(5)
v_smfmac_f32_16x16x64_bf16 v[64:67], v[76:79], v[44:51], v2
ds_read_b128 v[44:47], v3 offset:14336
ds_read_b128 v[48:51], v3 offset:15360
v_smfmac_f32_16x16x64_bf16 v[68:71], v[76:79], a[112:119], v2
ds_read_b128 v[76:79], v11 offset:1024
s_waitcnt lgkmcnt(7)
v_smfmac_f32_16x16x64_bf16 v[60:63], v[80:83], v[160:167], v2
s_waitcnt lgkmcnt(5)
v_smfmac_f32_16x16x64_bf16 v[64:67], v[80:83], v[36:43], v2
ds_read_b128 v[36:39], v3 offset:16384
ds_read_b128 v[40:43], v3 offset:17408
v_smfmac_f32_16x16x64_bf16 v[68:71], v[80:83], a[120:127], v2
ds_read_b128 v[80:83], v11 offset:1536
s_add_u32 s50, s55, 33554432
s_waitcnt lgkmcnt(7)
v_smfmac_f32_16x16x64_bf16 v[60:63], v[72:75], v[168:175], v2
buffer_load_dwordx4 v[52:55], v1, s[4:7], s50 offen offset:0 sc1 nt
buffer_load_dwordx4 v[56:59], v1, s[4:7], s50 offen offset:1024 sc1 nt
v_smfmac_f32_16x16x64_bf16 v[64:67], v[72:75], a[8:15], v2
s_waitcnt vmcnt(6)
v_smfmac_f32_16x16x64_bf16 v[68:71], v[72:75], v[20:27], v2
ds_read_b128 v[72:75], v11 offset:2048
v_add_u32 v10, s53, v9
s_waitcnt lgkmcnt(7)
v_smfmac_f32_16x16x64_bf16 v[60:63], v[84:87], v[176:183], v2
ds_read_b128 v[20:23], v1 offset:10240
ds_read_b128 v[24:27], v1 offset:14336
s_waitcnt lgkmcnt(7)
v_smfmac_f32_16x16x64_bf16 v[64:67], v[84:87], v[44:51], v2
ds_read_b128 v[44:47], v1 offset:11264
ds_read_b128 v[48:51], v1 offset:15360
v_smfmac_f32_16x16x64_bf16 v[68:71], v[84:87], a[128:135], v2
ds_read_b128 v[84:87], v10 offset:0
s_waitcnt lgkmcnt(9)
v_smfmac_f32_16x16x64_bf16 v[60:63], v[76:79], v[184:191], v2
s_waitcnt lgkmcnt(7)
v_smfmac_f32_16x16x64_bf16 v[64:67], v[76:79], v[36:43], v2
ds_read_b128 v[36:39], v1 offset:12288
ds_read_b128 v[40:43], v1 offset:16384
v_smfmac_f32_16x16x64_bf16 v[68:71], v[76:79], a[136:143], v2
ds_read_b128 v[76:79], v10 offset:512
s_waitcnt lgkmcnt(9)
v_smfmac_f32_16x16x64_bf16 v[60:63], v[80:83], v[192:199], v2
v_smfmac_f32_16x16x64_bf16 v[64:67], v[80:83], a[16:23], v2
s_waitcnt vmcnt(4)
v_smfmac_f32_16x16x64_bf16 v[68:71], v[80:83], v[28:35], v2
ds_read_b128 v[80:83], v10 offset:1024
s_lshl_b32 s49, s44, 6
s_waitcnt lgkmcnt(9)
v_smfmac_f32_16x16x64_bf16 v[60:63], v[72:75], v[200:207], v2
s_add_u32 s49, s49, s43
s_add_u32 s49, s49, 2
v_smfmac_f32_16x16x64_bf16 v[64:67], v[72:75], a[24:31], v2
s_cmp_eq_u32 s43, 63
s_cselect_b32 s49, 0, s49
v_smfmac_f32_16x16x64_bf16 v[68:71], v[72:75], a[144:151], v2
ds_read_b128 v[28:31], v1 offset:13312
ds_read_b128 v[32:35], v1 offset:17408
s_waitcnt lgkmcnt(6)
v_smfmac_f32_16x16x64_bf16 v[60:63], v[84:87], v[208:215], v2
ds_read_b128 v[72:75], v10 offset:1536
v_smfmac_f32_16x16x64_bf16 v[64:67], v[84:87], a[32:39], v2
v_smfmac_f32_16x16x64_bf16 v[68:71], v[84:87], a[152:159], v2
ds_read_b128 v[84:87], v10 offset:2048
s_waitcnt lgkmcnt(5)
v_smfmac_f32_16x16x64_bf16 v[60:63], v[76:79], v[216:223], v2
v_smfmac_f32_16x16x64_bf16 v[64:67], v[76:79], a[40:47], v2
s_waitcnt vmcnt(2)
v_smfmac_f32_16x16x64_bf16 v[68:71], v[76:79], v[12:19], v2
s_lshl_b32 s74, s44, 6
s_add_u32 s74, s74, s43
s_waitcnt lgkmcnt(4)
v_smfmac_f32_16x16x64_bf16 v[60:63], v[80:83], v[224:231], v2
v_mov_b32 v12, s74
buffer_store_dword v12, off, s[4:7], s73 offset:24 sc1
v_smfmac_f32_16x16x64_bf16 v[64:67], v[80:83], a[48:55], v2
s_waitcnt lgkmcnt(1)
v_smfmac_f32_16x16x64_bf16 v[60:63], v[72:75], v[232:239], v2
v_smfmac_f32_16x16x64_bf16 v[64:67], v[72:75], a[56:63], v2
s_waitcnt lgkmcnt(0)
v_smfmac_f32_16x16x64_bf16 v[60:63], v[84:87], v[240:247], v2
v_smfmac_f32_16x16x64_bf16 v[64:67], v[84:87], a[64:71], v2
v_smfmac_f32_16x16x64_bf16 v[68:71], v[80:83], a[160:167], v2
v_smfmac_f32_16x16x64_bf16 v[68:71], v[72:75], a[168:175], v2
v_cvt_pk_bf16_f32 v60, v60, v61
v_cvt_pk_bf16_f32 v61, v62, v63
ds_write_b64 v8, v[60:61] offset:19456
v_cvt_pk_bf16_f32 v64, v64, v65
v_cvt_pk_bf16_f32 v65, v66, v67
ds_write_b64 v8, v[64:65] offset:21504
v_smfmac_f32_16x16x64_bf16 v[68:71], v[84:87], a[176:183], v2
buffer_store_dwordx2 v[64:65], v8, s[4:7], s56 offen sc1
s_waitcnt lgkmcnt(0)
s_barrier
ds_read_b64_tr_b16 v[84:85], v7 offset:19456
ds_read_b64_tr_b16 v[86:87], v7 offset:19712
ds_read_b64_tr_b16 v[60:61], v7 offset:19968
ds_read_b64_tr_b16 v[62:63], v7 offset:20224
ds_read_b64_tr_b16 v[64:65], v7 offset:20480
ds_read_b64_tr_b16 v[66:67], v7 offset:20736
buffer_load_dwordx4 v[12:15], v1, s[4:7], s81 offen offset:2048
buffer_load_dwordx4 v[16:19], v1, s[4:7], s81 offen offset:3072
v_cvt_pk_bf16_f32 v68, v68, v69
v_cvt_pk_bf16_f32 v69, v70, v71
buffer_store_dwordx2 v[68:69], v8, s[4:7], s56 offen offset:2048 sc1
s_add_u32 s56, s56, 131072
s_cmp_eq_u32 s43, 63
s_cbranch_scc1 CD_LAYER_END
s_waitcnt lgkmcnt(4)
v_mfma_f32_16x16x32_bf16 v[72:75], v[20:23], v[84:87], 0
ds_read_b64_tr_b16 v[20:21], v7 offset:20992
ds_read_b64_tr_b16 v[22:23], v7 offset:21248
v_mfma_f32_16x16x32_bf16 v[76:79], v[24:27], v[84:87], 0
ds_read_b64_tr_b16 v[24:25], v7 offset:21504
ds_read_b64_tr_b16 v[26:27], v7 offset:21760
s_waitcnt lgkmcnt(6)
v_mfma_f32_16x16x32_bf16 v[72:75], v[44:47], v[60:63], v[72:75]
ds_read_b64_tr_b16 v[44:45], v7 offset:22016
ds_read_b64_tr_b16 v[46:47], v7 offset:22272
v_mfma_f32_16x16x32_bf16 v[76:79], v[48:51], v[60:63], v[76:79]
ds_read_b64_tr_b16 v[48:49], v7 offset:22528
ds_read_b64_tr_b16 v[50:51], v7 offset:22784
s_waitcnt lgkmcnt(8)
v_mfma_f32_16x16x32_bf16 v[72:75], v[36:39], v[64:67], v[72:75]
ds_read_b64_tr_b16 v[36:37], v7 offset:23040
ds_read_b64_tr_b16 v[38:39], v7 offset:23296
v_mfma_f32_16x16x32_bf16 v[76:79], v[40:43], v[64:67], v[76:79]
s_waitcnt lgkmcnt(8)
v_mfma_f32_16x16x32_bf16 v[72:75], v[28:31], v[20:23], v[72:75]
v_mfma_f32_16x16x32_bf16 v[76:79], v[32:35], v[20:23], v[76:79]
buffer_load_dwordx4 v[28:31], v1, s[4:7], s84 offen offset:2048
buffer_load_dwordx4 v[32:35], v1, s[4:7], s84 offen offset:3072
s_waitcnt lgkmcnt(6)
v_mfma_f32_16x16x32_bf16 v[80:83], v[24:27], v[84:87], 0
v_mov_b32 v40, 0x3f803f80
s_waitcnt lgkmcnt(4)
v_mfma_f32_16x16x32_bf16 v[80:83], v[44:47], v[60:63], v[80:83]
v_mov_b32 v41, 0x3f803f80
s_waitcnt lgkmcnt(2)
v_mfma_f32_16x16x32_bf16 v[80:83], v[48:51], v[64:67], v[80:83]
v_mov_b32 v42, 0x3f803f80
v_max3_f32 v10, v72, v73, v74
s_waitcnt lgkmcnt(0)
v_mfma_f32_16x16x32_bf16 v[80:83], v[36:39], v[20:23], v[80:83]
v_mov_b32 v43, 0x3f803f80
v_max3_f32 v10, v10, v75, v76
buffer_load_dwordx4 v[20:23], v1, s[4:7], s83 offen offset:0
buffer_load_dwordx4 v[24:27], v1, s[4:7], s83 offen offset:1024
v_max3_f32 v10, v10, v77, v78
v_max_f32 v10, v10, v79
v_add_u32 v0, s65, v9
v_mov_b64 v[84:85], 0
v_mov_b64 v[86:87], 0
v_mov_b64 v[70:71], 0
v_max3_f32 v10, v10, v80, v81
v_max3_f32 v10, v10, v82, v83
v_mov_b32 v11, v10
s_mov_b64 vcc, s[62:63]
s_nop 0
v_permlane32_swap_b32 v10, v11
v_max_f32 v10, v10, v11
v_mov_b32 v11, v10
s_nop 1
v_permlane16_swap_b32 v10, v11
v_max_f32 v10, v10, v11
v_mul_f32 v10, s64, v10
v_mov_b32 v11, v10
v_pk_fma_f32 v[72:73], v[72:73], s[70:71], v[10:11] neg_lo:[0,0,1] neg_hi:[0,0,1]
v_pk_fma_f32 v[74:75], v[74:75], s[70:71], v[10:11] neg_lo:[0,0,1] neg_hi:[0,0,1]
v_pk_fma_f32 v[76:77], v[76:77], s[70:71], v[10:11] neg_lo:[0,0,1] neg_hi:[0,0,1]
v_pk_fma_f32 v[78:79], v[78:79], s[70:71], v[10:11] neg_lo:[0,0,1] neg_hi:[0,0,1]
v_pk_fma_f32 v[80:81], v[80:81], s[70:71], v[10:11] neg_lo:[0,0,1] neg_hi:[0,0,1]
v_pk_fma_f32 v[82:83], v[82:83], s[70:71], v[10:11] neg_lo:[0,0,1] neg_hi:[0,0,1]
v_exp_f32 v72, v72
v_exp_f32 v73, v73
v_exp_f32 v74, v74
v_exp_f32 v75, v75
v_exp_f32 v76, v76
v_exp_f32 v77, v77
v_exp_f32 v78, v78
v_exp_f32 v79, v79
v_exp_f32 v80, v80
v_exp_f32 v81, v81
v_exp_f32 v82, v82
v_exp_f32 v83, v83
s_cmp_lt_u32 s58, s49
s_cbranch_scc1 CD_KVPOLL_2054
CD_KVOK_2053:
s_mov_b32 m0, s72
s_add_u32 s55, s55, 262144
buffer_load_dwordx4 v1, s[4:7], s55 offen sc1 nt lds
buffer_load_dwordx4 v1, s[4:7], s55 offen offset:1024 sc1 nt lds
v_cvt_pk_bf16_f32 v64, v72, v73
v_cvt_pk_bf16_f32 v65, v74, v75
v_cvt_pk_bf16_f32 v66, v76, v77
v_cvt_pk_bf16_f32 v67, v78, v79
v_cvt_pk_bf16_f32 v62, v80, v81
v_cvt_pk_bf16_f32 v63, v82, v83
v_mfma_f32_16x16x32_bf16 v[36:39], v[40:43], v[64:67], 0
v_cndmask_b32 v60, 0, v62, vcc
v_cndmask_b32 v61, 0, v63, vcc
s_waitcnt vmcnt(8)
v_mfma_f32_16x16x32_bf16 v[44:47], v[52:55], v[64:67], 0
v_xor_b32 v62, v62, v60
v_xor_b32 v63, v63, v61
v_mfma_f32_16x16x32_bf16 v[48:51], v[56:59], v[64:67], 0
v_mov_b64 v[72:73], 0
v_mfma_f32_16x16x16_bf16 v[36:39], v[40:41], v[60:61], v[36:39]
v_mov_b64 v[74:75], 0
v_mov_b64 v[76:77], 0
v_mfma_f32_16x16x16_bf16 v[44:47], v[68:69], v[60:61], v[44:47]
v_mov_b64 v[78:79], 0
v_mov_b64 v[80:81], 0
v_mfma_f32_16x16x16_bf16 v[48:51], v[68:69], v[62:63], v[48:51]
v_mov_b64 v[82:83], 0
v_mov_b64 v[68:69], 0
v_rcp_f32 v10, v36
s_nop 0
v_mov_b32 v11, v10
v_pk_mul_f32 v[44:45], v[44:45], v[10:11]
v_pk_mul_f32 v[46:47], v[46:47], v[10:11]
s_nop 0
v_pk_mul_f32 v[48:49], v[48:49], v[10:11]
v_pk_mul_f32 v[50:51], v[50:51], v[10:11]
v_cvt_pk_bf16_f32 v52, v44, v45
v_cvt_pk_bf16_f32 v53, v46, v47
v_cvt_pk_bf16_f32 v54, v48, v49
v_cvt_pk_bf16_f32 v55, v50, v51
ds_write_b128 v0, v[52:55]
v_add_u32 v10, s66, v9
v_smfmac_f32_16x16x64_bf16 v[76:79], v[52:55], a[208:215], v2
ds_read_b128 v[36:39], v3 offset:18432
ds_read_b128 v[40:43], v3 offset:19456
v_add_u32 v11, s67, v9
v_smfmac_f32_16x16x64_bf16 v[80:83], v[52:55], a[224:231], v2
ds_read_b128 v[44:47], v3 offset:20480
ds_read_b128 v[48:51], v3 offset:21504
v_add_u32 v0, s68, v9
s_waitcnt lgkmcnt(4)
s_barrier
ds_read_b128 v[56:59], v10
ds_read_b128 v[60:63], v11
ds_read_b128 v[64:67], v0
v_smfmac_f32_16x16x64_bf16 v[72:75], v[52:55], a[192:199], v2
s_waitcnt lgkmcnt(5)
v_smfmac_f32_16x16x64_bf16 v[84:87], v[52:55], v[36:43], v2
ds_read_b128 v[36:39], v3 offset:22528
ds_read_b128 v[40:43], v3 offset:23552
s_waitcnt lgkmcnt(5)
v_smfmac_f32_16x16x64_bf16 v[68:71], v[52:55], v[44:51], v2
ds_read_b128 v[44:47], v3 offset:24576
ds_read_b128 v[48:51], v3 offset:25600
s_waitcnt lgkmcnt(6)
v_smfmac_f32_16x16x64_bf16 v[84:87], v[56:59], a[240:247], v2
s_waitcnt lgkmcnt(2)
v_smfmac_f32_16x16x64_bf16 v[84:87], v[60:63], v[36:43], v2
ds_read_b128 v[36:39], v3 offset:26624
ds_read_b128 v[40:43], v3 offset:27648
v_smfmac_f32_16x16x64_bf16 v[84:87], v[64:67], a[248:255], v2
ds_read_b128 v[52:55], v1 offset:18432
s_waitcnt lgkmcnt(3)
v_smfmac_f32_16x16x64_bf16 v[68:71], v[56:59], v[44:51], v2
ds_read_b128 v[44:47], v3 offset:28672
ds_read_b128 v[48:51], v3 offset:29696
v_smfmac_f32_16x16x64_bf16 v[68:71], v[60:63], a[184:191], v2
v_cvt_pk_bf16_f32 v84, v84, v85
v_cvt_pk_bf16_f32 v85, v86, v87
s_waitcnt lgkmcnt(3)
v_smfmac_f32_16x16x64_bf16 v[68:71], v[64:67], v[36:43], v2
ds_read_b128 v[36:39], v3 offset:30720
ds_read_b128 v[40:43], v3 offset:31744
v_mov_b64 v[86:87], v[84:85]
s_nop 1
v_permlane32_swap_b32 v84, v86
s_waitcnt vmcnt(2)
v_smfmac_f32_16x16x64_bf16 v[72:75], v[56:59], v[12:19], v2
v_permlane32_swap_b32 v85, v87
v_and_or_b32 v84, v84, -2, s33
v_smfmac_f32_16x16x64_bf16 v[72:75], v[60:63], a[200:207], v2
s_mov_b64 exec, s[62:63]
buffer_store_dwordx4 v[84:87], v4, s[4:7], s31 offen sc1
s_mov_b64 exec, -1
v_smfmac_f32_16x16x64_bf16 v[72:75], v[64:67], v[28:35], v2
v_cvt_pk_bf16_f32 v68, v68, v69
v_cvt_pk_bf16_f32 v69, v70, v71
s_waitcnt lgkmcnt(2)
v_smfmac_f32_16x16x64_bf16 v[76:79], v[56:59], v[44:51], v2
ds_read_b128 v[44:47], v3 offset:32768
ds_read_b128 v[48:51], v3 offset:33792
v_and_or_b32 v68, v68, -2, s33
s_nop 0
v_cvt_pk_bf16_f32 v70, v72, v73
v_smfmac_f32_16x16x64_bf16 v[76:79], v[60:63], v[20:27], v2
v_cvt_pk_bf16_f32 v71, v74, v75
buffer_store_dwordx4 v[68:71], v4, s[4:7], s48 offen sc1
s_waitcnt lgkmcnt(2)
v_smfmac_f32_16x16x64_bf16 v[80:83], v[56:59], v[36:43], v2
v_smfmac_f32_16x16x64_bf16 v[76:79], v[64:67], a[216:223], v2
s_waitcnt lgkmcnt(0)
v_smfmac_f32_16x16x64_bf16 v[80:83], v[60:63], v[44:51], v2
v_smfmac_f32_16x16x64_bf16 v[80:83], v[64:67], a[232:239], v2
v_cvt_pk_bf16_f32 v76, v76, v77
v_cvt_pk_bf16_f32 v77, v78, v79
s_mov_b32 s69, 0
s_cmp_eq_u32 s59, 0
v_and_or_b32 v76, v76, -2, s33
s_nop 2
v_cvt_pk_bf16_f32 v78, v80, v81
v_cvt_pk_bf16_f32 v79, v82, v83
buffer_store_dwordx4 v[76:79], v4, s[4:7], s30 offen sc1
s_cbranch_scc1 CD_NORED
v_mov_b32 v10, -1
s_waitcnt vmcnt(0)
buffer_load_dwordx4 v[36:39], v5, s[4:7], s48 offen offset:0 sc1
buffer_load_dwordx4 v[40:43], v5, s[4:7], s48 offen offset:1024 sc1
buffer_load_dwordx4 v[44:47], v5, s[4:7], s48 offen offset:2048 sc1
buffer_load_dwordx4 v[48:51], v5, s[4:7], s48 offen offset:3072 sc1
buffer_load_dwordx4 v[12:15], v1, s[4:7], s80 offen offset:0
buffer_load_dwordx4 v[16:19], v1, s[4:7], s80 offen offset:1024
buffer_load_dwordx4 v[20:23], v1, s[4:7], s82 offen offset:0
buffer_load_dwordx4 v[24:27], v1, s[4:7], s82 offen offset:1024
s_waitcnt vmcnt(7)
v_mfma_f32_16x16x32_bf16 v[56:59], v[52:55], v[36:39], 0
v_xor_b32 v11, s33, v36
s_waitcnt vmcnt(6)
v_mfma_f32_16x16x32_bf16 v[56:59], v[52:55], v[40:43], v[56:59]
v_bitop3_b32 v11, v11, v40, s33 bitop3:0xf6
s_waitcnt vmcnt(5)
v_mfma_f32_16x16x32_bf16 v[56:59], v[52:55], v[44:47], v[56:59]
v_bitop3_b32 v11, v11, v44, s33 bitop3:0xf6
s_waitcnt vmcnt(4)
v_mfma_f32_16x16x32_bf16 v[56:59], v[52:55], v[48:51], v[56:59]
v_bitop3_b32 v11, v11, v48, s33 bitop3:0xf6
v_and_b32 v11, 1, v11
v_cmp_ne_u32 vcc, 0, v11
s_cbranch_vccnz CD_POLL1
CD_P1OK:
s_nop 3
v_add_f32_dpp v56, v56, v56 row_ror:8 row_mask:0xf bank_mask:0xf
v_add_f32_dpp v57, v57, v57 row_ror:8 row_mask:0xf bank_mask:0xf
v_add_f32_dpp v58, v58, v58 row_ror:8 row_mask:0xf bank_mask:0xf
v_add_f32_dpp v59, v59, v59 row_ror:8 row_mask:0xf bank_mask:0xf
v_cvt_pk_bf16_f32 v56, v56, v57
v_cvt_pk_bf16_f32 v57, v58, v59
v_cndmask_b32 v56, v56, v57, s[60:61]
v_min_u32 v56, -2, v56
buffer_store_dword v56, v6, s[4:7], s46 offen sc1
buffer_store_dword v10, v6, s[4:7], s47 offen sc1
CD_RED_DONE:
s_mul_i32 s49, s41, 2560
v_add_u32 v10, s49, v1
v_lshrrev_b32 v11, 1, v1
v_add_u32 v11, s49, v11
s_mov_b32 s45, s46
s_add_u32 s42, s42, 1
s_add_u32 s43, s43, 1
s_branch CD_STEP
CD_NORED:
buffer_load_dwordx4 v[12:15], v1, s[4:7], s80 offen offset:0
buffer_load_dwordx4 v[16:19], v1, s[4:7], s80 offen offset:1024
buffer_load_dwordx4 v[20:23], v1, s[4:7], s82 offen offset:0
buffer_load_dwordx4 v[24:27], v1, s[4:7], s82 offen offset:1024
s_branch CD_RED_DONE
CD_KVPOLL_2052:
s_mov_b32 s69, 0
CD_KVPOLL_2052L:
v_and_b32 v11, 48, v1
v_lshrrev_b32 v11, 2, v11
buffer_load_dword v11, v11, s[4:7], s73 offen offset:8 sc1
s_add_u32 s69, s69, 1
s_cmp_gt_u32 s69, 131072
s_cbranch_scc1 ABORT
s_waitcnt vmcnt(0)
v_min_u32_dpp v11, v11, v11 quad_perm:[1,0,3,2] row_mask:0xf bank_mask:0xf
s_nop 1
v_min_u32_dpp v11, v11, v11 quad_perm:[2,3,0,1] row_mask:0xf bank_mask:0xf
s_nop 0
v_readfirstlane_b32 s58, v11
s_nop 1
s_cmp_lt_u32 s58, s49
s_cbranch_scc1 CD_KVPOLL_2052L
s_branch CD_KVOK_2051
CD_KVPOLL_2054:
s_mov_b32 s69, 0
CD_KVPOLL_2054L:
v_and_b32 v11, 48, v1
v_lshrrev_b32 v11, 2, v11
buffer_load_dword v11, v11, s[4:7], s73 offen offset:8 sc1
s_add_u32 s69, s69, 1
s_cmp_gt_u32 s69, 131072
s_cbranch_scc1 ABORT
s_waitcnt vmcnt(0)
v_min_u32_dpp v11, v11, v11 quad_perm:[1,0,3,2] row_mask:0xf bank_mask:0xf
s_nop 1
v_min_u32_dpp v11, v11, v11 quad_perm:[2,3,0,1] row_mask:0xf bank_mask:0xf
s_nop 0
v_readfirstlane_b32 s58, v11
s_nop 1
s_cmp_lt_u32 s58, s49
s_cbranch_scc1 CD_KVPOLL_2054L
s_branch CD_KVOK_2053
CD_POLL1:
buffer_load_dwordx4 v[36:39], v5, s[4:7], s48 offen offset:0 sc1
buffer_load_dwordx4 v[40:43], v5, s[4:7], s48 offen offset:1024 sc1
buffer_load_dwordx4 v[44:47], v5, s[4:7], s48 offen offset:2048 sc1
buffer_load_dwordx4 v[48:51], v5, s[4:7], s48 offen offset:3072 sc1
s_add_u32 s69, s69, 1
s_cmp_gt_u32 s69, 131072
s_cbranch_scc1 ABORT
s_waitcnt vmcnt(3)
v_mfma_f32_16x16x32_bf16 v[56:59], v[52:55], v[36:39], 0
v_xor_b32 v11, s33, v36
s_waitcnt vmcnt(2)
v_mfma_f32_16x16x32_bf16 v[56:59], v[52:55], v[40:43], v[56:59]
v_bitop3_b32 v11, v11, v40, s33 bitop3:0xf6
s_waitcnt vmcnt(1)
v_mfma_f32_16x16x32_bf16 v[56:59], v[52:55], v[44:47], v[56:59]
v_bitop3_b32 v11, v11, v44, s33 bitop3:0xf6
s_waitcnt vmcnt(0)
v_mfma_f32_16x16x32_bf16 v[56:59], v[52:55], v[48:51], v[56:59]
v_bitop3_b32 v11, v11, v48, s33 bitop3:0xf6
v_and_b32 v11, 1, v11
v_cmp_ne_u32 vcc, 0, v11
s_cbranch_vccnz CD_POLL1
s_nop 3
s_branch CD_P1OK
CD_POLL2R:
buffer_load_dwordx4 v[76:79], v9, s[4:7], s45 offen sc1
buffer_load_dwordx4 v[80:83], v9, s[4:7], s45 offen offset:512 sc1
buffer_load_dwordx4 v[52:55], v10, s[4:7], s45 offen offset:1024 sc1
buffer_load_dwordx2 v[56:57], v11, s[4:7], s45 offen offset:2048 sc1
s_add_u32 s69, s69, 1
s_cmp_gt_u32 s69, 131072
s_cbranch_scc1 ABORT
s_branch CD_POLL2
CD_LAYER_END:
s_add_u32 s44, s44, 1
s_lshl_b32 s49, s44, 6
v_mov_b32 v10, s49
v_mov_b32 v11, 24
s_waitcnt vmcnt(0) lgkmcnt(0)
s_barrier
buffer_store_dword v10, v11, s[4:7], s73 offen sc1
s_cmp_lt_u32 s44, 2
s_cbranch_scc1 CD_LAYER
s_waitcnt vmcnt(0)
s_branch DONE
s_branch DONE
ABORT:
s_mov_b64 exec, -1
v_mov_b32 v10, 0xdead
v_mov_b32 v11, 4
buffer_store_dword v10, v11, s[8:11], 0 offen
DONE:
s_endpgm
CODE_END:
.section .rodata,"a"
.p2align 6
.amdhsa_kernel interleave_layers__memory_aug_recurrent_mem_tr__mixer_token_mlp__prompt_kernel
  .amdhsa_next_free_vgpr 512
  .amdhsa_next_free_sgpr 102
  .amdhsa_accum_offset 256
  .amdhsa_group_segment_fixed_size 0
  .amdhsa_kernarg_size 120
  .amdhsa_user_sgpr_count 2
  .amdhsa_user_sgpr_kernarg_segment_ptr 1
  .amdhsa_system_sgpr_workgroup_id_x 1
.end_amdhsa_kernel
```
